```python
import torch

def _softmax(x, axis=-1):
    return torch.softmax(x, dim=axis)
def _gelu(x):
    return torch.nn.functional.gelu(x, approximate="tanh")
def _silu(x):
    return torch.nn.functional.silu(x)
def _sigmoid(x):
    return torch.sigmoid(x)
def _layernorm(x, axis=-1, eps=1e-5):
    m = x.mean(dim=axis, keepdim=True)
    v = x.var(dim=axis, keepdim=True, unbiased=False)
    return (x - m) / torch.sqrt(v + eps)
def _scatter_add(tgt, idx, src, axis=0):
    return tgt.clone().index_add_(axis, idx, src)
def _segment_sum(src, seg, n):
    out = torch.zeros((n,) + src.shape[1:], dtype=src.dtype)
    return out.index_add_(0, seg, src)
def _pad(x, pw):
    flat = tuple(v for pair in reversed(pw) for v in pair)
    return torch.nn.functional.pad(x, flat)

kernel_name = 'recurrent_scan__gqa_block_cached__glu_gated_glu__prompt'

def setup_inputs():

    _w = (lambda a: (lambda t: t.to(torch.bfloat16) if t.is_floating_point() else t)(torch.as_tensor(a)))
    def _A_setup():
        B, Sq, D = 1, 2048, 512
        Hq, Hkv, Sk, Dh = 32, 8, 2048, 128
        assert Hq % Hkv == 0, (Hq, Hkv)
        return {
            "x": _w((lambda *s: torch.randn(*s, dtype=torch.bfloat16) * 0.05)(B, Sq, D)),
            "k_cache": _w((lambda *s: torch.randn(*s, dtype=torch.bfloat16) * 1.6)(B, Hkv, Sk, Dh)),
            "v_cache": _w((lambda *s: torch.randn(*s, dtype=torch.bfloat16) * 0.2)(B, Hkv, Sk, Dh)),
            "wq": _w((lambda *s: torch.randn(*s, dtype=torch.bfloat16) * 1.6)(D, Hq * Dh) * (D ** -0.5)),
            "wo": _w((lambda *s: torch.randn(*s, dtype=torch.bfloat16) * 0.2)(Hq * Dh, D) * ((Hq * Dh) ** -0.5)),
        }
    _A_in = _A_setup()

    def _B_setup():
        B, S, D, F = 1, 2048, 512, 1792
        return {
            "x": _w((lambda *s: torch.randn(*s, dtype=torch.bfloat16) * 0.05)(B, S, D)),
            "w_gate": _w((lambda *s: torch.randn(*s, dtype=torch.bfloat16) * 0.2)(D, F)),
            "w_up": _w((lambda *s: torch.randn(*s, dtype=torch.bfloat16) * 0.1)(D, F)),
            "w_down": _w((lambda *s: torch.randn(*s, dtype=torch.bfloat16) * 0.1)(F, D)),
        }
    _B_in = _B_setup()

    return {
        "A_x": _A_in["x"],
        "A_k_cache": _A_in["k_cache"],
        "A_v_cache": _A_in["v_cache"],
        "A_wq": _A_in["wq"],
        "A_wo": _A_in["wo"],
        "B_x": _B_in["x"],
        "B_w_gate": _B_in["w_gate"],
        "B_w_up": _B_in["w_up"],
        "B_w_down": _B_in["w_down"],
    }

def reference(A_x, A_k_cache, A_v_cache, A_wq, A_wo, B_x, B_w_gate, B_w_up, B_w_down):
    def _A_ref(x, k_cache, v_cache, wq, wo):
        B, Sq, D = x.shape
        Hq, Dh = 32, 128
        Hkv = k_cache.shape[1]
        rep = Hq // Hkv
        q = (lambda x, *d: x.permute(*d))((x @ wq).reshape(B, Sq, Hq, Dh), 0, 2, 1, 3)
        k = (lambda x, n, axis: torch.repeat_interleave(x, n, dim=axis))(k_cache, rep, axis=1)
        v = (lambda x, n, axis: torch.repeat_interleave(x, n, dim=axis))(v_cache, rep, axis=1)
        scores = torch.einsum("bhqd,bhkd->bhqk", q, k) * (Dh ** -0.5)
        p = _softmax(scores, axis=-1)
        o = torch.einsum("bhqk,bhkd->bhqd", p, v)
        return (lambda x, *d: x.permute(*d))(o, 0, 2, 1, 3).reshape(B, Sq, Hq * Dh) @ wo

    def _B_ref(x, w_gate, w_up, w_down):
        g = torch.einsum("bsd,df->bsf", x, w_gate)
        u = torch.einsum("bsd,df->bsf", x, w_up)
        h = _sigmoid(g) * u
        return torch.einsum("bsf,fd->bsd", h, w_down)

    x = A_x
    xn = _layernorm(x, axis=-1)
    s = _A_ref(xn, A_k_cache, A_v_cache, A_wq, A_wo)
    g = _silu(_B_ref(xn, B_w_gate, B_w_up, B_w_down))
    return x + s * g
```

```asm
; @launch grid=(256,1,1) block=(256,1,1) lds=163840
.amdgcn_target "amdgcn-amd-amdhsa--gfx950"
.text
.globl recurrent_scan__gqa_block_cached__glu_gated_glu__prompt_kernel
.p2align 8
.type recurrent_scan__gqa_block_cached__glu_gated_glu__prompt_kernel,@function
recurrent_scan__gqa_block_cached__glu_gated_glu__prompt_kernel:
    s_cmp_ge_u32 s2, 256
    s_cbranch_scc1 L_end
    s_load_dwordx16 s[64:79], s[0:1], 0
    s_load_dwordx4 s[80:83], s[0:1], 64
    s_load_dwordx4 s[84:87], s[0:1], 80
    s_memrealtime s[60:61]
    s_getpc_b64 s[28:29]
    v_lshlrev_b32 v208, 5, v0
    global_load_dword a97, v208, s[28:29]
    v_lshrrev_b32 v2, 6, v0
    v_and_b32 v0, 63, v0
    v_readfirstlane_b32 s42, v2
    s_and_b32 s40, s2, 7
    s_lshr_b32 s41, s2, 3
    s_and_b32 s43, s41, 15
    s_and_b32 s63, s2, 1
    v_and_b32 v2, 15, v0
    v_lshrrev_b32 v3, 4, v0
    s_lshl_b32 s52, s42, 14
    v_lshlrev_b32 v4, 10, v2
    v_lshl_add_u32 v4, v3, 4, v4
    v_add_u32 v4, s52, v4
    s_and_b32 s53, s43, 14
    v_lshl_add_u32 v228, s53, 6, v4
    s_lshl_b32 s51, s41, 16
    v_xor_b32 v229, 128, v228
    v_xor_b32 v230, 256, v228
    v_xor_b32 v231, 384, v228
    v_xor_b32 v232, 512, v228
    v_xor_b32 v233, 640, v228
    v_xor_b32 v234, 768, v228
    v_xor_b32 v235, 896, v228
    s_waitcnt lgkmcnt(0)
    s_add_u32 s4, s64, s51
    s_addc_u32 s5, s65, 0
    s_sub_u32 s6, 2097152, s51
    s_mov_b32 s7, 0x20000
    buffer_load_dwordx4 v[128:131], v228, s[4:7], 0 offen offset:0
    buffer_load_dwordx4 v[132:135], v228, s[4:7], 0 offen offset:64
    buffer_load_dwordx4 v[136:139], v229, s[4:7], 0 offen offset:0
    buffer_load_dwordx4 v[140:143], v229, s[4:7], 0 offen offset:64
    buffer_load_dwordx4 v[144:147], v230, s[4:7], 0 offen offset:0
    buffer_load_dwordx4 v[148:151], v230, s[4:7], 0 offen offset:64
    buffer_load_dwordx4 v[152:155], v231, s[4:7], 0 offen offset:0
    buffer_load_dwordx4 v[156:159], v231, s[4:7], 0 offen offset:64
    buffer_load_dwordx4 v[160:163], v232, s[4:7], 0 offen offset:0
    buffer_load_dwordx4 v[164:167], v232, s[4:7], 0 offen offset:64
    buffer_load_dwordx4 v[168:171], v233, s[4:7], 0 offen offset:0
    buffer_load_dwordx4 v[172:175], v233, s[4:7], 0 offen offset:64
    buffer_load_dwordx4 v[176:179], v234, s[4:7], 0 offen offset:0
    buffer_load_dwordx4 v[180:183], v234, s[4:7], 0 offen offset:64
    buffer_load_dwordx4 v[184:187], v235, s[4:7], 0 offen offset:0
    buffer_load_dwordx4 v[188:191], v235, s[4:7], 0 offen offset:64
    v_lshlrev_b32 v1, 4, v0
    s_lshl_b32 s52, s42, 10
    v_add_u32 v211, s52, v1
    s_xor_b32 s52, s53, 0
    s_sub_u32 s52, s52, s43
    s_and_b32 s52, s52, 15
    v_lshl_add_u32 v212, s52, 12, v211
    s_xor_b32 s52, s53, 1
    s_sub_u32 s52, s52, s43
    s_and_b32 s52, s52, 15
    v_lshl_add_u32 v213, s52, 12, v211
    s_xor_b32 s52, s53, 2
    s_sub_u32 s52, s52, s43
    s_and_b32 s52, s52, 15
    v_lshl_add_u32 v214, s52, 12, v211
    s_xor_b32 s52, s53, 3
    s_sub_u32 s52, s52, s43
    s_and_b32 s52, s52, 15
    v_lshl_add_u32 v215, s52, 12, v211
    s_xor_b32 s52, s53, 4
    s_sub_u32 s52, s52, s43
    s_and_b32 s52, s52, 15
    v_lshl_add_u32 v216, s52, 12, v211
    s_xor_b32 s52, s53, 5
    s_sub_u32 s52, s52, s43
    s_and_b32 s52, s52, 15
    v_lshl_add_u32 v217, s52, 12, v211
    s_xor_b32 s52, s53, 6
    s_sub_u32 s52, s52, s43
    s_and_b32 s52, s52, 15
    v_lshl_add_u32 v218, s52, 12, v211
    s_xor_b32 s52, s53, 7
    s_sub_u32 s52, s52, s43
    s_and_b32 s52, s52, 15
    v_lshl_add_u32 v219, s52, 12, v211
    s_xor_b32 s52, s53, 8
    s_sub_u32 s52, s52, s43
    s_and_b32 s52, s52, 15
    v_lshl_add_u32 v220, s52, 12, v211
    s_xor_b32 s52, s53, 9
    s_sub_u32 s52, s52, s43
    s_and_b32 s52, s52, 15
    v_lshl_add_u32 v221, s52, 12, v211
    s_xor_b32 s52, s53, 10
    s_sub_u32 s52, s52, s43
    s_and_b32 s52, s52, 15
    v_lshl_add_u32 v222, s52, 12, v211
    s_xor_b32 s52, s53, 11
    s_sub_u32 s52, s52, s43
    s_and_b32 s52, s52, 15
    v_lshl_add_u32 v223, s52, 12, v211
    s_xor_b32 s52, s53, 12
    s_sub_u32 s52, s52, s43
    s_and_b32 s52, s52, 15
    v_lshl_add_u32 v224, s52, 12, v211
    s_xor_b32 s52, s53, 13
    s_sub_u32 s52, s52, s43
    s_and_b32 s52, s52, 15
    v_lshl_add_u32 v225, s52, 12, v211
    s_xor_b32 s52, s53, 14
    s_sub_u32 s52, s52, s43
    s_and_b32 s52, s52, 15
    v_lshl_add_u32 v226, s52, 12, v211
    s_xor_b32 s52, s53, 15
    s_sub_u32 s52, s52, s43
    s_and_b32 s52, s52, 15
    v_lshl_add_u32 v227, s52, 12, v211
    s_getpc_b64 s[8:9]
L_pc:
    s_lshl_b32 s52, s41, 2
    s_add_u32 s52, s52, s42
    s_lshl_b32 s52, s52, 9
    v_lshl_add_u32 v210, v0, 3, s52
    v_min_u32 v210, L_code_end - L_pc - 4, v210
    s_mul_i32 s51, s40, 448
    s_lshl_b32 s52, s42, 7
    s_add_u32 s51, s51, s52
    s_lshl_b32 s52, s63, 6
    s_sub_u32 s51, s51, s52
    s_add_u32 s24, s76, s51
    s_addc_u32 s25, s77, 0
    s_sub_u32 s26, 1835008, s51
    s_mov_b32 s27, 0x20000
    s_add_u32 s28, s78, s51
    s_addc_u32 s29, s79, 0
    s_sub_u32 s30, 1835008, s51
    s_mov_b32 s31, 0x20000
    s_mul_i32 s45, s42, 24576
    s_add_u32 s45, s45, 65536
    s_mul_i32 s64, s43, 114688
    s_add_u32 s65, s64, 114688
    s_sub_u32 s52, s65, 1835008
    s_min_u32 s65, s65, s52
    v_lshrrev_b32 v6, 3, v0
    v_and_b32 v8, 7, v0
    v_and_b32 v7, 1, v3
    v_lshlrev_b32 v7, 1, v7
    v_xor_b32 v7, v7, v8
    v_lshlrev_b32 v9, 1, v3
    v_xor_b32 v8, v9, v8
    s_mul_i32 s51, s63, 3
    s_add_u32 s51, s51, s42
    s_cmp_eq_u32 s51, 3
    s_cselect_b32 s52, 4, 0
    s_lshl_b32 s53, s63, 2
    v_mul_u32_u24 v9, 3584, v6
    v_xor_b32 v18, 0, v7
    v_xor_b32 v4, s53, v18
    v_and_b32 v4, s52, v4
    v_lshl_add_u32 v4, v4, 28, v9
    v_lshl_add_u32 v18, v18, 4, v4
    v_xor_b32 v19, 4, v7
    v_xor_b32 v4, s53, v19
    v_and_b32 v4, s52, v4
    v_lshl_add_u32 v4, v4, 28, v9
    v_lshl_add_u32 v19, v19, 4, v4
    v_add_u32 v19, 27648, v19
    v_xor_b32 v20, 0, v7
    v_xor_b32 v4, s53, v20
    v_and_b32 v4, s52, v4
    v_lshl_add_u32 v4, v4, 28, v9
    v_lshl_add_u32 v20, v20, 4, v4
    v_add_u32 v20, 55296, v20
    v_xor_b32 v21, 4, v7
    v_xor_b32 v4, s53, v21
    v_and_b32 v4, s52, v4
    v_lshl_add_u32 v4, v4, 28, v9
    v_lshl_add_u32 v21, v21, 4, v4
    v_add_u32 v21, 82944, v21
    v_bfe_u32 v4, v0, 2, 2
    v_and_b32 v5, 3, v0
    v_lshrrev_b32 v6, 1, v4
    v_and_b32 v7, 1, v3
    v_lshl_add_u32 v6, v7, 1, v6
    v_lshlrev_b32 v6, 5, v6
    v_lshl_add_u32 v6, v5, 3, v6
    v_lshl_add_u32 v6, v4, 7, v6
    v_add_u32 v6, s45, v6
    v_lshl_add_u32 v10, v3, 10, v6
    v_mov_b32 v6, 0x3f803f80
    s_mov_b32 s62, 0x3e0293ee
    v_xor_b32 v11, 32, v10
    v_xor_b32 v12, 64, v10
    v_xor_b32 v13, 96, v10
    v_accvgpr_write_b32 a108, v6
    v_accvgpr_write_b32 a109, v6
    v_accvgpr_write_b32 a110, v6
    v_accvgpr_write_b32 a111, v6
    v_cmp_eq_u32 s[10:11], 1, v5
    v_cmp_eq_u32 s[12:13], 2, v5
    v_cmp_eq_u32 s[14:15], 3, v5
    v_cmp_eq_u32 s[16:17], v4, v3
    s_mov_b32 s61, 0xffff0000
    s_waitcnt vmcnt(15)
    v_mfma_f32_16x16x32_bf16 v[192:195], a[108:111], v[128:131], 0
    v_mfma_f32_16x16x32_bf16 v[196:199], v[128:131], v[128:131], 0
    s_waitcnt vmcnt(14)
    v_mfma_f32_16x16x32_bf16 v[192:195], a[108:111], v[132:135], v[192:195]
    v_mfma_f32_16x16x32_bf16 v[196:199], v[132:135], v[132:135], v[196:199]
    s_waitcnt vmcnt(13)
    v_mfma_f32_16x16x32_bf16 v[192:195], a[108:111], v[136:139], v[192:195]
    v_mfma_f32_16x16x32_bf16 v[196:199], v[136:139], v[136:139], v[196:199]
    s_waitcnt vmcnt(12)
    v_mfma_f32_16x16x32_bf16 v[192:195], a[108:111], v[140:143], v[192:195]
    v_mfma_f32_16x16x32_bf16 v[196:199], v[140:143], v[140:143], v[196:199]
    s_waitcnt vmcnt(11)
    v_mfma_f32_16x16x32_bf16 v[192:195], a[108:111], v[144:147], v[192:195]
    v_mfma_f32_16x16x32_bf16 v[196:199], v[144:147], v[144:147], v[196:199]
    s_waitcnt vmcnt(10)
    v_mfma_f32_16x16x32_bf16 v[192:195], a[108:111], v[148:151], v[192:195]
    v_mfma_f32_16x16x32_bf16 v[196:199], v[148:151], v[148:151], v[196:199]
    s_waitcnt vmcnt(9)
    v_mfma_f32_16x16x32_bf16 v[192:195], a[108:111], v[152:155], v[192:195]
    v_mfma_f32_16x16x32_bf16 v[196:199], v[152:155], v[152:155], v[196:199]
    s_waitcnt vmcnt(8)
    v_mfma_f32_16x16x32_bf16 v[192:195], a[108:111], v[156:159], v[192:195]
    v_mfma_f32_16x16x32_bf16 v[196:199], v[156:159], v[156:159], v[196:199]
    s_waitcnt vmcnt(7)
    v_mfma_f32_16x16x32_bf16 v[192:195], a[108:111], v[160:163], v[192:195]
    v_mfma_f32_16x16x32_bf16 v[196:199], v[160:163], v[160:163], v[196:199]
    s_waitcnt vmcnt(6)
    v_mfma_f32_16x16x32_bf16 v[192:195], a[108:111], v[164:167], v[192:195]
    v_mfma_f32_16x16x32_bf16 v[196:199], v[164:167], v[164:167], v[196:199]
    s_waitcnt vmcnt(5)
    v_mfma_f32_16x16x32_bf16 v[192:195], a[108:111], v[168:171], v[192:195]
    v_mfma_f32_16x16x32_bf16 v[196:199], v[168:171], v[168:171], v[196:199]
    s_waitcnt vmcnt(4)
    v_mfma_f32_16x16x32_bf16 v[192:195], a[108:111], v[172:175], v[192:195]
    v_mfma_f32_16x16x32_bf16 v[196:199], v[172:175], v[172:175], v[196:199]
    s_waitcnt vmcnt(3)
    v_mfma_f32_16x16x32_bf16 v[192:195], a[108:111], v[176:179], v[192:195]
    v_mfma_f32_16x16x32_bf16 v[196:199], v[176:179], v[176:179], v[196:199]
    s_waitcnt vmcnt(2)
    v_mfma_f32_16x16x32_bf16 v[192:195], a[108:111], v[180:183], v[192:195]
    v_mfma_f32_16x16x32_bf16 v[196:199], v[180:183], v[180:183], v[196:199]
    s_waitcnt vmcnt(1)
    v_mfma_f32_16x16x32_bf16 v[192:195], a[108:111], v[184:187], v[192:195]
    v_mfma_f32_16x16x32_bf16 v[196:199], v[184:187], v[184:187], v[196:199]
    s_waitcnt vmcnt(0)
    v_mfma_f32_16x16x32_bf16 v[192:195], a[108:111], v[188:191], v[192:195]
    v_mfma_f32_16x16x32_bf16 v[196:199], v[188:191], v[188:191], v[196:199]
    s_nop 6
    v_mul_f32 v192, 0x3b000000, v192
    v_cndmask_b32 v196, v196, v197, s[10:11]
    v_cndmask_b32 v196, v196, v198, s[12:13]
    v_cndmask_b32 v196, v196, v199, s[14:15]
    v_cndmask_b32 v196, 0, v196, s[16:17]
    s_add_u32 m0, s45, 0
    s_nop 0
    buffer_load_dwordx4 v18, s[24:27], s64 offen offset:0 lds
    v_mov_b32 v197, v196
    s_nop 1
    v_permlane32_swap_b32 v196, v197
    v_add_f32 v196, v196, v197
    v_mov_b32 v197, v196
    s_nop 1
    v_permlane16_swap_b32 v196, v197
    v_add_f32 v196, v196, v197
    buffer_load_dwordx4 v19, s[24:27], s64 offen offset:1024 lds
    v_mul_f32 v196, 0x3b000000, v196
    v_fma_f32 v196, -v192, v192, v196
    v_max_f32 v196, 0, v196
    v_cvt_pk_bf16_f32 v196, v196, v196
    v_lshlrev_b32 v196, 16, v196
    v_add_f32 v196, 0x3727c5ac, v196
    v_cvt_pk_bf16_f32 v196, v196, v196
    v_lshlrev_b32 v196, 16, v196
    buffer_load_dwordx4 v20, s[24:27], s64 offen offset:2048 lds
    v_sqrt_f32 v196, v196
    s_nop 0
    v_cvt_pk_bf16_f32 v196, v196, v196
    v_lshlrev_b32 v196, 16, v196
    v_cvt_pk_bf16_f32 v192, v192, v192
    v_lshlrev_b32 v192, 16, v192
    buffer_load_dwordx4 v21, s[24:27], s64 offen offset:3072 lds
    v_rcp_f32 v196, v196
    s_nop 0
    v_mul_f32 v196, s62, v196
    v_mul_f32 v192, v192, v196
    v_lshlrev_b32 v206, 16, v128
    v_and_b32 v207, s61, v128
    v_lshlrev_b32 v208, 16, v129
    v_and_b32 v209, s61, v129
    v_pk_fma_f32 v[206:207], v[206:207], v[196:197], v[192:193] op_sel_hi:[1,0,0] neg_lo:[0,0,1] neg_hi:[0,0,1]
    v_pk_fma_f32 v[208:209], v[208:209], v[196:197], v[192:193] op_sel_hi:[1,0,0] neg_lo:[0,0,1] neg_hi:[0,0,1]
    v_cvt_pk_bf16_f32 v128, v206, v207
    v_cvt_pk_bf16_f32 v129, v208, v209
    v_lshlrev_b32 v206, 16, v130
    v_and_b32 v207, s61, v130
    v_lshlrev_b32 v208, 16, v131
    v_and_b32 v209, s61, v131
    v_pk_fma_f32 v[206:207], v[206:207], v[196:197], v[192:193] op_sel_hi:[1,0,0] neg_lo:[0,0,1] neg_hi:[0,0,1]
    v_pk_fma_f32 v[208:209], v[208:209], v[196:197], v[192:193] op_sel_hi:[1,0,0] neg_lo:[0,0,1] neg_hi:[0,0,1]
    v_cvt_pk_bf16_f32 v130, v206, v207
    v_cvt_pk_bf16_f32 v131, v208, v209
    ds_write_b128 v212, v[128:131]
    s_add_u32 m0, s45, 4096
    s_nop 0
    buffer_load_dwordx4 v18, s[28:31], s64 offen offset:0 lds
    v_lshlrev_b32 v206, 16, v132
    v_and_b32 v207, s61, v132
    v_lshlrev_b32 v208, 16, v133
    v_and_b32 v209, s61, v133
    v_pk_fma_f32 v[206:207], v[206:207], v[196:197], v[192:193] op_sel_hi:[1,0,0] neg_lo:[0,0,1] neg_hi:[0,0,1]
    v_pk_fma_f32 v[208:209], v[208:209], v[196:197], v[192:193] op_sel_hi:[1,0,0] neg_lo:[0,0,1] neg_hi:[0,0,1]
    v_cvt_pk_bf16_f32 v132, v206, v207
    v_cvt_pk_bf16_f32 v133, v208, v209
    v_lshlrev_b32 v206, 16, v134
    v_and_b32 v207, s61, v134
    v_lshlrev_b32 v208, 16, v135
    v_and_b32 v209, s61, v135
    v_pk_fma_f32 v[206:207], v[206:207], v[196:197], v[192:193] op_sel_hi:[1,0,0] neg_lo:[0,0,1] neg_hi:[0,0,1]
    v_pk_fma_f32 v[208:209], v[208:209], v[196:197], v[192:193] op_sel_hi:[1,0,0] neg_lo:[0,0,1] neg_hi:[0,0,1]
    v_cvt_pk_bf16_f32 v134, v206, v207
    v_cvt_pk_bf16_f32 v135, v208, v209
    ds_write_b128 v213, v[132:135]
    buffer_load_dwordx4 v19, s[28:31], s64 offen offset:1024 lds
    v_lshlrev_b32 v206, 16, v136
    v_and_b32 v207, s61, v136
    v_lshlrev_b32 v208, 16, v137
    v_and_b32 v209, s61, v137
    v_pk_fma_f32 v[206:207], v[206:207], v[196:197], v[192:193] op_sel_hi:[1,0,0] neg_lo:[0,0,1] neg_hi:[0,0,1]
    v_pk_fma_f32 v[208:209], v[208:209], v[196:197], v[192:193] op_sel_hi:[1,0,0] neg_lo:[0,0,1] neg_hi:[0,0,1]
    v_cvt_pk_bf16_f32 v136, v206, v207
    v_cvt_pk_bf16_f32 v137, v208, v209
    v_lshlrev_b32 v206, 16, v138
    v_and_b32 v207, s61, v138
    v_lshlrev_b32 v208, 16, v139
    v_and_b32 v209, s61, v139
    v_pk_fma_f32 v[206:207], v[206:207], v[196:197], v[192:193] op_sel_hi:[1,0,0] neg_lo:[0,0,1] neg_hi:[0,0,1]
    v_pk_fma_f32 v[208:209], v[208:209], v[196:197], v[192:193] op_sel_hi:[1,0,0] neg_lo:[0,0,1] neg_hi:[0,0,1]
    v_cvt_pk_bf16_f32 v138, v206, v207
    v_cvt_pk_bf16_f32 v139, v208, v209
    ds_write_b128 v214, v[136:139]
    buffer_load_dwordx4 v20, s[28:31], s64 offen offset:2048 lds
    v_lshlrev_b32 v206, 16, v140
    v_and_b32 v207, s61, v140
    v_lshlrev_b32 v208, 16, v141
    v_and_b32 v209, s61, v141
    v_pk_fma_f32 v[206:207], v[206:207], v[196:197], v[192:193] op_sel_hi:[1,0,0] neg_lo:[0,0,1] neg_hi:[0,0,1]
    v_pk_fma_f32 v[208:209], v[208:209], v[196:197], v[192:193] op_sel_hi:[1,0,0] neg_lo:[0,0,1] neg_hi:[0,0,1]
    v_cvt_pk_bf16_f32 v140, v206, v207
    v_cvt_pk_bf16_f32 v141, v208, v209
    v_lshlrev_b32 v206, 16, v142
    v_and_b32 v207, s61, v142
    v_lshlrev_b32 v208, 16, v143
    v_and_b32 v209, s61, v143
    v_pk_fma_f32 v[206:207], v[206:207], v[196:197], v[192:193] op_sel_hi:[1,0,0] neg_lo:[0,0,1] neg_hi:[0,0,1]
    v_pk_fma_f32 v[208:209], v[208:209], v[196:197], v[192:193] op_sel_hi:[1,0,0] neg_lo:[0,0,1] neg_hi:[0,0,1]
    v_cvt_pk_bf16_f32 v142, v206, v207
    v_cvt_pk_bf16_f32 v143, v208, v209
    ds_write_b128 v215, v[140:143]
    buffer_load_dwordx4 v21, s[28:31], s64 offen offset:3072 lds
    v_lshlrev_b32 v206, 16, v144
    v_and_b32 v207, s61, v144
    v_lshlrev_b32 v208, 16, v145
    v_and_b32 v209, s61, v145
    v_pk_fma_f32 v[206:207], v[206:207], v[196:197], v[192:193] op_sel_hi:[1,0,0] neg_lo:[0,0,1] neg_hi:[0,0,1]
    v_pk_fma_f32 v[208:209], v[208:209], v[196:197], v[192:193] op_sel_hi:[1,0,0] neg_lo:[0,0,1] neg_hi:[0,0,1]
    v_cvt_pk_bf16_f32 v144, v206, v207
    v_cvt_pk_bf16_f32 v145, v208, v209
    v_lshlrev_b32 v206, 16, v146
    v_and_b32 v207, s61, v146
    v_lshlrev_b32 v208, 16, v147
    v_and_b32 v209, s61, v147
    v_pk_fma_f32 v[206:207], v[206:207], v[196:197], v[192:193] op_sel_hi:[1,0,0] neg_lo:[0,0,1] neg_hi:[0,0,1]
    v_pk_fma_f32 v[208:209], v[208:209], v[196:197], v[192:193] op_sel_hi:[1,0,0] neg_lo:[0,0,1] neg_hi:[0,0,1]
    v_cvt_pk_bf16_f32 v146, v206, v207
    v_cvt_pk_bf16_f32 v147, v208, v209
    ds_write_b128 v216, v[144:147]
    s_add_u32 m0, s45, 8192
    s_nop 0
    buffer_load_dwordx4 v18, s[24:27], s65 offen offset:0 lds
    s_add_u32 s64, s64, 229376
    s_sub_u32 s48, s64, 1835008
    s_min_u32 s64, s64, s48
    v_lshlrev_b32 v206, 16, v148
    v_and_b32 v207, s61, v148
    v_lshlrev_b32 v208, 16, v149
    v_and_b32 v209, s61, v149
    v_pk_fma_f32 v[206:207], v[206:207], v[196:197], v[192:193] op_sel_hi:[1,0,0] neg_lo:[0,0,1] neg_hi:[0,0,1]
    v_pk_fma_f32 v[208:209], v[208:209], v[196:197], v[192:193] op_sel_hi:[1,0,0] neg_lo:[0,0,1] neg_hi:[0,0,1]
    v_cvt_pk_bf16_f32 v148, v206, v207
    v_cvt_pk_bf16_f32 v149, v208, v209
    v_lshlrev_b32 v206, 16, v150
    v_and_b32 v207, s61, v150
    v_lshlrev_b32 v208, 16, v151
    v_and_b32 v209, s61, v151
    v_pk_fma_f32 v[206:207], v[206:207], v[196:197], v[192:193] op_sel_hi:[1,0,0] neg_lo:[0,0,1] neg_hi:[0,0,1]
    v_pk_fma_f32 v[208:209], v[208:209], v[196:197], v[192:193] op_sel_hi:[1,0,0] neg_lo:[0,0,1] neg_hi:[0,0,1]
    v_cvt_pk_bf16_f32 v150, v206, v207
    v_cvt_pk_bf16_f32 v151, v208, v209
    ds_write_b128 v217, v[148:151]
    buffer_load_dwordx4 v19, s[24:27], s65 offen offset:1024 lds
    v_lshlrev_b32 v206, 16, v152
    v_and_b32 v207, s61, v152
    v_lshlrev_b32 v208, 16, v153
    v_and_b32 v209, s61, v153
    v_pk_fma_f32 v[206:207], v[206:207], v[196:197], v[192:193] op_sel_hi:[1,0,0] neg_lo:[0,0,1] neg_hi:[0,0,1]
    v_pk_fma_f32 v[208:209], v[208:209], v[196:197], v[192:193] op_sel_hi:[1,0,0] neg_lo:[0,0,1] neg_hi:[0,0,1]
    v_cvt_pk_bf16_f32 v152, v206, v207
    v_cvt_pk_bf16_f32 v153, v208, v209
    v_lshlrev_b32 v206, 16, v154
    v_and_b32 v207, s61, v154
    v_lshlrev_b32 v208, 16, v155
    v_and_b32 v209, s61, v155
    v_pk_fma_f32 v[206:207], v[206:207], v[196:197], v[192:193] op_sel_hi:[1,0,0] neg_lo:[0,0,1] neg_hi:[0,0,1]
    v_pk_fma_f32 v[208:209], v[208:209], v[196:197], v[192:193] op_sel_hi:[1,0,0] neg_lo:[0,0,1] neg_hi:[0,0,1]
    v_cvt_pk_bf16_f32 v154, v206, v207
    v_cvt_pk_bf16_f32 v155, v208, v209
    ds_write_b128 v218, v[152:155]
    buffer_load_dwordx4 v20, s[24:27], s65 offen offset:2048 lds
    v_lshlrev_b32 v206, 16, v156
    v_and_b32 v207, s61, v156
    v_lshlrev_b32 v208, 16, v157
    v_and_b32 v209, s61, v157
    v_pk_fma_f32 v[206:207], v[206:207], v[196:197], v[192:193] op_sel_hi:[1,0,0] neg_lo:[0,0,1] neg_hi:[0,0,1]
    v_pk_fma_f32 v[208:209], v[208:209], v[196:197], v[192:193] op_sel_hi:[1,0,0] neg_lo:[0,0,1] neg_hi:[0,0,1]
    v_cvt_pk_bf16_f32 v156, v206, v207
    v_cvt_pk_bf16_f32 v157, v208, v209
    v_lshlrev_b32 v206, 16, v158
    v_and_b32 v207, s61, v158
    v_lshlrev_b32 v208, 16, v159
    v_and_b32 v209, s61, v159
    v_pk_fma_f32 v[206:207], v[206:207], v[196:197], v[192:193] op_sel_hi:[1,0,0] neg_lo:[0,0,1] neg_hi:[0,0,1]
    v_pk_fma_f32 v[208:209], v[208:209], v[196:197], v[192:193] op_sel_hi:[1,0,0] neg_lo:[0,0,1] neg_hi:[0,0,1]
    v_cvt_pk_bf16_f32 v158, v206, v207
    v_cvt_pk_bf16_f32 v159, v208, v209
    ds_write_b128 v219, v[156:159]
    buffer_load_dwordx4 v21, s[24:27], s65 offen offset:3072 lds
    v_lshlrev_b32 v206, 16, v160
    v_and_b32 v207, s61, v160
    v_lshlrev_b32 v208, 16, v161
    v_and_b32 v209, s61, v161
    v_pk_fma_f32 v[206:207], v[206:207], v[196:197], v[192:193] op_sel_hi:[1,0,0] neg_lo:[0,0,1] neg_hi:[0,0,1]
    v_pk_fma_f32 v[208:209], v[208:209], v[196:197], v[192:193] op_sel_hi:[1,0,0] neg_lo:[0,0,1] neg_hi:[0,0,1]
    v_cvt_pk_bf16_f32 v160, v206, v207
    v_cvt_pk_bf16_f32 v161, v208, v209
    v_lshlrev_b32 v206, 16, v162
    v_and_b32 v207, s61, v162
    v_lshlrev_b32 v208, 16, v163
    v_and_b32 v209, s61, v163
    v_pk_fma_f32 v[206:207], v[206:207], v[196:197], v[192:193] op_sel_hi:[1,0,0] neg_lo:[0,0,1] neg_hi:[0,0,1]
    v_pk_fma_f32 v[208:209], v[208:209], v[196:197], v[192:193] op_sel_hi:[1,0,0] neg_lo:[0,0,1] neg_hi:[0,0,1]
    v_cvt_pk_bf16_f32 v162, v206, v207
    v_cvt_pk_bf16_f32 v163, v208, v209
    ds_write_b128 v220, v[160:163]
    s_add_u32 m0, s45, 12288
    s_nop 0
    buffer_load_dwordx4 v18, s[28:31], s65 offen offset:0 lds
    v_lshlrev_b32 v206, 16, v164
    v_and_b32 v207, s61, v164
    v_lshlrev_b32 v208, 16, v165
    v_and_b32 v209, s61, v165
    v_pk_fma_f32 v[206:207], v[206:207], v[196:197], v[192:193] op_sel_hi:[1,0,0] neg_lo:[0,0,1] neg_hi:[0,0,1]
    v_pk_fma_f32 v[208:209], v[208:209], v[196:197], v[192:193] op_sel_hi:[1,0,0] neg_lo:[0,0,1] neg_hi:[0,0,1]
    v_cvt_pk_bf16_f32 v164, v206, v207
    v_cvt_pk_bf16_f32 v165, v208, v209
    v_lshlrev_b32 v206, 16, v166
    v_and_b32 v207, s61, v166
    v_lshlrev_b32 v208, 16, v167
    v_and_b32 v209, s61, v167
    v_pk_fma_f32 v[206:207], v[206:207], v[196:197], v[192:193] op_sel_hi:[1,0,0] neg_lo:[0,0,1] neg_hi:[0,0,1]
    v_pk_fma_f32 v[208:209], v[208:209], v[196:197], v[192:193] op_sel_hi:[1,0,0] neg_lo:[0,0,1] neg_hi:[0,0,1]
    v_cvt_pk_bf16_f32 v166, v206, v207
    v_cvt_pk_bf16_f32 v167, v208, v209
    ds_write_b128 v221, v[164:167]
    buffer_load_dwordx4 v19, s[28:31], s65 offen offset:1024 lds
    v_lshlrev_b32 v206, 16, v168
    v_and_b32 v207, s61, v168
    v_lshlrev_b32 v208, 16, v169
    v_and_b32 v209, s61, v169
    v_pk_fma_f32 v[206:207], v[206:207], v[196:197], v[192:193] op_sel_hi:[1,0,0] neg_lo:[0,0,1] neg_hi:[0,0,1]
    v_pk_fma_f32 v[208:209], v[208:209], v[196:197], v[192:193] op_sel_hi:[1,0,0] neg_lo:[0,0,1] neg_hi:[0,0,1]
    v_cvt_pk_bf16_f32 v168, v206, v207
    v_cvt_pk_bf16_f32 v169, v208, v209
    v_lshlrev_b32 v206, 16, v170
    v_and_b32 v207, s61, v170
    v_lshlrev_b32 v208, 16, v171
    v_and_b32 v209, s61, v171
    v_pk_fma_f32 v[206:207], v[206:207], v[196:197], v[192:193] op_sel_hi:[1,0,0] neg_lo:[0,0,1] neg_hi:[0,0,1]
    v_pk_fma_f32 v[208:209], v[208:209], v[196:197], v[192:193] op_sel_hi:[1,0,0] neg_lo:[0,0,1] neg_hi:[0,0,1]
    v_cvt_pk_bf16_f32 v170, v206, v207
    v_cvt_pk_bf16_f32 v171, v208, v209
    ds_write_b128 v222, v[168:171]
    buffer_load_dwordx4 v20, s[28:31], s65 offen offset:2048 lds
    v_lshlrev_b32 v206, 16, v172
    v_and_b32 v207, s61, v172
    v_lshlrev_b32 v208, 16, v173
    v_and_b32 v209, s61, v173
    v_pk_fma_f32 v[206:207], v[206:207], v[196:197], v[192:193] op_sel_hi:[1,0,0] neg_lo:[0,0,1] neg_hi:[0,0,1]
    v_pk_fma_f32 v[208:209], v[208:209], v[196:197], v[192:193] op_sel_hi:[1,0,0] neg_lo:[0,0,1] neg_hi:[0,0,1]
    v_cvt_pk_bf16_f32 v172, v206, v207
    v_cvt_pk_bf16_f32 v173, v208, v209
    v_lshlrev_b32 v206, 16, v174
    v_and_b32 v207, s61, v174
    v_lshlrev_b32 v208, 16, v175
    v_and_b32 v209, s61, v175
    v_pk_fma_f32 v[206:207], v[206:207], v[196:197], v[192:193] op_sel_hi:[1,0,0] neg_lo:[0,0,1] neg_hi:[0,0,1]
    v_pk_fma_f32 v[208:209], v[208:209], v[196:197], v[192:193] op_sel_hi:[1,0,0] neg_lo:[0,0,1] neg_hi:[0,0,1]
    v_cvt_pk_bf16_f32 v174, v206, v207
    v_cvt_pk_bf16_f32 v175, v208, v209
    ds_write_b128 v223, v[172:175]
    buffer_load_dwordx4 v21, s[28:31], s65 offen offset:3072 lds
    v_lshlrev_b32 v206, 16, v176
    v_and_b32 v207, s61, v176
    v_lshlrev_b32 v208, 16, v177
    v_and_b32 v209, s61, v177
    v_pk_fma_f32 v[206:207], v[206:207], v[196:197], v[192:193] op_sel_hi:[1,0,0] neg_lo:[0,0,1] neg_hi:[0,0,1]
    v_pk_fma_f32 v[208:209], v[208:209], v[196:197], v[192:193] op_sel_hi:[1,0,0] neg_lo:[0,0,1] neg_hi:[0,0,1]
    v_cvt_pk_bf16_f32 v176, v206, v207
    v_cvt_pk_bf16_f32 v177, v208, v209
    v_lshlrev_b32 v206, 16, v178
    v_and_b32 v207, s61, v178
    v_lshlrev_b32 v208, 16, v179
    v_and_b32 v209, s61, v179
    v_pk_fma_f32 v[206:207], v[206:207], v[196:197], v[192:193] op_sel_hi:[1,0,0] neg_lo:[0,0,1] neg_hi:[0,0,1]
    v_pk_fma_f32 v[208:209], v[208:209], v[196:197], v[192:193] op_sel_hi:[1,0,0] neg_lo:[0,0,1] neg_hi:[0,0,1]
    v_cvt_pk_bf16_f32 v178, v206, v207
    v_cvt_pk_bf16_f32 v179, v208, v209
    ds_write_b128 v224, v[176:179]
    v_lshlrev_b32 v206, 16, v180
    v_and_b32 v207, s61, v180
    v_lshlrev_b32 v208, 16, v181
    v_and_b32 v209, s61, v181
    v_pk_fma_f32 v[206:207], v[206:207], v[196:197], v[192:193] op_sel_hi:[1,0,0] neg_lo:[0,0,1] neg_hi:[0,0,1]
    v_pk_fma_f32 v[208:209], v[208:209], v[196:197], v[192:193] op_sel_hi:[1,0,0] neg_lo:[0,0,1] neg_hi:[0,0,1]
    v_cvt_pk_bf16_f32 v180, v206, v207
    v_cvt_pk_bf16_f32 v181, v208, v209
    v_lshlrev_b32 v206, 16, v182
    v_and_b32 v207, s61, v182
    v_lshlrev_b32 v208, 16, v183
    v_and_b32 v209, s61, v183
    v_pk_fma_f32 v[206:207], v[206:207], v[196:197], v[192:193] op_sel_hi:[1,0,0] neg_lo:[0,0,1] neg_hi:[0,0,1]
    v_pk_fma_f32 v[208:209], v[208:209], v[196:197], v[192:193] op_sel_hi:[1,0,0] neg_lo:[0,0,1] neg_hi:[0,0,1]
    v_cvt_pk_bf16_f32 v182, v206, v207
    v_cvt_pk_bf16_f32 v183, v208, v209
    ds_write_b128 v225, v[180:183]
    v_lshlrev_b32 v206, 16, v184
    v_and_b32 v207, s61, v184
    v_lshlrev_b32 v208, 16, v185
    v_and_b32 v209, s61, v185
    v_pk_fma_f32 v[206:207], v[206:207], v[196:197], v[192:193] op_sel_hi:[1,0,0] neg_lo:[0,0,1] neg_hi:[0,0,1]
    v_pk_fma_f32 v[208:209], v[208:209], v[196:197], v[192:193] op_sel_hi:[1,0,0] neg_lo:[0,0,1] neg_hi:[0,0,1]
    v_cvt_pk_bf16_f32 v184, v206, v207
    v_cvt_pk_bf16_f32 v185, v208, v209
    v_lshlrev_b32 v206, 16, v186
    v_and_b32 v207, s61, v186
    v_lshlrev_b32 v208, 16, v187
    v_and_b32 v209, s61, v187
    v_pk_fma_f32 v[206:207], v[206:207], v[196:197], v[192:193] op_sel_hi:[1,0,0] neg_lo:[0,0,1] neg_hi:[0,0,1]
    v_pk_fma_f32 v[208:209], v[208:209], v[196:197], v[192:193] op_sel_hi:[1,0,0] neg_lo:[0,0,1] neg_hi:[0,0,1]
    v_cvt_pk_bf16_f32 v186, v206, v207
    v_cvt_pk_bf16_f32 v187, v208, v209
    ds_write_b128 v226, v[184:187]
    v_lshlrev_b32 v206, 16, v188
    v_and_b32 v207, s61, v188
    v_lshlrev_b32 v208, 16, v189
    v_and_b32 v209, s61, v189
    v_pk_fma_f32 v[206:207], v[206:207], v[196:197], v[192:193] op_sel_hi:[1,0,0] neg_lo:[0,0,1] neg_hi:[0,0,1]
    v_pk_fma_f32 v[208:209], v[208:209], v[196:197], v[192:193] op_sel_hi:[1,0,0] neg_lo:[0,0,1] neg_hi:[0,0,1]
    v_cvt_pk_bf16_f32 v188, v206, v207
    v_cvt_pk_bf16_f32 v189, v208, v209
    v_lshlrev_b32 v206, 16, v190
    v_and_b32 v207, s61, v190
    v_lshlrev_b32 v208, 16, v191
    v_and_b32 v209, s61, v191
    v_pk_fma_f32 v[206:207], v[206:207], v[196:197], v[192:193] op_sel_hi:[1,0,0] neg_lo:[0,0,1] neg_hi:[0,0,1]
    v_pk_fma_f32 v[208:209], v[208:209], v[196:197], v[192:193] op_sel_hi:[1,0,0] neg_lo:[0,0,1] neg_hi:[0,0,1]
    v_cvt_pk_bf16_f32 v190, v206, v207
    v_cvt_pk_bf16_f32 v191, v208, v209
    ds_write_b128 v227, v[188:191]
    global_load_dword a97, v210, s[8:9]
    s_waitcnt lgkmcnt(0)
    s_barrier
    s_waitcnt vmcnt(13)
    ds_read_b128 a[16:19], v1 offset:0
    ds_read_b128 a[20:23], v1 offset:1024
    ds_read_b128 a[24:27], v1 offset:2048
    ds_read_b128 a[28:31], v1 offset:3072
    ds_read_b64_tr_b16 a[0:1], v10 offset:0
    ds_read_b64_tr_b16 a[2:3], v10 offset:512
    ds_read_b64_tr_b16 a[4:5], v11 offset:0
    ds_read_b64_tr_b16 a[6:7], v11 offset:512
    s_waitcnt lgkmcnt(0)
    v_mfma_f32_16x16x32_bf16 v[128:131], a[0:3], a[16:19], 0
    s_add_u32 m0, s45, 16384
    ds_read_b64_tr_b16 a[8:9], v12 offset:0
    ds_read_b64_tr_b16 a[10:11], v12 offset:512
    v_mfma_f32_16x16x32_bf16 v[144:147], a[4:7], a[16:19], 0
    buffer_load_dwordx4 v18, s[24:27], s64 offen offset:0 lds
    s_mul_i32 s51, s41, 37
    v_mfma_f32_16x16x32_bf16 v[132:135], a[0:3], a[20:23], 0
    s_add_u32 s65, s65, 229376
    ds_read_b64_tr_b16 a[12:13], v13 offset:0
    ds_read_b64_tr_b16 a[14:15], v13 offset:512
    v_mfma_f32_16x16x32_bf16 v[148:151], a[4:7], a[20:23], 0
    buffer_load_dwordx4 v19, s[24:27], s64 offen offset:1024 lds
    s_lshr_b32 s51, s51, 8
    v_mfma_f32_16x16x32_bf16 v[136:139], a[0:3], a[24:27], 0
    s_sub_u32 s48, s65, 1835008
    ds_read_b128 a[32:35], v1 offset:4096
    s_mul_i32 s51, s51, 7
    v_mfma_f32_16x16x32_bf16 v[152:155], a[4:7], a[24:27], 0
    buffer_load_dwordx4 v20, s[24:27], s64 offen offset:2048 lds
    s_sub_u32 s44, s41, s51
    v_mfma_f32_16x16x32_bf16 v[140:143], a[0:3], a[28:31], 0
    buffer_load_dwordx4 v21, s[24:27], s64 offen offset:3072 lds
    s_lshl_b32 s51, s40, 10
    v_mfma_f32_16x16x32_bf16 v[156:159], a[4:7], a[28:31], 0
    s_waitcnt vmcnt(13) lgkmcnt(1)
    s_lshl_b32 s53, s42, 8
    s_add_u32 s51, s51, s53
    s_min_u32 s65, s65, s48
    v_mfma_f32_16x16x32_bf16 v[160:163], a[8:11], a[16:19], 0
    s_add_u32 m0, s45, 20480
    ds_read_b64_tr_b16 a[0:1], v10 offset:4096
    ds_read_b64_tr_b16 a[2:3], v10 offset:4608
    v_mfma_f32_16x16x32_bf16 v[176:179], a[12:15], a[16:19], 0
    buffer_load_dwordx4 v18, s[28:31], s64 offen offset:0 lds
    s_add_u32 s16, s70, s51
    s_addc_u32 s17, s71, 0
    v_mfma_f32_16x16x32_bf16 v[164:167], a[8:11], a[20:23], 0
    ds_read_b64_tr_b16 a[4:5], v11 offset:4096
    ds_read_b64_tr_b16 a[6:7], v11 offset:4608
    v_mfma_f32_16x16x32_bf16 v[180:183], a[12:15], a[20:23], 0
    buffer_load_dwordx4 v19, s[28:31], s64 offen offset:1024 lds
    s_sub_u32 s18, 4194304, s51
    v_mfma_f32_16x16x32_bf16 v[168:171], a[8:11], a[24:27], 0
    ds_read_b128 a[36:39], v1 offset:5120
    s_mov_b32 s19, 0x20000
    v_mfma_f32_16x16x32_bf16 v[184:187], a[12:15], a[24:27], 0
    buffer_load_dwordx4 v20, s[28:31], s64 offen offset:2048 lds
    s_lshl_b32 s51, s40, 19
    v_mfma_f32_16x16x32_bf16 v[172:175], a[8:11], a[28:31], 0
    buffer_load_dwordx4 v21, s[28:31], s64 offen offset:3072 lds
    s_add_u32 s51, s51, s53
    v_mfma_f32_16x16x32_bf16 v[188:191], a[12:15], a[28:31], 0
    s_waitcnt lgkmcnt(1)
    v_mfma_f32_16x16x32_bf16 v[192:195], a[0:3], a[16:19], 0
    s_add_u32 m0, s45, 0
    ds_read_b64_tr_b16 a[8:9], v12 offset:4096
    ds_read_b64_tr_b16 a[10:11], v12 offset:4608
    v_mfma_f32_16x16x32_bf16 v[208:211], a[4:7], a[16:19], 0
    buffer_load_dwordx4 v18, s[24:27], s65 offen offset:0 lds
    s_add_u32 s20, s72, s51
    s_addc_u32 s21, s73, 0
    v_mfma_f32_16x16x32_bf16 v[196:199], a[0:3], a[20:23], 0
    s_add_u32 s64, s64, 229376
    ds_read_b64_tr_b16 a[12:13], v13 offset:4096
    ds_read_b64_tr_b16 a[14:15], v13 offset:4608
    v_mfma_f32_16x16x32_bf16 v[212:215], a[4:7], a[20:23], 0
    s_sub_u32 s48, s64, 1835008
    s_sub_u32 s22, 4194304, s51
    s_mov_b32 s23, 0x20000
    v_mfma_f32_16x16x32_bf16 v[200:203], a[0:3], a[24:27], 0
    s_min_u32 s64, s64, s48
    ds_read_b128 a[40:43], v1 offset:6144
    s_mul_i32 s51, s40, 229376
    v_mfma_f32_16x16x32_bf16 v[216:219], a[4:7], a[24:27], 0
    buffer_load_dwordx4 v19, s[24:27], s65 offen offset:1024 lds
    s_add_u32 s51, s51, s53
    v_mfma_f32_16x16x32_bf16 v[204:207], a[0:3], a[28:31], 0
    s_add_u32 s32, s80, s51
    s_addc_u32 s33, s81, 0
    v_mfma_f32_16x16x32_bf16 v[220:223], a[4:7], a[28:31], 0
    s_waitcnt vmcnt(15) lgkmcnt(1)
    v_mfma_f32_16x16x32_bf16 v[224:227], a[8:11], a[16:19], 0
    ds_read_b64_tr_b16 a[0:1], v10 offset:8192
    ds_read_b64_tr_b16 a[2:3], v10 offset:8704
    v_mfma_f32_16x16x32_bf16 v[240:243], a[12:15], a[16:19], 0
    buffer_load_dwordx4 v20, s[24:27], s65 offen offset:2048 lds
    s_sub_u32 s34, 1835008, s51
    v_mfma_f32_16x16x32_bf16 v[228:231], a[8:11], a[20:23], 0
    ds_read_b64_tr_b16 a[4:5], v11 offset:8192
    ds_read_b64_tr_b16 a[6:7], v11 offset:8704
    v_mfma_f32_16x16x32_bf16 v[244:247], a[12:15], a[20:23], 0
    s_mov_b32 s35, 0x20000
    v_mfma_f32_16x16x32_bf16 v[232:235], a[8:11], a[24:27], 0
    ds_read_b128 a[44:47], v1 offset:7168
    s_lshl_b32 s51, s40, 19
    v_mfma_f32_16x16x32_bf16 v[248:251], a[12:15], a[24:27], 0
    buffer_load_dwordx4 v21, s[24:27], s65 offen offset:3072 lds
    s_add_u32 s8, s66, s51
    s_addc_u32 s9, s67, 0
    v_mfma_f32_16x16x32_bf16 v[236:239], a[8:11], a[28:31], 0
    v_mfma_f32_16x16x32_bf16 v[252:255], a[12:15], a[28:31], 0
    s_waitcnt lgkmcnt(0)
    v_mfma_f32_16x16x32_bf16 v[128:131], a[0:3], a[32:35], v[128:131]
    s_add_u32 m0, s45, 4096
    ds_read_b64_tr_b16 a[8:9], v12 offset:8192
    ds_read_b64_tr_b16 a[10:11], v12 offset:8704
    v_mfma_f32_16x16x32_bf16 v[144:147], a[4:7], a[32:35], v[144:147]
    buffer_load_dwordx4 v18, s[28:31], s65 offen offset:0 lds
    s_sub_u32 s10, 4194304, s51
    v_mfma_f32_16x16x32_bf16 v[132:135], a[0:3], a[36:39], v[132:135]
    ds_read_b64_tr_b16 a[12:13], v13 offset:8192
    ds_read_b64_tr_b16 a[14:15], v13 offset:8704
    v_mfma_f32_16x16x32_bf16 v[148:151], a[4:7], a[36:39], v[148:151]
    s_mov_b32 s11, 0x20000
    s_add_u32 s12, s68, s51
    s_addc_u32 s13, s69, 0
    v_mfma_f32_16x16x32_bf16 v[136:139], a[0:3], a[40:43], v[136:139]
    ds_read_b128 a[48:51], v1 offset:8192
    s_sub_u32 s14, 4194304, s51
    v_mfma_f32_16x16x32_bf16 v[152:155], a[4:7], a[40:43], v[152:155]
    buffer_load_dwordx4 v19, s[28:31], s65 offen offset:1024 lds
    s_mov_b32 s15, 0x20000
    v_mfma_f32_16x16x32_bf16 v[140:143], a[0:3], a[44:47], v[140:143]
    s_mov_b32 s10, 524288
    v_mfma_f32_16x16x32_bf16 v[156:159], a[4:7], a[44:47], v[156:159]
    s_waitcnt vmcnt(15) lgkmcnt(1)
    v_mfma_f32_16x16x32_bf16 v[160:163], a[8:11], a[32:35], v[160:163]
    ds_read_b64_tr_b16 a[0:1], v10 offset:12288
    ds_read_b64_tr_b16 a[2:3], v10 offset:12800
    v_mfma_f32_16x16x32_bf16 v[176:179], a[12:15], a[32:35], v[176:179]
    buffer_load_dwordx4 v20, s[28:31], s65 offen offset:2048 lds
    s_mov_b32 s14, 524288
    v_mfma_f32_16x16x32_bf16 v[164:167], a[8:11], a[36:39], v[164:167]
    ds_read_b64_tr_b16 a[4:5], v11 offset:12288
    ds_read_b64_tr_b16 a[6:7], v11 offset:12800
    v_mfma_f32_16x16x32_bf16 v[180:183], a[12:15], a[36:39], v[180:183]
    s_lshl_b32 s51, s40, 5
    s_add_u32 s51, s51, s41
    v_mfma_f32_16x16x32_bf16 v[168:171], a[8:11], a[40:43], v[168:171]
    ds_read_b128 a[52:55], v1 offset:9216
    s_lshl_b32 s51, s51, 2
    v_mfma_f32_16x16x32_bf16 v[184:187], a[12:15], a[40:43], v[184:187]
    buffer_load_dwordx4 v21, s[28:31], s65 offen offset:3072 lds
    s_add_u32 s51, s51, s42
    v_mfma_f32_16x16x32_bf16 v[172:175], a[8:11], a[44:47], v[172:175]
    s_lshl_b32 s51, s51, 14
    v_mfma_f32_16x16x32_bf16 v[188:191], a[12:15], a[44:47], v[188:191]
    s_waitcnt lgkmcnt(1)
    v_mfma_f32_16x16x32_bf16 v[192:195], a[0:3], a[32:35], v[192:195]
    s_add_u32 m0, s45, 8192
    ds_read_b64_tr_b16 a[8:9], v12 offset:12288
    ds_read_b64_tr_b16 a[10:11], v12 offset:12800
    v_mfma_f32_16x16x32_bf16 v[208:211], a[4:7], a[32:35], v[208:211]
    buffer_load_dwordx4 v18, s[24:27], s64 offen offset:0 lds
    s_add_u32 s36, s86, s51
    s_addc_u32 s37, s87, 0
    v_mfma_f32_16x16x32_bf16 v[196:199], a[0:3], a[36:39], v[196:199]
    s_add_u32 s65, s65, 229376
    ds_read_b64_tr_b16 a[12:13], v13 offset:12288
    ds_read_b64_tr_b16 a[14:15], v13 offset:12800
    v_mfma_f32_16x16x32_bf16 v[212:215], a[4:7], a[36:39], v[212:215]
    s_sub_u32 s48, s65, 1835008
    s_sub_u32 s38, 33554432, s51
    s_mov_b32 s39, 0x20000
    v_mfma_f32_16x16x32_bf16 v[200:203], a[0:3], a[40:43], v[200:203]
    s_min_u32 s65, s65, s48
    ds_read_b128 a[56:59], v1 offset:10240
    s_or_b32 s74, s60, 1
    v_mfma_f32_16x16x32_bf16 v[216:219], a[4:7], a[40:43], v[216:219]
    buffer_load_dwordx4 v19, s[24:27], s64 offen offset:1024 lds
    s_mul_i32 s66, s43, 262144
    v_mfma_f32_16x16x32_bf16 v[204:207], a[0:3], a[44:47], v[204:207]
    s_add_u32 s67, s66, 262144
    v_mfma_f32_16x16x32_bf16 v[220:223], a[4:7], a[44:47], v[220:223]
    s_waitcnt vmcnt(14) lgkmcnt(1)
    v_mfma_f32_16x16x32_bf16 v[224:227], a[8:11], a[32:35], v[224:227]
    ds_read_b64_tr_b16 a[0:1], v10 offset:16384
    ds_read_b64_tr_b16 a[2:3], v10 offset:16896
    v_mfma_f32_16x16x32_bf16 v[240:243], a[12:15], a[32:35], v[240:243]
    buffer_load_dwordx4 v20, s[24:27], s64 offen offset:2048 lds
    s_sub_u32 s52, s67, 4194304
    v_mfma_f32_16x16x32_bf16 v[228:231], a[8:11], a[36:39], v[228:231]
    ds_read_b64_tr_b16 a[4:5], v11 offset:16384
    ds_read_b64_tr_b16 a[6:7], v11 offset:16896
    v_mfma_f32_16x16x32_bf16 v[244:247], a[12:15], a[36:39], v[244:247]
    s_min_u32 s67, s67, s52
    s_mul_i32 s68, s44, 32768
    v_mfma_f32_16x16x32_bf16 v[232:235], a[8:11], a[40:43], v[232:235]
    ds_read_b128 a[60:63], v1 offset:11264
    s_add_u32 s69, s68, 32768
    v_mfma_f32_16x16x32_bf16 v[248:251], a[12:15], a[40:43], v[248:251]
    buffer_load_dwordx4 v21, s[24:27], s64 offen offset:3072 lds
    s_sub_u32 s52, s69, 229376
    v_mfma_f32_16x16x32_bf16 v[236:239], a[8:11], a[44:47], v[236:239]
    s_min_u32 s69, s69, s52
    v_mfma_f32_16x16x32_bf16 v[252:255], a[12:15], a[44:47], v[252:255]
    s_waitcnt lgkmcnt(0)
    v_mfma_f32_16x16x32_bf16 v[128:131], a[0:3], a[48:51], v[128:131]
    s_add_u32 m0, s45, 12288
    ds_read_b64_tr_b16 a[8:9], v12 offset:16384
    ds_read_b64_tr_b16 a[10:11], v12 offset:16896
    v_mfma_f32_16x16x32_bf16 v[144:147], a[4:7], a[48:51], v[144:147]
    buffer_load_dwordx4 v18, s[28:31], s64 offen offset:0 lds
    s_and_b32 s51, s40, 4
    v_mfma_f32_16x16x32_bf16 v[132:135], a[0:3], a[52:55], v[132:135]
    ds_read_b64_tr_b16 a[12:13], v13 offset:16384
    ds_read_b64_tr_b16 a[14:15], v13 offset:16896
    v_mfma_f32_16x16x32_bf16 v[148:151], a[4:7], a[52:55], v[148:151]
    s_xor_b32 s51, s51, 4
    s_lshl_b32 s51, s51, 5
    v_mfma_f32_16x16x32_bf16 v[136:139], a[0:3], a[56:59], v[136:139]
    ds_read_b128 a[64:67], v1 offset:12288
    s_add_u32 s70, s43, 0
    v_mfma_f32_16x16x32_bf16 v[152:155], a[4:7], a[56:59], v[152:155]
    buffer_load_dwordx4 v19, s[28:31], s64 offen offset:1024 lds
    s_and_b32 s70, s70, 3
    v_mfma_f32_16x16x32_bf16 v[140:143], a[0:3], a[60:63], v[140:143]
    s_lshl_b32 s70, s70, 17
    s_add_u32 s70, s70, s51
    v_mfma_f32_16x16x32_bf16 v[156:159], a[4:7], a[60:63], v[156:159]
    s_waitcnt vmcnt(14) lgkmcnt(1)
    v_mfma_f32_16x16x32_bf16 v[160:163], a[8:11], a[48:51], v[160:163]
    ds_read_b64_tr_b16 a[0:1], v10 offset:20480
    ds_read_b64_tr_b16 a[2:3], v10 offset:20992
    v_mfma_f32_16x16x32_bf16 v[176:179], a[12:15], a[48:51], v[176:179]
    buffer_load_dwordx4 v20, s[28:31], s64 offen offset:2048 lds
    s_add_u32 s71, s43, 1
    v_mfma_f32_16x16x32_bf16 v[164:167], a[8:11], a[52:55], v[164:167]
    ds_read_b64_tr_b16 a[4:5], v11 offset:20480
    ds_read_b64_tr_b16 a[6:7], v11 offset:20992
    v_mfma_f32_16x16x32_bf16 v[180:183], a[12:15], a[52:55], v[180:183]
    s_and_b32 s71, s71, 3
    s_lshl_b32 s71, s71, 17
    v_mfma_f32_16x16x32_bf16 v[168:171], a[8:11], a[56:59], v[168:171]
    ds_read_b128 a[68:71], v1 offset:13312
    s_add_u32 s71, s71, s51
    v_mfma_f32_16x16x32_bf16 v[184:187], a[12:15], a[56:59], v[184:187]
    buffer_load_dwordx4 v21, s[28:31], s64 offen offset:3072 lds
    s_add_u32 s72, s43, 2
    v_mfma_f32_16x16x32_bf16 v[172:175], a[8:11], a[60:63], v[172:175]
    s_and_b32 s72, s72, 3
    v_mfma_f32_16x16x32_bf16 v[188:191], a[12:15], a[60:63], v[188:191]
    s_waitcnt lgkmcnt(1)
    v_mfma_f32_16x16x32_bf16 v[192:195], a[0:3], a[48:51], v[192:195]
    s_add_u32 m0, s45, 16384
    ds_read_b64_tr_b16 a[8:9], v12 offset:20480
    ds_read_b64_tr_b16 a[10:11], v12 offset:20992
    v_mfma_f32_16x16x32_bf16 v[208:211], a[4:7], a[48:51], v[208:211]
    buffer_load_dwordx4 v18, s[24:27], s65 offen offset:0 lds
    s_lshl_b32 s72, s72, 17
    v_mfma_f32_16x16x32_bf16 v[196:199], a[0:3], a[52:55], v[196:199]
    s_add_u32 s64, s64, 229376
    ds_read_b64_tr_b16 a[12:13], v13 offset:20480
    ds_read_b64_tr_b16 a[14:15], v13 offset:20992
    v_mfma_f32_16x16x32_bf16 v[212:215], a[4:7], a[52:55], v[212:215]
    s_sub_u32 s48, s64, 1835008
    s_add_u32 s72, s72, s51
    s_add_u32 s73, s43, 3
    v_mfma_f32_16x16x32_bf16 v[200:203], a[0:3], a[56:59], v[200:203]
    s_min_u32 s64, s64, s48
    ds_read_b128 a[72:75], v1 offset:14336
    s_and_b32 s73, s73, 3
    v_mfma_f32_16x16x32_bf16 v[216:219], a[4:7], a[56:59], v[216:219]
    buffer_load_dwordx4 v19, s[24:27], s65 offen offset:1024 lds
    s_lshl_b32 s73, s73, 17
    v_mfma_f32_16x16x32_bf16 v[204:207], a[0:3], a[60:63], v[204:207]
    s_add_u32 s73, s73, s51
    v_lshrrev_b32 v6, 3, v0
    v_mfma_f32_16x16x32_bf16 v[220:223], a[4:7], a[60:63], v[220:223]
    s_waitcnt vmcnt(14) lgkmcnt(1)
    v_mfma_f32_16x16x32_bf16 v[224:227], a[8:11], a[48:51], v[224:227]
    ds_read_b64_tr_b16 a[0:1], v10 offset:0
    ds_read_b64_tr_b16 a[2:3], v10 offset:512
    v_mfma_f32_16x16x32_bf16 v[240:243], a[12:15], a[48:51], v[240:243]
    buffer_load_dwordx4 v20, s[24:27], s65 offen offset:2048 lds
    v_and_b32 v8, 7, v0
    v_mfma_f32_16x16x32_bf16 v[228:231], a[8:11], a[52:55], v[228:231]
    ds_read_b64_tr_b16 a[4:5], v11 offset:0
    ds_read_b64_tr_b16 a[6:7], v11 offset:512
    v_mfma_f32_16x16x32_bf16 v[244:247], a[12:15], a[52:55], v[244:247]
    v_and_b32 v7, 1, v3
    v_lshlrev_b32 v7, 1, v7
    v_mfma_f32_16x16x32_bf16 v[232:235], a[8:11], a[56:59], v[232:235]
    ds_read_b128 a[76:79], v1 offset:15360
    v_xor_b32 v7, v7, v8
    v_mfma_f32_16x16x32_bf16 v[248:251], a[12:15], a[56:59], v[248:251]
    buffer_load_dwordx4 v21, s[24:27], s65 offen offset:3072 lds
    v_lshlrev_b32 v9, 1, v3
    v_mfma_f32_16x16x32_bf16 v[236:239], a[8:11], a[60:63], v[236:239]
    v_xor_b32 v8, v9, v8
    v_mfma_f32_16x16x32_bf16 v[252:255], a[12:15], a[60:63], v[252:255]
    s_waitcnt lgkmcnt(0)
    v_mfma_f32_16x16x32_bf16 v[128:131], a[0:3], a[64:67], v[128:131]
    s_add_u32 m0, s45, 20480
    ds_read_b64_tr_b16 a[8:9], v12 offset:0
    ds_read_b64_tr_b16 a[10:11], v12 offset:512
    v_mfma_f32_16x16x32_bf16 v[144:147], a[4:7], a[64:67], v[144:147]
    buffer_load_dwordx4 v18, s[28:31], s65 offen offset:0 lds
    v_mul_u32_u24 v9, 8192, v6
    v_mfma_f32_16x16x32_bf16 v[132:135], a[0:3], a[68:71], v[132:135]
    ds_read_b64_tr_b16 a[12:13], v13 offset:0
    ds_read_b64_tr_b16 a[14:15], v13 offset:512
    v_mfma_f32_16x16x32_bf16 v[148:151], a[4:7], a[68:71], v[148:151]
    v_xor_b32 v22, 0, v7
    v_lshl_add_u32 v22, v22, 4, v9
    v_mfma_f32_16x16x32_bf16 v[136:139], a[0:3], a[72:75], v[136:139]
    ds_read_b128 a[16:19], v1 offset:16384
    v_xor_b32 v23, 4, v7
    v_mfma_f32_16x16x32_bf16 v[152:155], a[4:7], a[72:75], v[152:155]
    buffer_load_dwordx4 v19, s[28:31], s65 offen offset:1024 lds
    v_lshl_add_u32 v23, v23, 4, v9
    v_mfma_f32_16x16x32_bf16 v[140:143], a[0:3], a[76:79], v[140:143]
    v_add_u32 v23, 64512, v23
    v_xor_b32 v24, 0, v7
    v_mfma_f32_16x16x32_bf16 v[156:159], a[4:7], a[76:79], v[156:159]
    s_waitcnt vmcnt(14) lgkmcnt(1)
    v_mfma_f32_16x16x32_bf16 v[160:163], a[8:11], a[64:67], v[160:163]
    ds_read_b64_tr_b16 a[0:1], v10 offset:4096
    ds_read_b64_tr_b16 a[2:3], v10 offset:4608
    v_mfma_f32_16x16x32_bf16 v[176:179], a[12:15], a[64:67], v[176:179]
    buffer_load_dwordx4 v20, s[28:31], s65 offen offset:2048 lds
    v_lshl_add_u32 v24, v24, 4, v9
    v_mfma_f32_16x16x32_bf16 v[164:167], a[8:11], a[68:71], v[164:167]
    ds_read_b64_tr_b16 a[4:5], v11 offset:4096
    ds_read_b64_tr_b16 a[6:7], v11 offset:4608
    v_mfma_f32_16x16x32_bf16 v[180:183], a[12:15], a[68:71], v[180:183]
    v_add_u32 v24, 129024, v24
    v_xor_b32 v25, 4, v7
    v_mfma_f32_16x16x32_bf16 v[168:171], a[8:11], a[72:75], v[168:171]
    ds_read_b128 a[20:23], v1 offset:17408
    v_lshl_add_u32 v25, v25, 4, v9
    v_mfma_f32_16x16x32_bf16 v[184:187], a[12:15], a[72:75], v[184:187]
    buffer_load_dwordx4 v21, s[28:31], s65 offen offset:3072 lds
    v_add_u32 v25, 193536, v25
    v_mfma_f32_16x16x32_bf16 v[172:175], a[8:11], a[76:79], v[172:175]
    v_mul_u32_u24 v9, 1024, v6
    v_mfma_f32_16x16x32_bf16 v[188:191], a[12:15], a[76:79], v[188:191]
    s_waitcnt lgkmcnt(1)
    v_mfma_f32_16x16x32_bf16 v[192:195], a[0:3], a[64:67], v[192:195]
    s_add_u32 m0, s45, 0
    ds_read_b64_tr_b16 a[8:9], v12 offset:4096
    ds_read_b64_tr_b16 a[10:11], v12 offset:4608
    v_mfma_f32_16x16x32_bf16 v[208:211], a[4:7], a[64:67], v[208:211]
    buffer_load_dwordx4 v18, s[24:27], s64 offen offset:0 lds
    v_mov_b32 v26, v8
    v_mfma_f32_16x16x32_bf16 v[196:199], a[0:3], a[68:71], v[196:199]
    s_add_u32 s65, s65, 229376
    ds_read_b64_tr_b16 a[12:13], v13 offset:4096
    ds_read_b64_tr_b16 a[14:15], v13 offset:4608
    v_mfma_f32_16x16x32_bf16 v[212:215], a[4:7], a[68:71], v[212:215]
    s_sub_u32 s48, s65, 1835008
    v_lshl_add_u32 v26, v26, 4, v9
    v_mov_b32 v27, v8
    v_mfma_f32_16x16x32_bf16 v[200:203], a[0:3], a[72:75], v[200:203]
    s_min_u32 s65, s65, s48
    ds_read_b128 a[24:27], v1 offset:18432
    v_lshl_add_u32 v27, v27, 4, v9
    v_mfma_f32_16x16x32_bf16 v[216:219], a[4:7], a[72:75], v[216:219]
    buffer_load_dwordx4 v19, s[24:27], s64 offen offset:1024 lds
    v_add_u32 v27, 7168, v27
    v_mfma_f32_16x16x32_bf16 v[204:207], a[0:3], a[76:79], v[204:207]
    v_mov_b32 v28, v8
    v_lshl_add_u32 v28, v28, 4, v9
    v_mfma_f32_16x16x32_bf16 v[220:223], a[4:7], a[76:79], v[220:223]
    s_waitcnt vmcnt(14) lgkmcnt(1)
    v_mfma_f32_16x16x32_bf16 v[224:227], a[8:11], a[64:67], v[224:227]
    ds_read_b64_tr_b16 a[0:1], v10 offset:8192
    ds_read_b64_tr_b16 a[2:3], v10 offset:8704
    v_mfma_f32_16x16x32_bf16 v[240:243], a[12:15], a[64:67], v[240:243]
    buffer_load_dwordx4 v20, s[24:27], s64 offen offset:2048 lds
    v_add_u32 v28, 14336, v28
    v_mfma_f32_16x16x32_bf16 v[228:231], a[8:11], a[68:71], v[228:231]
    ds_read_b64_tr_b16 a[4:5], v11 offset:8192
    ds_read_b64_tr_b16 a[6:7], v11 offset:8704
    v_mfma_f32_16x16x32_bf16 v[244:247], a[12:15], a[68:71], v[244:247]
    v_mov_b32 v29, v8
    v_lshl_add_u32 v29, v29, 4, v9
    v_mfma_f32_16x16x32_bf16 v[232:235], a[8:11], a[72:75], v[232:235]
    ds_read_b128 a[28:31], v1 offset:19456
    v_add_u32 v29, 21504, v29
    v_mfma_f32_16x16x32_bf16 v[248:251], a[12:15], a[72:75], v[248:251]
    buffer_load_dwordx4 v21, s[24:27], s64 offen offset:3072 lds
    v_lshlrev_b32 v6, 9, v3
    v_mfma_f32_16x16x32_bf16 v[236:239], a[8:11], a[76:79], v[236:239]
    v_and_b32 v7, 1, v3
    v_mfma_f32_16x16x32_bf16 v[252:255], a[12:15], a[76:79], v[252:255]
    s_waitcnt lgkmcnt(0)
    v_mfma_f32_16x16x32_bf16 v[128:131], a[0:3], a[16:19], v[128:131]
    s_add_u32 m0, s45, 4096
    ds_read_b64_tr_b16 a[8:9], v12 offset:8192
    ds_read_b64_tr_b16 a[10:11], v12 offset:8704
    v_mfma_f32_16x16x32_bf16 v[144:147], a[4:7], a[16:19], v[144:147]
    buffer_load_dwordx4 v18, s[28:31], s64 offen offset:0 lds
    v_sub_u32 v14, v10, v6
    v_mfma_f32_16x16x32_bf16 v[132:135], a[0:3], a[20:23], v[132:135]
    ds_read_b64_tr_b16 a[12:13], v13 offset:8192
    ds_read_b64_tr_b16 a[14:15], v13 offset:8704
    v_mfma_f32_16x16x32_bf16 v[148:151], a[4:7], a[20:23], v[148:151]
    v_sub_u32 v15, v11, v6
    v_sub_u32 v16, v12, v6
    v_mfma_f32_16x16x32_bf16 v[136:139], a[0:3], a[24:27], v[136:139]
    ds_read_b128 a[32:35], v1 offset:20480
    v_sub_u32 v17, v13, v6
    v_mfma_f32_16x16x32_bf16 v[152:155], a[4:7], a[24:27], v[152:155]
    buffer_load_dwordx4 v19, s[28:31], s64 offen offset:1024 lds
    v_lshrrev_b32 v6, 1, v3
    v_mfma_f32_16x16x32_bf16 v[140:143], a[0:3], a[28:31], v[140:143]
    v_lshl_add_u32 v6, v7, 1, v6
    v_xor_b32 v6, v6, v2
    v_mfma_f32_16x16x32_bf16 v[156:159], a[4:7], a[28:31], v[156:159]
    s_waitcnt vmcnt(14) lgkmcnt(1)
    v_mfma_f32_16x16x32_bf16 v[160:163], a[8:11], a[16:19], v[160:163]
    ds_read_b64_tr_b16 a[0:1], v10 offset:12288
    ds_read_b64_tr_b16 a[2:3], v10 offset:12800
    v_mfma_f32_16x16x32_bf16 v[176:179], a[12:15], a[16:19], v[176:179]
    buffer_load_dwordx4 v20, s[28:31], s64 offen offset:2048 lds
    v_lshlrev_b32 v6, 4, v6
    v_mfma_f32_16x16x32_bf16 v[164:167], a[8:11], a[20:23], v[164:167]
    ds_read_b64_tr_b16 a[4:5], v11 offset:12288
    ds_read_b64_tr_b16 a[6:7], v11 offset:12800
    v_mfma_f32_16x16x32_bf16 v[180:183], a[12:15], a[20:23], v[180:183]
    v_lshl_add_u32 v6, v2, 8, v6
    v_add_u32 v34, 32768, v6
    v_mfma_f32_16x16x32_bf16 v[168:171], a[8:11], a[24:27], v[168:171]
    ds_read_b128 a[36:39], v1 offset:21504
    v_xor_b32 v35, 64, v34
    v_mfma_f32_16x16x32_bf16 v[184:187], a[12:15], a[24:27], v[184:187]
    buffer_load_dwordx4 v21, s[28:31], s64 offen offset:3072 lds
    v_xor_b32 v36, 128, v34
    v_mfma_f32_16x16x32_bf16 v[172:175], a[8:11], a[28:31], v[172:175]
    v_xor_b32 v37, 192, v34
    v_mfma_f32_16x16x32_bf16 v[188:191], a[12:15], a[28:31], v[188:191]
    s_waitcnt lgkmcnt(1)
    v_mfma_f32_16x16x32_bf16 v[192:195], a[0:3], a[16:19], v[192:195]
    s_add_u32 m0, s45, 8192
    ds_read_b64_tr_b16 a[8:9], v12 offset:12288
    ds_read_b64_tr_b16 a[10:11], v12 offset:12800
    v_mfma_f32_16x16x32_bf16 v[208:211], a[4:7], a[16:19], v[208:211]
    buffer_load_dwordx4 v18, s[24:27], s65 offen offset:0 lds
    v_lshl_add_u32 v6, v7, 2, v4
    v_mfma_f32_16x16x32_bf16 v[196:199], a[0:3], a[20:23], v[196:199]
    s_add_u32 s64, s64, 229376
    ds_read_b64_tr_b16 a[12:13], v13 offset:12288
    ds_read_b64_tr_b16 a[14:15], v13 offset:12800
    v_mfma_f32_16x16x32_bf16 v[212:215], a[4:7], a[20:23], v[212:215]
    s_sub_u32 s48, s64, 1835008
    v_lshlrev_b32 v6, 5, v6
    v_lshl_add_u32 v6, v5, 3, v6
    v_mfma_f32_16x16x32_bf16 v[200:203], a[0:3], a[24:27], v[200:203]
    s_min_u32 s64, s64, s48
    ds_read_b128 a[40:43], v1 offset:22528
    v_lshl_add_u32 v8, v3, 2, v4
    v_mfma_f32_16x16x32_bf16 v[216:219], a[4:7], a[24:27], v[216:219]
    buffer_load_dwordx4 v19, s[24:27], s65 offen offset:1024 lds
    v_lshl_add_u32 v6, v8, 8, v6
    v_mfma_f32_16x16x32_bf16 v[204:207], a[0:3], a[28:31], v[204:207]
    v_add_u32 v38, 57344, v6
    v_xor_b32 v39, 32, v38
    v_mfma_f32_16x16x32_bf16 v[220:223], a[4:7], a[28:31], v[220:223]
    s_waitcnt vmcnt(14) lgkmcnt(1)
    v_mfma_f32_16x16x32_bf16 v[224:227], a[8:11], a[16:19], v[224:227]
    ds_read_b64_tr_b16 a[0:1], v10 offset:16384
    ds_read_b64_tr_b16 a[2:3], v10 offset:16896
    v_mfma_f32_16x16x32_bf16 v[240:243], a[12:15], a[16:19], v[240:243]
    buffer_load_dwordx4 v20, s[24:27], s65 offen offset:2048 lds
    v_xor_b32 v40, 64, v38
    v_mfma_f32_16x16x32_bf16 v[228:231], a[8:11], a[20:23], v[228:231]
    ds_read_b64_tr_b16 a[4:5], v11 offset:16384
    ds_read_b64_tr_b16 a[6:7], v11 offset:16896
    v_mfma_f32_16x16x32_bf16 v[244:247], a[12:15], a[20:23], v[244:247]
    v_xor_b32 v41, 96, v38
    v_xor_b32 v42, 128, v38
    v_mfma_f32_16x16x32_bf16 v[232:235], a[8:11], a[24:27], v[232:235]
    ds_read_b128 a[44:47], v1 offset:23552
    v_xor_b32 v43, 160, v38
    v_mfma_f32_16x16x32_bf16 v[248:251], a[12:15], a[24:27], v[248:251]
    buffer_load_dwordx4 v21, s[24:27], s65 offen offset:3072 lds
    v_xor_b32 v44, 192, v38
    v_mfma_f32_16x16x32_bf16 v[236:239], a[8:11], a[28:31], v[236:239]
    v_xor_b32 v45, 224, v38
    v_mfma_f32_16x16x32_bf16 v[252:255], a[12:15], a[28:31], v[252:255]
    s_waitcnt lgkmcnt(0)
    v_mfma_f32_16x16x32_bf16 v[128:131], a[0:3], a[32:35], v[128:131]
    s_add_u32 m0, s45, 12288
    ds_read_b64_tr_b16 a[8:9], v12 offset:16384
    ds_read_b64_tr_b16 a[10:11], v12 offset:16896
    v_mfma_f32_16x16x32_bf16 v[144:147], a[4:7], a[32:35], v[144:147]
    buffer_load_dwordx4 v18, s[28:31], s65 offen offset:0 lds
    v_add_u32 v38, 57344, v38
    v_mfma_f32_16x16x32_bf16 v[132:135], a[0:3], a[36:39], v[132:135]
    ds_read_b64_tr_b16 a[12:13], v13 offset:16384
    ds_read_b64_tr_b16 a[14:15], v13 offset:16896
    v_mfma_f32_16x16x32_bf16 v[148:151], a[4:7], a[36:39], v[148:151]
    v_add_u32 v39, 57344, v39
    v_add_u32 v40, 57344, v40
    v_mfma_f32_16x16x32_bf16 v[136:139], a[0:3], a[40:43], v[136:139]
    ds_read_b128 a[48:51], v1 offset:24576
    v_add_u32 v41, 57344, v41
    v_mfma_f32_16x16x32_bf16 v[152:155], a[4:7], a[40:43], v[152:155]
    buffer_load_dwordx4 v19, s[28:31], s65 offen offset:1024 lds
    v_xor_b32 v6, v2, v3
    v_mfma_f32_16x16x32_bf16 v[140:143], a[0:3], a[44:47], v[140:143]
    v_xor_b32 v6, 0, v6
    v_lshlrev_b32 v6, 4, v6
    v_mfma_f32_16x16x32_bf16 v[156:159], a[4:7], a[44:47], v[156:159]
    s_waitcnt vmcnt(14) lgkmcnt(1)
    v_mfma_f32_16x16x32_bf16 v[160:163], a[8:11], a[32:35], v[160:163]
    ds_read_b64_tr_b16 a[0:1], v10 offset:20480
    ds_read_b64_tr_b16 a[2:3], v10 offset:20992
    v_mfma_f32_16x16x32_bf16 v[176:179], a[12:15], a[32:35], v[176:179]
    buffer_load_dwordx4 v20, s[28:31], s65 offen offset:2048 lds
    v_lshl_add_u32 v46, v3, 8, v6
    v_mfma_f32_16x16x32_bf16 v[164:167], a[8:11], a[36:39], v[164:167]
    ds_read_b64_tr_b16 a[4:5], v11 offset:20480
    ds_read_b64_tr_b16 a[6:7], v11 offset:20992
    v_mfma_f32_16x16x32_bf16 v[180:183], a[12:15], a[36:39], v[180:183]
    v_xor_b32 v6, v2, v3
    v_xor_b32 v6, 4, v6
    v_mfma_f32_16x16x32_bf16 v[168:171], a[8:11], a[40:43], v[168:171]
    ds_read_b128 a[52:55], v1 offset:25600
    v_lshlrev_b32 v6, 4, v6
    v_mfma_f32_16x16x32_bf16 v[184:187], a[12:15], a[40:43], v[184:187]
    buffer_load_dwordx4 v21, s[28:31], s65 offen offset:3072 lds
    v_lshl_add_u32 v47, v3, 8, v6
    v_mfma_f32_16x16x32_bf16 v[172:175], a[8:11], a[44:47], v[172:175]
    v_xor_b32 v6, v2, v3
    v_mfma_f32_16x16x32_bf16 v[188:191], a[12:15], a[44:47], v[188:191]
    s_waitcnt lgkmcnt(1)
    v_mfma_f32_16x16x32_bf16 v[192:195], a[0:3], a[32:35], v[192:195]
    s_add_u32 m0, s45, 16384
    ds_read_b64_tr_b16 a[8:9], v12 offset:20480
    ds_read_b64_tr_b16 a[10:11], v12 offset:20992
    v_mfma_f32_16x16x32_bf16 v[208:211], a[4:7], a[32:35], v[208:211]
    buffer_load_dwordx4 v18, s[24:27], s64 offen offset:0 lds
    v_xor_b32 v6, 8, v6
    v_mfma_f32_16x16x32_bf16 v[196:199], a[0:3], a[36:39], v[196:199]
    s_add_u32 s65, s65, 229376
    ds_read_b64_tr_b16 a[12:13], v13 offset:20480
    ds_read_b64_tr_b16 a[14:15], v13 offset:20992
    v_mfma_f32_16x16x32_bf16 v[212:215], a[4:7], a[36:39], v[212:215]
    s_sub_u32 s48, s65, 1835008
    v_lshlrev_b32 v6, 4, v6
    v_lshl_add_u32 v48, v3, 8, v6
    v_mfma_f32_16x16x32_bf16 v[200:203], a[0:3], a[40:43], v[200:203]
    s_min_u32 s65, s65, s48
    ds_read_b128 a[56:59], v1 offset:26624
    v_xor_b32 v6, v2, v3
    v_mfma_f32_16x16x32_bf16 v[216:219], a[4:7], a[40:43], v[216:219]
    buffer_load_dwordx4 v19, s[24:27], s64 offen offset:1024 lds
    v_xor_b32 v6, 12, v6
    v_mfma_f32_16x16x32_bf16 v[204:207], a[0:3], a[44:47], v[204:207]
    v_lshlrev_b32 v6, 4, v6
    v_lshl_add_u32 v49, v3, 8, v6
    v_mfma_f32_16x16x32_bf16 v[220:223], a[4:7], a[44:47], v[220:223]
    s_waitcnt vmcnt(14) lgkmcnt(1)
    v_mfma_f32_16x16x32_bf16 v[224:227], a[8:11], a[32:35], v[224:227]
    ds_read_b64_tr_b16 a[0:1], v10 offset:0
    ds_read_b64_tr_b16 a[2:3], v10 offset:512
    v_mfma_f32_16x16x32_bf16 v[240:243], a[12:15], a[32:35], v[240:243]
    buffer_load_dwordx4 v20, s[24:27], s64 offen offset:2048 lds
    v_lshlrev_b32 v6, 1, v3
    v_mfma_f32_16x16x32_bf16 v[228:231], a[8:11], a[36:39], v[228:231]
    ds_read_b64_tr_b16 a[4:5], v11 offset:0
    ds_read_b64_tr_b16 a[6:7], v11 offset:512
    v_mfma_f32_16x16x32_bf16 v[244:247], a[12:15], a[36:39], v[244:247]
    v_xor_b32 v6, v6, v2
    v_xor_b32 v6, 0, v6
    v_mfma_f32_16x16x32_bf16 v[232:235], a[8:11], a[40:43], v[232:235]
    ds_read_b128 a[60:63], v1 offset:27648
    v_lshlrev_b32 v6, 4, v6
    v_mfma_f32_16x16x32_bf16 v[248:251], a[12:15], a[40:43], v[248:251]
    buffer_load_dwordx4 v21, s[24:27], s64 offen offset:3072 lds
    v_lshl_add_u32 v50, v3, 8, v6
    v_mfma_f32_16x16x32_bf16 v[236:239], a[8:11], a[44:47], v[236:239]
    v_lshlrev_b32 v6, 1, v3
    v_mfma_f32_16x16x32_bf16 v[252:255], a[12:15], a[44:47], v[252:255]
    s_waitcnt lgkmcnt(0)
    v_mfma_f32_16x16x32_bf16 v[128:131], a[0:3], a[48:51], v[128:131]
    s_add_u32 m0, s45, 20480
    ds_read_b64_tr_b16 a[8:9], v12 offset:0
    ds_read_b64_tr_b16 a[10:11], v12 offset:512
    v_mfma_f32_16x16x32_bf16 v[144:147], a[4:7], a[48:51], v[144:147]
    buffer_load_dwordx4 v18, s[28:31], s64 offen offset:0 lds
    v_xor_b32 v6, v6, v2
    v_mfma_f32_16x16x32_bf16 v[132:135], a[0:3], a[52:55], v[132:135]
    ds_read_b64_tr_b16 a[12:13], v13 offset:0
    ds_read_b64_tr_b16 a[14:15], v13 offset:512
    v_mfma_f32_16x16x32_bf16 v[148:151], a[4:7], a[52:55], v[148:151]
    v_xor_b32 v6, 8, v6
    v_lshlrev_b32 v6, 4, v6
    v_mfma_f32_16x16x32_bf16 v[136:139], a[0:3], a[56:59], v[136:139]
    ds_read_b128 a[64:67], v1 offset:28672
    v_lshl_add_u32 v51, v3, 8, v6
    v_mfma_f32_16x16x32_bf16 v[152:155], a[4:7], a[56:59], v[152:155]
    buffer_load_dwordx4 v19, s[28:31], s64 offen offset:1024 lds
    s_lshl_b32 s51, s42, 12
    v_mfma_f32_16x16x32_bf16 v[140:143], a[0:3], a[60:63], v[140:143]
    s_add_u32 s56, s51, 65536
    s_add_u32 s57, s51, 114688
    v_mfma_f32_16x16x32_bf16 v[156:159], a[4:7], a[60:63], v[156:159]
    s_waitcnt vmcnt(14) lgkmcnt(1)
    v_mfma_f32_16x16x32_bf16 v[160:163], a[8:11], a[48:51], v[160:163]
    ds_read_b64_tr_b16 a[0:1], v10 offset:4096
    ds_read_b64_tr_b16 a[2:3], v10 offset:4608
    v_mfma_f32_16x16x32_bf16 v[176:179], a[12:15], a[48:51], v[176:179]
    buffer_load_dwordx4 v20, s[28:31], s64 offen offset:2048 lds
    s_cmp_lt_u32 s42, 2
    s_cselect_b64 vcc, -1, 0
    s_cselect_b32 s88, s8, s12
    s_cselect_b32 s89, s9, s13
    s_cselect_b32 s95, 0, 24576
    v_mfma_f32_16x16x32_bf16 v[164:167], a[8:11], a[52:55], v[164:167]
    ds_read_b64_tr_b16 a[4:5], v11 offset:4096
    ds_read_b64_tr_b16 a[6:7], v11 offset:4608
    v_mfma_f32_16x16x32_bf16 v[180:183], a[12:15], a[52:55], v[180:183]
    v_mfma_f32_16x16x32_bf16 v[168:171], a[8:11], a[56:59], v[168:171]
    ds_read_b128 a[68:71], v1 offset:29696
    s_mov_b32 s90, 524288
    v_mfma_f32_16x16x32_bf16 v[184:187], a[12:15], a[56:59], v[184:187]
    buffer_load_dwordx4 v21, s[28:31], s64 offen offset:3072 lds
    v_mfma_f32_16x16x32_bf16 v[172:175], a[8:11], a[60:63], v[172:175]
    v_mfma_f32_16x16x32_bf16 v[188:191], a[12:15], a[60:63], v[188:191]
    s_waitcnt lgkmcnt(1)
    v_mfma_f32_16x16x32_bf16 v[192:195], a[0:3], a[48:51], v[192:195]
    s_add_u32 m0, s45, 0
    ds_read_b64_tr_b16 a[8:9], v12 offset:4096
    ds_read_b64_tr_b16 a[10:11], v12 offset:4608
    v_mfma_f32_16x16x32_bf16 v[208:211], a[4:7], a[48:51], v[208:211]
    buffer_load_dwordx4 v18, s[24:27], s65 offen offset:0 lds
    s_mov_b32 s91, 0x20000
    v_mfma_f32_16x16x32_bf16 v[196:199], a[0:3], a[52:55], v[196:199]
    s_add_u32 s64, s64, 229376
    ds_read_b64_tr_b16 a[12:13], v13 offset:4096
    ds_read_b64_tr_b16 a[14:15], v13 offset:4608
    v_mfma_f32_16x16x32_bf16 v[212:215], a[4:7], a[52:55], v[212:215]
    s_sub_u32 s48, s64, 1835008
    s_and_b32 s51, s42, 1
    s_lshl_b32 s51, s51, 12
    v_mfma_f32_16x16x32_bf16 v[200:203], a[0:3], a[56:59], v[200:203]
    s_min_u32 s64, s64, s48
    ds_read_b128 a[72:75], v1 offset:30720
    s_add_u32 s51, s51, 32768
    v_mfma_f32_16x16x32_bf16 v[216:219], a[4:7], a[56:59], v[216:219]
    buffer_load_dwordx4 v19, s[24:27], s65 offen offset:1024 lds
    s_add_u32 s95, s95, s51
    v_mfma_f32_16x16x32_bf16 v[204:207], a[0:3], a[60:63], v[204:207]
    v_cndmask_b32 v30, v50, v46, vcc
    v_cndmask_b32 v31, v51, v47, vcc
    v_mfma_f32_16x16x32_bf16 v[220:223], a[4:7], a[60:63], v[220:223]
    s_waitcnt vmcnt(14) lgkmcnt(1)
    v_mfma_f32_16x16x32_bf16 v[224:227], a[8:11], a[48:51], v[224:227]
    ds_read_b64_tr_b16 a[0:1], v10 offset:8192
    ds_read_b64_tr_b16 a[2:3], v10 offset:8704
    v_mfma_f32_16x16x32_bf16 v[240:243], a[12:15], a[48:51], v[240:243]
    buffer_load_dwordx4 v20, s[24:27], s65 offen offset:2048 lds
    v_cndmask_b32 v32, v50, v48, vcc
    v_mfma_f32_16x16x32_bf16 v[228:231], a[8:11], a[52:55], v[228:231]
    ds_read_b64_tr_b16 a[4:5], v11 offset:8192
    ds_read_b64_tr_b16 a[6:7], v11 offset:8704
    v_mfma_f32_16x16x32_bf16 v[244:247], a[12:15], a[52:55], v[244:247]
    v_cndmask_b32 v33, v51, v49, vcc
    s_and_b32 s52, s41, 0
    v_mfma_f32_16x16x32_bf16 v[232:235], a[8:11], a[56:59], v[232:235]
    ds_read_b128 a[76:79], v1 offset:31744
    s_lshl_b32 s52, s52, 14
    v_mfma_f32_16x16x32_bf16 v[248:251], a[12:15], a[56:59], v[248:251]
    buffer_load_dwordx4 v21, s[24:27], s65 offen offset:3072 lds
    s_and_b32 s53, s42, 1
    v_mfma_f32_16x16x32_bf16 v[236:239], a[8:11], a[60:63], v[236:239]
    s_lshl_b32 s53, s53, 12
    v_mfma_f32_16x16x32_bf16 v[252:255], a[12:15], a[60:63], v[252:255]
    s_waitcnt lgkmcnt(0)
    v_mfma_f32_16x16x32_bf16 v[128:131], a[0:3], a[64:67], v[128:131]
    s_add_u32 m0, s45, 4096
    ds_read_b64_tr_b16 a[8:9], v12 offset:8192
    ds_read_b64_tr_b16 a[10:11], v12 offset:8704
    v_mfma_f32_16x16x32_bf16 v[144:147], a[4:7], a[64:67], v[144:147]
    buffer_load_dwordx4 v18, s[28:31], s65 offen offset:0 lds
    s_add_u32 s94, s52, s53
    v_mfma_f32_16x16x32_bf16 v[132:135], a[0:3], a[68:71], v[132:135]
    ds_read_b64_tr_b16 a[12:13], v13 offset:8192
    ds_read_b64_tr_b16 a[14:15], v13 offset:8704
    v_mfma_f32_16x16x32_bf16 v[148:151], a[4:7], a[68:71], v[148:151]
    s_lshr_b32 s51, s42, 1
    s_add_u32 s51, s51, 1
    v_mfma_f32_16x16x32_bf16 v[136:139], a[0:3], a[72:75], v[136:139]
    ds_read_b128 a[16:19], v1 offset:32768
    s_lshl_b32 s51, s51, 13
    v_mfma_f32_16x16x32_bf16 v[152:155], a[4:7], a[72:75], v[152:155]
    buffer_load_dwordx4 v19, s[28:31], s65 offen offset:1024 lds
    s_add_u32 s54, s94, s51
    v_mfma_f32_16x16x32_bf16 v[140:143], a[0:3], a[76:79], v[140:143]
    s_and_b32 s54, s54, 0x7ffff
    s_sub_u32 s55, s54, 16384
    v_mfma_f32_16x16x32_bf16 v[156:159], a[4:7], a[76:79], v[156:159]
    s_waitcnt vmcnt(14) lgkmcnt(1)
    v_mfma_f32_16x16x32_bf16 v[160:163], a[8:11], a[64:67], v[160:163]
    ds_read_b64_tr_b16 a[0:1], v10 offset:12288
    ds_read_b64_tr_b16 a[2:3], v10 offset:12800
    v_mfma_f32_16x16x32_bf16 v[176:179], a[12:15], a[64:67], v[176:179]
    buffer_load_dwordx4 v20, s[28:31], s65 offen offset:2048 lds
    s_and_b32 s55, s55, 0x7ffff
    v_mfma_f32_16x16x32_bf16 v[164:167], a[8:11], a[68:71], v[164:167]
    ds_read_b64_tr_b16 a[4:5], v11 offset:12288
    ds_read_b64_tr_b16 a[6:7], v11 offset:12800
    v_mfma_f32_16x16x32_bf16 v[180:183], a[12:15], a[68:71], v[180:183]
    s_lshl_b32 s51, s42, 1
    s_add_u32 s51, s51, 0
    v_mfma_f32_16x16x32_bf16 v[168:171], a[8:11], a[72:75], v[168:171]
    ds_read_b128 a[20:23], v1 offset:33792
    s_sub_u32 s53, s51, s63
    v_mfma_f32_16x16x32_bf16 v[184:187], a[12:15], a[72:75], v[184:187]
    buffer_load_dwordx4 v21, s[28:31], s65 offen offset:3072 lds
    s_add_u32 s51, s53, 7
    v_mfma_f32_16x16x32_bf16 v[172:175], a[8:11], a[76:79], v[172:175]
    s_sub_u32 s51, s51, s44
    v_mfma_f32_16x16x32_bf16 v[188:191], a[12:15], a[76:79], v[188:191]
    s_waitcnt lgkmcnt(1)
    v_mfma_f32_16x16x32_bf16 v[192:195], a[0:3], a[64:67], v[192:195]
    s_add_u32 m0, s45, 8192
    ds_read_b64_tr_b16 a[8:9], v12 offset:12288
    ds_read_b64_tr_b16 a[10:11], v12 offset:12800
    v_mfma_f32_16x16x32_bf16 v[208:211], a[4:7], a[64:67], v[208:211]
    buffer_load_dwordx4 v18, s[24:27], s64 offen offset:0 lds
    s_cmp_ge_u32 s51, 7
    s_cselect_b32 s52, 7, 0
    v_mfma_f32_16x16x32_bf16 v[196:199], a[0:3], a[68:71], v[196:199]
    s_add_u32 s65, s65, 229376
    ds_read_b64_tr_b16 a[12:13], v13 offset:12288
    ds_read_b64_tr_b16 a[14:15], v13 offset:12800
    v_mfma_f32_16x16x32_bf16 v[212:215], a[4:7], a[68:71], v[212:215]
    s_sub_u32 s48, s65, 1835008
    s_sub_u32 s51, s51, s52
    v_mfma_f32_16x16x32_bf16 v[200:203], a[0:3], a[72:75], v[200:203]
    s_min_u32 s65, s65, s48
    ds_read_b128 a[24:27], v1 offset:34816
    s_cmp_ge_u32 s53, 7
    s_cselect_b32 s51, 7, s51
    v_mfma_f32_16x16x32_bf16 v[216:219], a[4:7], a[72:75], v[216:219]
    buffer_load_dwordx4 v19, s[24:27], s64 offen offset:1024 lds
    s_lshl_b32 s51, s51, 12
    v_mfma_f32_16x16x32_bf16 v[204:207], a[0:3], a[76:79], v[204:207]
    v_add_u32 v52, s51, v1
    v_mfma_f32_16x16x32_bf16 v[220:223], a[4:7], a[76:79], v[220:223]
    s_waitcnt vmcnt(14) lgkmcnt(1)
    v_mfma_f32_16x16x32_bf16 v[224:227], a[8:11], a[64:67], v[224:227]
    ds_read_b64_tr_b16 a[0:1], v10 offset:16384
    ds_read_b64_tr_b16 a[2:3], v10 offset:16896
    v_mfma_f32_16x16x32_bf16 v[240:243], a[12:15], a[64:67], v[240:243]
    buffer_load_dwordx4 v20, s[24:27], s64 offen offset:2048 lds
    s_lshl_b32 s51, s42, 1
    v_mfma_f32_16x16x32_bf16 v[228:231], a[8:11], a[68:71], v[228:231]
    ds_read_b64_tr_b16 a[4:5], v11 offset:16384
    ds_read_b64_tr_b16 a[6:7], v11 offset:16896
    v_mfma_f32_16x16x32_bf16 v[244:247], a[12:15], a[68:71], v[244:247]
    s_add_u32 s51, s51, 1
    s_sub_u32 s53, s51, s63
    v_mfma_f32_16x16x32_bf16 v[232:235], a[8:11], a[72:75], v[232:235]
    ds_read_b128 a[28:31], v1 offset:35840
    s_add_u32 s51, s53, 7
    v_mfma_f32_16x16x32_bf16 v[248:251], a[12:15], a[72:75], v[248:251]
    buffer_load_dwordx4 v21, s[24:27], s64 offen offset:3072 lds
    s_sub_u32 s51, s51, s44
    v_mfma_f32_16x16x32_bf16 v[236:239], a[8:11], a[76:79], v[236:239]
    s_cmp_ge_u32 s51, 7
    s_cselect_b32 s52, 7, 0
    v_mfma_f32_16x16x32_bf16 v[252:255], a[12:15], a[76:79], v[252:255]
    s_waitcnt lgkmcnt(0)
    v_mfma_f32_16x16x32_bf16 v[128:131], a[0:3], a[16:19], v[128:131]
    s_add_u32 m0, s45, 12288
    ds_read_b64_tr_b16 a[8:9], v12 offset:16384
    ds_read_b64_tr_b16 a[10:11], v12 offset:16896
    v_mfma_f32_16x16x32_bf16 v[144:147], a[4:7], a[16:19], v[144:147]
    buffer_load_dwordx4 v18, s[28:31], s64 offen offset:0 lds
    s_sub_u32 s51, s51, s52
    v_mfma_f32_16x16x32_bf16 v[132:135], a[0:3], a[20:23], v[132:135]
    ds_read_b64_tr_b16 a[12:13], v13 offset:16384
    ds_read_b64_tr_b16 a[14:15], v13 offset:16896
    v_mfma_f32_16x16x32_bf16 v[148:151], a[4:7], a[20:23], v[148:151]
    s_cmp_ge_u32 s53, 7
    s_cselect_b32 s51, 7, s51
    v_mfma_f32_16x16x32_bf16 v[136:139], a[0:3], a[24:27], v[136:139]
    ds_read_b128 a[32:35], v1 offset:36864
    s_lshl_b32 s51, s51, 12
    v_mfma_f32_16x16x32_bf16 v[152:155], a[4:7], a[24:27], v[152:155]
    buffer_load_dwordx4 v19, s[28:31], s64 offen offset:1024 lds
    v_add_u32 v53, s51, v1
    v_mfma_f32_16x16x32_bf16 v[140:143], a[0:3], a[28:31], v[140:143]
    s_sub_u32 s51, s42, s43
    v_mfma_f32_16x16x32_bf16 v[156:159], a[4:7], a[28:31], v[156:159]
    s_waitcnt vmcnt(14) lgkmcnt(1)
    v_mfma_f32_16x16x32_bf16 v[160:163], a[8:11], a[16:19], v[160:163]
    ds_read_b64_tr_b16 a[0:1], v10 offset:20480
    ds_read_b64_tr_b16 a[2:3], v10 offset:20992
    v_mfma_f32_16x16x32_bf16 v[176:179], a[12:15], a[16:19], v[176:179]
    buffer_load_dwordx4 v20, s[28:31], s64 offen offset:2048 lds
    s_and_b32 s51, s51, 3
    v_mfma_f32_16x16x32_bf16 v[164:167], a[8:11], a[20:23], v[164:167]
    ds_read_b64_tr_b16 a[4:5], v11 offset:20480
    ds_read_b64_tr_b16 a[6:7], v11 offset:20992
    v_mfma_f32_16x16x32_bf16 v[180:183], a[12:15], a[20:23], v[180:183]
    s_lshl_b32 s51, s51, 12
    s_add_u32 s51, s51, 65536
    v_mfma_f32_16x16x32_bf16 v[168:171], a[8:11], a[24:27], v[168:171]
    ds_read_b128 a[36:39], v1 offset:37888
    v_add_u32 v56, s51, v1
    v_mfma_f32_16x16x32_bf16 v[184:187], a[12:15], a[24:27], v[184:187]
    buffer_load_dwordx4 v21, s[28:31], s64 offen offset:3072 lds
    v_add_u32 v54, 65536, v1
    v_mfma_f32_16x16x32_bf16 v[172:175], a[8:11], a[28:31], v[172:175]
    s_lshl_b32 s92, s42, 14
    v_mfma_f32_16x16x32_bf16 v[188:191], a[12:15], a[28:31], v[188:191]
    s_waitcnt lgkmcnt(1)
    v_mfma_f32_16x16x32_bf16 v[192:195], a[0:3], a[16:19], v[192:195]
    s_add_u32 m0, s45, 16384
    ds_read_b64_tr_b16 a[8:9], v12 offset:20480
    ds_read_b64_tr_b16 a[10:11], v12 offset:20992
    v_mfma_f32_16x16x32_bf16 v[208:211], a[4:7], a[16:19], v[208:211]
    buffer_load_dwordx4 v18, s[24:27], s65 offen offset:0 lds
    s_lshl_b32 s93, s42, 12
    v_mfma_f32_16x16x32_bf16 v[196:199], a[0:3], a[20:23], v[196:199]
    s_add_u32 s64, s64, 229376
    ds_read_b64_tr_b16 a[12:13], v13 offset:20480
    ds_read_b64_tr_b16 a[14:15], v13 offset:20992
    v_mfma_f32_16x16x32_bf16 v[212:215], a[4:7], a[20:23], v[212:215]
    s_sub_u32 s48, s64, 1835008
    s_add_u32 s93, s93, 131072
    s_mov_b32 s59, 0
    v_mfma_f32_16x16x32_bf16 v[200:203], a[0:3], a[24:27], v[200:203]
    s_min_u32 s64, s64, s48
    ds_read_b128 a[40:43], v1 offset:38912
    v_mov_b32 v60, 0xff800000
    v_mfma_f32_16x16x32_bf16 v[216:219], a[4:7], a[24:27], v[216:219]
    buffer_load_dwordx4 v19, s[24:27], s65 offen offset:1024 lds
    v_mov_b32 v61, 0xff800000
    v_mfma_f32_16x16x32_bf16 v[204:207], a[0:3], a[28:31], v[204:207]
    v_mov_b32 v62, 0xff800000
    v_mov_b32 v63, 0xff800000
    v_mfma_f32_16x16x32_bf16 v[220:223], a[4:7], a[28:31], v[220:223]
    s_waitcnt vmcnt(14) lgkmcnt(1)
    v_mfma_f32_16x16x32_bf16 v[224:227], a[8:11], a[16:19], v[224:227]
    ds_read_b64_tr_b16 a[0:1], v10 offset:0
    ds_read_b64_tr_b16 a[2:3], v10 offset:512
    v_mfma_f32_16x16x32_bf16 v[240:243], a[12:15], a[16:19], v[240:243]
    buffer_load_dwordx4 v20, s[24:27], s65 offen offset:2048 lds
    s_lshl_b32 s51, s41, 2
    v_mfma_f32_16x16x32_bf16 v[228:231], a[8:11], a[20:23], v[228:231]
    ds_read_b64_tr_b16 a[4:5], v11 offset:0
    ds_read_b64_tr_b16 a[6:7], v11 offset:512
    v_mfma_f32_16x16x32_bf16 v[244:247], a[12:15], a[20:23], v[244:247]
    s_add_u32 s51, s51, s42
    s_lshl_b32 s53, s42, 8
    v_mfma_f32_16x16x32_bf16 v[232:235], a[8:11], a[24:27], v[232:235]
    ds_read_b128 a[44:47], v1 offset:39936
    s_lshl_b32 s52, s51, 12
    v_mfma_f32_16x16x32_bf16 v[248:251], a[12:15], a[24:27], v[248:251]
    buffer_load_dwordx4 v21, s[24:27], s65 offen offset:3072 lds
    s_sub_u32 s52, s52, s53
    v_mfma_f32_16x16x32_bf16 v[236:239], a[8:11], a[28:31], v[236:239]
    v_lshlrev_b32 v58, 6, v0
    v_mfma_f32_16x16x32_bf16 v[252:255], a[12:15], a[28:31], v[252:255]
    s_waitcnt lgkmcnt(0)
    v_mfma_f32_16x16x32_bf16 v[128:131], a[0:3], a[32:35], v[128:131]
    s_add_u32 m0, s45, 20480
    ds_read_b64_tr_b16 a[8:9], v12 offset:0
    ds_read_b64_tr_b16 a[10:11], v12 offset:512
    v_mfma_f32_16x16x32_bf16 v[144:147], a[4:7], a[32:35], v[144:147]
    buffer_load_dwordx4 v18, s[28:31], s65 offen offset:0 lds
    v_add_u32 v58, s52, v58
    v_mfma_f32_16x16x32_bf16 v[132:135], a[0:3], a[36:39], v[132:135]
    ds_read_b64_tr_b16 a[12:13], v13 offset:0
    ds_read_b64_tr_b16 a[14:15], v13 offset:512
    v_mfma_f32_16x16x32_bf16 v[148:151], a[4:7], a[36:39], v[148:151]
    s_lshl_b32 s51, s41, 10
    s_add_u32 s51, s51, 33554432
    v_mfma_f32_16x16x32_bf16 v[136:139], a[0:3], a[40:43], v[136:139]
    ds_read_b128 a[48:51], v1 offset:40960
    s_add_u32 s76, s86, s51
    s_addc_u32 s77, s87, 0
    v_mfma_f32_16x16x32_bf16 v[152:155], a[4:7], a[40:43], v[152:155]
    buffer_load_dwordx4 v19, s[28:31], s65 offen offset:1024 lds
    s_mov_b32 s78, 1024
    v_mfma_f32_16x16x32_bf16 v[140:143], a[0:3], a[44:47], v[140:143]
    s_mov_b32 s79, 0x20000
    v_mfma_f32_16x16x32_bf16 v[156:159], a[4:7], a[44:47], v[156:159]
    s_waitcnt vmcnt(14) lgkmcnt(1)
    v_mfma_f32_16x16x32_bf16 v[160:163], a[8:11], a[32:35], v[160:163]
    ds_read_b64_tr_b16 a[0:1], v10 offset:4096
    ds_read_b64_tr_b16 a[2:3], v10 offset:4608
    v_mfma_f32_16x16x32_bf16 v[176:179], a[12:15], a[32:35], v[176:179]
    buffer_load_dwordx4 v20, s[28:31], s65 offen offset:2048 lds
    s_lshl_b32 s51, s41, 16
    v_mfma_f32_16x16x32_bf16 v[164:167], a[8:11], a[36:39], v[164:167]
    ds_read_b64_tr_b16 a[4:5], v11 offset:4096
    ds_read_b64_tr_b16 a[6:7], v11 offset:4608
    v_mfma_f32_16x16x32_bf16 v[180:183], a[12:15], a[36:39], v[180:183]
    s_add_u32 s80, s82, s51
    s_addc_u32 s81, s83, 0
    v_mfma_f32_16x16x32_bf16 v[168:171], a[8:11], a[40:43], v[168:171]
    ds_read_b128 a[52:55], v1 offset:41984
    s_mov_b32 s82, 65536
    v_mfma_f32_16x16x32_bf16 v[184:187], a[12:15], a[40:43], v[184:187]
    buffer_load_dwordx4 v21, s[28:31], s65 offen offset:3072 lds
    s_mov_b32 s83, 0x20000
    v_mfma_f32_16x16x32_bf16 v[172:175], a[8:11], a[44:47], v[172:175]
    s_lshl_b32 s52, s42, 8
    v_mfma_f32_16x16x32_bf16 v[188:191], a[12:15], a[44:47], v[188:191]
    s_waitcnt lgkmcnt(1)
    v_mfma_f32_16x16x32_bf16 v[192:195], a[0:3], a[32:35], v[192:195]
    s_add_u32 m0, s45, 0
    ds_read_b64_tr_b16 a[8:9], v12 offset:4096
    ds_read_b64_tr_b16 a[10:11], v12 offset:4608
    v_mfma_f32_16x16x32_bf16 v[208:211], a[4:7], a[32:35], v[208:211]
    buffer_load_dwordx4 v18, s[24:27], s64 offen offset:0 lds
    v_and_b32 v59, 15, v0
    v_mfma_f32_16x16x32_bf16 v[196:199], a[0:3], a[36:39], v[196:199]
    s_add_u32 s65, s65, 229376
    ds_read_b64_tr_b16 a[12:13], v13 offset:4096
    ds_read_b64_tr_b16 a[14:15], v13 offset:4608
    v_mfma_f32_16x16x32_bf16 v[212:215], a[4:7], a[36:39], v[212:215]
    s_sub_u32 s48, s65, 1835008
    v_lshl_add_u32 v59, v59, 2, s52
    s_and_b32 s51, s40, 1
    v_mfma_f32_16x16x32_bf16 v[200:203], a[0:3], a[40:43], v[200:203]
    s_min_u32 s65, s65, s48
    ds_read_b128 a[56:59], v1 offset:43008
    s_lshl_b32 s51, s51, 15
    v_mfma_f32_16x16x32_bf16 v[216:219], a[4:7], a[40:43], v[216:219]
    buffer_load_dwordx4 v19, s[24:27], s64 offen offset:1024 lds
    s_lshr_b32 s52, s40, 1
    v_mfma_f32_16x16x32_bf16 v[204:207], a[0:3], a[44:47], v[204:207]
    s_lshl_b32 s52, s52, 6
    s_add_u32 s51, s51, s52
    v_mfma_f32_16x16x32_bf16 v[220:223], a[4:7], a[44:47], v[220:223]
    s_waitcnt vmcnt(14) lgkmcnt(1)
    v_mfma_f32_16x16x32_bf16 v[224:227], a[8:11], a[32:35], v[224:227]
    ds_read_b64_tr_b16 a[0:1], v10 offset:8192
    ds_read_b64_tr_b16 a[2:3], v10 offset:8704
    v_mfma_f32_16x16x32_bf16 v[240:243], a[12:15], a[32:35], v[240:243]
    buffer_load_dwordx4 v20, s[24:27], s64 offen offset:2048 lds
    s_lshl_b32 s52, s42, 8
    v_mfma_f32_16x16x32_bf16 v[228:231], a[8:11], a[36:39], v[228:231]
    ds_read_b64_tr_b16 a[4:5], v11 offset:8192
    ds_read_b64_tr_b16 a[6:7], v11 offset:8704
    v_mfma_f32_16x16x32_bf16 v[244:247], a[12:15], a[36:39], v[244:247]
    s_add_u32 s51, s51, s52
    v_and_b32 v57, 15, v0
    v_mfma_f32_16x16x32_bf16 v[232:235], a[8:11], a[40:43], v[232:235]
    ds_read_b128 a[60:63], v1 offset:44032
    v_lshrrev_b32 v9, 4, v0
    v_mfma_f32_16x16x32_bf16 v[248:251], a[12:15], a[40:43], v[248:251]
    buffer_load_dwordx4 v21, s[24:27], s64 offen offset:3072 lds
    v_lshlrev_b32 v57, 10, v57
    v_mfma_f32_16x16x32_bf16 v[236:239], a[8:11], a[44:47], v[236:239]
    v_lshl_add_u32 v57, v9, 3, v57
    v_mfma_f32_16x16x32_bf16 v[252:255], a[12:15], a[44:47], v[252:255]
    s_waitcnt lgkmcnt(0)
    v_mfma_f32_16x16x32_bf16 v[128:131], a[0:3], a[48:51], v[128:131]
    s_add_u32 m0, s45, 4096
    ds_read_b64_tr_b16 a[8:9], v12 offset:8192
    ds_read_b64_tr_b16 a[10:11], v12 offset:8704
    v_mfma_f32_16x16x32_bf16 v[144:147], a[4:7], a[48:51], v[144:147]
    buffer_load_dwordx4 v18, s[28:31], s64 offen offset:0 lds
    v_add_u32 v57, s51, v57
    v_mfma_f32_16x16x32_bf16 v[132:135], a[0:3], a[52:55], v[132:135]
    ds_read_b64_tr_b16 a[12:13], v13 offset:8192
    ds_read_b64_tr_b16 a[14:15], v13 offset:8704
    v_mfma_f32_16x16x32_bf16 v[148:151], a[4:7], a[52:55], v[148:151]
    v_accvgpr_write_b32 a108, 0
    v_accvgpr_write_b32 a109, 0
    v_mfma_f32_16x16x32_bf16 v[136:139], a[0:3], a[56:59], v[136:139]
    ds_read_b128 a[64:67], v1 offset:45056
    v_accvgpr_write_b32 a110, 0
    v_mfma_f32_16x16x32_bf16 v[152:155], a[4:7], a[56:59], v[152:155]
    buffer_load_dwordx4 v19, s[28:31], s64 offen offset:1024 lds
    v_accvgpr_write_b32 a111, 0
    v_mfma_f32_16x16x32_bf16 v[140:143], a[0:3], a[60:63], v[140:143]
    v_bfe_u32 v6, v0, 1, 2
    v_mov_b32 v7, 0x3f803f80
    v_mfma_f32_16x16x32_bf16 v[156:159], a[4:7], a[60:63], v[156:159]
    s_waitcnt vmcnt(14) lgkmcnt(1)
    v_mfma_f32_16x16x32_bf16 v[160:163], a[8:11], a[48:51], v[160:163]
    ds_read_b64_tr_b16 a[0:1], v10 offset:12288
    ds_read_b64_tr_b16 a[2:3], v10 offset:12800
    v_mfma_f32_16x16x32_bf16 v[176:179], a[12:15], a[48:51], v[176:179]
    buffer_load_dwordx4 v20, s[28:31], s64 offen offset:2048 lds
    v_cmp_eq_u32 vcc, 0, v6
    v_mfma_f32_16x16x32_bf16 v[164:167], a[8:11], a[52:55], v[164:167]
    ds_read_b64_tr_b16 a[4:5], v11 offset:12288
    ds_read_b64_tr_b16 a[6:7], v11 offset:12800
    v_mfma_f32_16x16x32_bf16 v[180:183], a[12:15], a[52:55], v[180:183]
    v_cndmask_b32 v8, 0, v7, vcc
    v_accvgpr_write_b32 a112, v8
    v_mfma_f32_16x16x32_bf16 v[168:171], a[8:11], a[56:59], v[168:171]
    ds_read_b128 a[68:71], v1 offset:46080
    v_accvgpr_write_b32 a113, v8
    v_mfma_f32_16x16x32_bf16 v[184:187], a[12:15], a[56:59], v[184:187]
    buffer_load_dwordx4 v21, s[28:31], s64 offen offset:3072 lds
    v_accvgpr_write_b32 a114, v8
    v_mfma_f32_16x16x32_bf16 v[172:175], a[8:11], a[60:63], v[172:175]
    v_accvgpr_write_b32 a115, v8
    v_mfma_f32_16x16x32_bf16 v[188:191], a[12:15], a[60:63], v[188:191]
    s_waitcnt lgkmcnt(1)
    v_mfma_f32_16x16x32_bf16 v[192:195], a[0:3], a[48:51], v[192:195]
    s_add_u32 m0, s45, 8192
    ds_read_b64_tr_b16 a[8:9], v12 offset:12288
    ds_read_b64_tr_b16 a[10:11], v12 offset:12800
    v_mfma_f32_16x16x32_bf16 v[208:211], a[4:7], a[48:51], v[208:211]
    buffer_load_dwordx4 v18, s[24:27], s65 offen offset:0 lds
    v_cmp_eq_u32 vcc, 1, v6
    v_mfma_f32_16x16x32_bf16 v[196:199], a[0:3], a[52:55], v[196:199]
    s_add_u32 s64, s64, 229376
    ds_read_b64_tr_b16 a[12:13], v13 offset:12288
    ds_read_b64_tr_b16 a[14:15], v13 offset:12800
    v_mfma_f32_16x16x32_bf16 v[212:215], a[4:7], a[52:55], v[212:215]
    s_sub_u32 s48, s64, 1835008
    v_cndmask_b32 v8, 0, v7, vcc
    v_accvgpr_write_b32 a116, v8
    v_mfma_f32_16x16x32_bf16 v[200:203], a[0:3], a[56:59], v[200:203]
    s_min_u32 s64, s64, s48
    ds_read_b128 a[72:75], v1 offset:47104
    v_accvgpr_write_b32 a117, v8
    v_mfma_f32_16x16x32_bf16 v[216:219], a[4:7], a[56:59], v[216:219]
    buffer_load_dwordx4 v19, s[24:27], s65 offen offset:1024 lds
    v_accvgpr_write_b32 a118, v8
    v_mfma_f32_16x16x32_bf16 v[204:207], a[0:3], a[60:63], v[204:207]
    v_accvgpr_write_b32 a119, v8
    v_cmp_eq_u32 vcc, 2, v6
    v_mfma_f32_16x16x32_bf16 v[220:223], a[4:7], a[60:63], v[220:223]
    s_waitcnt vmcnt(14) lgkmcnt(1)
    v_mfma_f32_16x16x32_bf16 v[224:227], a[8:11], a[48:51], v[224:227]
    ds_read_b64_tr_b16 a[0:1], v10 offset:16384
    ds_read_b64_tr_b16 a[2:3], v10 offset:16896
    v_mfma_f32_16x16x32_bf16 v[240:243], a[12:15], a[48:51], v[240:243]
    buffer_load_dwordx4 v20, s[24:27], s65 offen offset:2048 lds
    v_cndmask_b32 v8, 0, v7, vcc
    v_mfma_f32_16x16x32_bf16 v[228:231], a[8:11], a[52:55], v[228:231]
    ds_read_b64_tr_b16 a[4:5], v11 offset:16384
    ds_read_b64_tr_b16 a[6:7], v11 offset:16896
    v_mfma_f32_16x16x32_bf16 v[244:247], a[12:15], a[52:55], v[244:247]
    v_accvgpr_write_b32 a120, v8
    v_accvgpr_write_b32 a121, v8
    v_mfma_f32_16x16x32_bf16 v[232:235], a[8:11], a[56:59], v[232:235]
    ds_read_b128 a[76:79], v1 offset:48128
    v_accvgpr_write_b32 a122, v8
    v_mfma_f32_16x16x32_bf16 v[248:251], a[12:15], a[56:59], v[248:251]
    buffer_load_dwordx4 v21, s[24:27], s65 offen offset:3072 lds
    v_accvgpr_write_b32 a123, v8
    v_mfma_f32_16x16x32_bf16 v[236:239], a[8:11], a[60:63], v[236:239]
    v_cmp_eq_u32 vcc, 3, v6
    v_mfma_f32_16x16x32_bf16 v[252:255], a[12:15], a[60:63], v[252:255]
    s_waitcnt lgkmcnt(0)
    v_mfma_f32_16x16x32_bf16 v[128:131], a[0:3], a[64:67], v[128:131]
    s_add_u32 m0, s45, 12288
    ds_read_b64_tr_b16 a[8:9], v12 offset:16384
    ds_read_b64_tr_b16 a[10:11], v12 offset:16896
    v_mfma_f32_16x16x32_bf16 v[144:147], a[4:7], a[64:67], v[144:147]
    buffer_load_dwordx4 v18, s[28:31], s65 offen offset:0 lds
    v_cndmask_b32 v8, 0, v7, vcc
    v_mfma_f32_16x16x32_bf16 v[132:135], a[0:3], a[68:71], v[132:135]
    ds_read_b64_tr_b16 a[12:13], v13 offset:16384
    ds_read_b64_tr_b16 a[14:15], v13 offset:16896
    v_mfma_f32_16x16x32_bf16 v[148:151], a[4:7], a[68:71], v[148:151]
    v_accvgpr_write_b32 a124, v8
    v_accvgpr_write_b32 a125, v8
    v_mfma_f32_16x16x32_bf16 v[136:139], a[0:3], a[72:75], v[136:139]
    ds_read_b128 a[16:19], v1 offset:49152
    v_accvgpr_write_b32 a126, v8
    v_mfma_f32_16x16x32_bf16 v[152:155], a[4:7], a[72:75], v[152:155]
    buffer_load_dwordx4 v19, s[28:31], s65 offen offset:1024 lds
    v_accvgpr_write_b32 a127, v8
    v_mfma_f32_16x16x32_bf16 v[140:143], a[0:3], a[76:79], v[140:143]
    s_mov_b32 s44, 0xc13504f3
    v_mfma_f32_16x16x32_bf16 v[156:159], a[4:7], a[76:79], v[156:159]
    s_waitcnt vmcnt(14) lgkmcnt(1)
    v_mfma_f32_16x16x32_bf16 v[160:163], a[8:11], a[64:67], v[160:163]
    ds_read_b64_tr_b16 a[0:1], v10 offset:20480
    ds_read_b64_tr_b16 a[2:3], v10 offset:20992
    v_mfma_f32_16x16x32_bf16 v[176:179], a[12:15], a[64:67], v[176:179]
    buffer_load_dwordx4 v20, s[28:31], s65 offen offset:2048 lds
    v_mfma_f32_16x16x32_bf16 v[164:167], a[8:11], a[68:71], v[164:167]
    ds_read_b64_tr_b16 a[4:5], v11 offset:20480
    ds_read_b64_tr_b16 a[6:7], v11 offset:20992
    v_mfma_f32_16x16x32_bf16 v[180:183], a[12:15], a[68:71], v[180:183]
    v_mfma_f32_16x16x32_bf16 v[168:171], a[8:11], a[72:75], v[168:171]
    ds_read_b128 a[20:23], v1 offset:50176
    v_mfma_f32_16x16x32_bf16 v[184:187], a[12:15], a[72:75], v[184:187]
    buffer_load_dwordx4 v21, s[28:31], s65 offen offset:3072 lds
    v_mfma_f32_16x16x32_bf16 v[172:175], a[8:11], a[76:79], v[172:175]
    v_mfma_f32_16x16x32_bf16 v[188:191], a[12:15], a[76:79], v[188:191]
    s_waitcnt lgkmcnt(1)
    v_mfma_f32_16x16x32_bf16 v[192:195], a[0:3], a[64:67], v[192:195]
    s_add_u32 m0, s45, 16384
    ds_read_b64_tr_b16 a[8:9], v12 offset:20480
    ds_read_b64_tr_b16 a[10:11], v12 offset:20992
    v_mfma_f32_16x16x32_bf16 v[208:211], a[4:7], a[64:67], v[208:211]
    buffer_load_dwordx4 v18, s[24:27], s64 offen offset:0 lds
    v_mfma_f32_16x16x32_bf16 v[196:199], a[0:3], a[68:71], v[196:199]
    s_add_u32 s65, s65, 229376
    ds_read_b64_tr_b16 a[12:13], v13 offset:20480
    ds_read_b64_tr_b16 a[14:15], v13 offset:20992
    v_mfma_f32_16x16x32_bf16 v[212:215], a[4:7], a[68:71], v[212:215]
    s_sub_u32 s48, s65, 1835008
    v_mfma_f32_16x16x32_bf16 v[200:203], a[0:3], a[72:75], v[200:203]
    s_min_u32 s65, s65, s48
    ds_read_b128 a[24:27], v1 offset:51200
    v_mfma_f32_16x16x32_bf16 v[216:219], a[4:7], a[72:75], v[216:219]
    buffer_load_dwordx4 v19, s[24:27], s64 offen offset:1024 lds
    v_mfma_f32_16x16x32_bf16 v[204:207], a[0:3], a[76:79], v[204:207]
    v_mfma_f32_16x16x32_bf16 v[220:223], a[4:7], a[76:79], v[220:223]
    s_waitcnt vmcnt(14) lgkmcnt(1)
    v_mfma_f32_16x16x32_bf16 v[224:227], a[8:11], a[64:67], v[224:227]
    ds_read_b64_tr_b16 a[0:1], v10 offset:0
    ds_read_b64_tr_b16 a[2:3], v10 offset:512
    v_mfma_f32_16x16x32_bf16 v[240:243], a[12:15], a[64:67], v[240:243]
    buffer_load_dwordx4 v20, s[24:27], s64 offen offset:2048 lds
    v_mfma_f32_16x16x32_bf16 v[228:231], a[8:11], a[68:71], v[228:231]
    ds_read_b64_tr_b16 a[4:5], v11 offset:0
    ds_read_b64_tr_b16 a[6:7], v11 offset:512
    v_mfma_f32_16x16x32_bf16 v[244:247], a[12:15], a[68:71], v[244:247]
    v_mfma_f32_16x16x32_bf16 v[232:235], a[8:11], a[72:75], v[232:235]
    ds_read_b128 a[28:31], v1 offset:52224
    v_mfma_f32_16x16x32_bf16 v[248:251], a[12:15], a[72:75], v[248:251]
    buffer_load_dwordx4 v21, s[24:27], s64 offen offset:3072 lds
    v_mfma_f32_16x16x32_bf16 v[236:239], a[8:11], a[76:79], v[236:239]
    v_mfma_f32_16x16x32_bf16 v[252:255], a[12:15], a[76:79], v[252:255]
    s_waitcnt lgkmcnt(0)
    v_mfma_f32_16x16x32_bf16 v[128:131], a[0:3], a[16:19], v[128:131]
    s_add_u32 m0, s45, 20480
    ds_read_b64_tr_b16 a[8:9], v12 offset:0
    ds_read_b64_tr_b16 a[10:11], v12 offset:512
    v_mfma_f32_16x16x32_bf16 v[144:147], a[4:7], a[16:19], v[144:147]
    buffer_load_dwordx4 v18, s[28:31], s64 offen offset:0 lds
    v_mfma_f32_16x16x32_bf16 v[132:135], a[0:3], a[20:23], v[132:135]
    ds_read_b64_tr_b16 a[12:13], v13 offset:0
    ds_read_b64_tr_b16 a[14:15], v13 offset:512
    v_mfma_f32_16x16x32_bf16 v[148:151], a[4:7], a[20:23], v[148:151]
    v_mfma_f32_16x16x32_bf16 v[136:139], a[0:3], a[24:27], v[136:139]
    ds_read_b128 a[32:35], v1 offset:53248
    v_mfma_f32_16x16x32_bf16 v[152:155], a[4:7], a[24:27], v[152:155]
    buffer_load_dwordx4 v19, s[28:31], s64 offen offset:1024 lds
    v_mfma_f32_16x16x32_bf16 v[140:143], a[0:3], a[28:31], v[140:143]
    v_mfma_f32_16x16x32_bf16 v[156:159], a[4:7], a[28:31], v[156:159]
    s_waitcnt vmcnt(14) lgkmcnt(1)
    v_mfma_f32_16x16x32_bf16 v[160:163], a[8:11], a[16:19], v[160:163]
    ds_read_b64_tr_b16 a[0:1], v10 offset:4096
    ds_read_b64_tr_b16 a[2:3], v10 offset:4608
    v_mfma_f32_16x16x32_bf16 v[176:179], a[12:15], a[16:19], v[176:179]
    buffer_load_dwordx4 v20, s[28:31], s64 offen offset:2048 lds
    v_mfma_f32_16x16x32_bf16 v[164:167], a[8:11], a[20:23], v[164:167]
    ds_read_b64_tr_b16 a[4:5], v11 offset:4096
    ds_read_b64_tr_b16 a[6:7], v11 offset:4608
    v_mfma_f32_16x16x32_bf16 v[180:183], a[12:15], a[20:23], v[180:183]
    v_mfma_f32_16x16x32_bf16 v[168:171], a[8:11], a[24:27], v[168:171]
    ds_read_b128 a[36:39], v1 offset:54272
    v_mfma_f32_16x16x32_bf16 v[184:187], a[12:15], a[24:27], v[184:187]
    buffer_load_dwordx4 v21, s[28:31], s64 offen offset:3072 lds
    v_mfma_f32_16x16x32_bf16 v[172:175], a[8:11], a[28:31], v[172:175]
    v_mfma_f32_16x16x32_bf16 v[188:191], a[12:15], a[28:31], v[188:191]
    s_waitcnt lgkmcnt(1)
    v_mfma_f32_16x16x32_bf16 v[192:195], a[0:3], a[16:19], v[192:195]
    s_add_u32 m0, s45, 0
    ds_read_b64_tr_b16 a[8:9], v12 offset:4096
    ds_read_b64_tr_b16 a[10:11], v12 offset:4608
    v_mfma_f32_16x16x32_bf16 v[208:211], a[4:7], a[16:19], v[208:211]
    buffer_load_dwordx4 v18, s[24:27], s65 offen offset:0 lds
    v_mfma_f32_16x16x32_bf16 v[196:199], a[0:3], a[20:23], v[196:199]
    ds_read_b64_tr_b16 a[12:13], v13 offset:4096
    ds_read_b64_tr_b16 a[14:15], v13 offset:4608
    v_mfma_f32_16x16x32_bf16 v[212:215], a[4:7], a[20:23], v[212:215]
    v_mfma_f32_16x16x32_bf16 v[200:203], a[0:3], a[24:27], v[200:203]
    ds_read_b128 a[40:43], v1 offset:55296
    v_mfma_f32_16x16x32_bf16 v[216:219], a[4:7], a[24:27], v[216:219]
    buffer_load_dwordx4 v19, s[24:27], s65 offen offset:1024 lds
    v_mfma_f32_16x16x32_bf16 v[204:207], a[0:3], a[28:31], v[204:207]
    v_mfma_f32_16x16x32_bf16 v[220:223], a[4:7], a[28:31], v[220:223]
    s_waitcnt vmcnt(14) lgkmcnt(1)
    v_mfma_f32_16x16x32_bf16 v[224:227], a[8:11], a[16:19], v[224:227]
    ds_read_b64_tr_b16 a[0:1], v10 offset:8192
    ds_read_b64_tr_b16 a[2:3], v10 offset:8704
    v_mfma_f32_16x16x32_bf16 v[240:243], a[12:15], a[16:19], v[240:243]
    buffer_load_dwordx4 v20, s[24:27], s65 offen offset:2048 lds
    v_mfma_f32_16x16x32_bf16 v[228:231], a[8:11], a[20:23], v[228:231]
    ds_read_b64_tr_b16 a[4:5], v11 offset:8192
    ds_read_b64_tr_b16 a[6:7], v11 offset:8704
    v_mfma_f32_16x16x32_bf16 v[244:247], a[12:15], a[20:23], v[244:247]
    v_mfma_f32_16x16x32_bf16 v[232:235], a[8:11], a[24:27], v[232:235]
    ds_read_b128 a[44:47], v1 offset:56320
    v_mfma_f32_16x16x32_bf16 v[248:251], a[12:15], a[24:27], v[248:251]
    buffer_load_dwordx4 v21, s[24:27], s65 offen offset:3072 lds
    v_mfma_f32_16x16x32_bf16 v[236:239], a[8:11], a[28:31], v[236:239]
    v_mfma_f32_16x16x32_bf16 v[252:255], a[12:15], a[28:31], v[252:255]
    s_waitcnt lgkmcnt(0)
    v_mfma_f32_16x16x32_bf16 v[128:131], a[0:3], a[32:35], v[128:131]
    s_add_u32 m0, s45, 4096
    ds_read_b64_tr_b16 a[8:9], v12 offset:8192
    ds_read_b64_tr_b16 a[10:11], v12 offset:8704
    v_mfma_f32_16x16x32_bf16 v[144:147], a[4:7], a[32:35], v[144:147]
    buffer_load_dwordx4 v18, s[28:31], s65 offen offset:0 lds
    v_mfma_f32_16x16x32_bf16 v[132:135], a[0:3], a[36:39], v[132:135]
    ds_read_b64_tr_b16 a[12:13], v13 offset:8192
    ds_read_b64_tr_b16 a[14:15], v13 offset:8704
    v_mfma_f32_16x16x32_bf16 v[148:151], a[4:7], a[36:39], v[148:151]
    v_mfma_f32_16x16x32_bf16 v[136:139], a[0:3], a[40:43], v[136:139]
    ds_read_b128 a[48:51], v1 offset:57344
    v_mfma_f32_16x16x32_bf16 v[152:155], a[4:7], a[40:43], v[152:155]
    buffer_load_dwordx4 v19, s[28:31], s65 offen offset:1024 lds
    v_mfma_f32_16x16x32_bf16 v[140:143], a[0:3], a[44:47], v[140:143]
    v_mfma_f32_16x16x32_bf16 v[156:159], a[4:7], a[44:47], v[156:159]
    s_waitcnt vmcnt(14) lgkmcnt(1)
    v_mfma_f32_16x16x32_bf16 v[160:163], a[8:11], a[32:35], v[160:163]
    ds_read_b64_tr_b16 a[0:1], v10 offset:12288
    ds_read_b64_tr_b16 a[2:3], v10 offset:12800
    v_mfma_f32_16x16x32_bf16 v[176:179], a[12:15], a[32:35], v[176:179]
    buffer_load_dwordx4 v20, s[28:31], s65 offen offset:2048 lds
    v_mfma_f32_16x16x32_bf16 v[164:167], a[8:11], a[36:39], v[164:167]
    ds_read_b64_tr_b16 a[4:5], v11 offset:12288
    ds_read_b64_tr_b16 a[6:7], v11 offset:12800
    v_mfma_f32_16x16x32_bf16 v[180:183], a[12:15], a[36:39], v[180:183]
    v_mfma_f32_16x16x32_bf16 v[168:171], a[8:11], a[40:43], v[168:171]
    ds_read_b128 a[52:55], v1 offset:58368
    v_mfma_f32_16x16x32_bf16 v[184:187], a[12:15], a[40:43], v[184:187]
    buffer_load_dwordx4 v21, s[28:31], s65 offen offset:3072 lds
    v_mfma_f32_16x16x32_bf16 v[172:175], a[8:11], a[44:47], v[172:175]
    v_mfma_f32_16x16x32_bf16 v[188:191], a[12:15], a[44:47], v[188:191]
    s_waitcnt lgkmcnt(1)
    v_mfma_f32_16x16x32_bf16 v[192:195], a[0:3], a[32:35], v[192:195]
    s_add_u32 m0, s45, 8192
    ds_read_b64_tr_b16 a[8:9], v12 offset:12288
    ds_read_b64_tr_b16 a[10:11], v12 offset:12800
    v_mfma_f32_16x16x32_bf16 v[208:211], a[4:7], a[32:35], v[208:211]
    buffer_load_dwordx4 v22, s[16:19], s66 offen offset:0 lds
    v_mfma_f32_16x16x32_bf16 v[196:199], a[0:3], a[36:39], v[196:199]
    s_add_u32 s50, s66, 128
    ds_read_b64_tr_b16 a[12:13], v13 offset:12288
    ds_read_b64_tr_b16 a[14:15], v13 offset:12800
    v_mfma_f32_16x16x32_bf16 v[212:215], a[4:7], a[36:39], v[212:215]
    v_mfma_f32_16x16x32_bf16 v[200:203], a[0:3], a[40:43], v[200:203]
    ds_read_b128 a[56:59], v1 offset:59392
    v_mfma_f32_16x16x32_bf16 v[216:219], a[4:7], a[40:43], v[216:219]
    buffer_load_dwordx4 v23, s[16:19], s66 offen offset:1024 lds
    v_mfma_f32_16x16x32_bf16 v[204:207], a[0:3], a[44:47], v[204:207]
    v_mfma_f32_16x16x32_bf16 v[220:223], a[4:7], a[44:47], v[220:223]
    s_waitcnt vmcnt(14) lgkmcnt(1)
    v_mfma_f32_16x16x32_bf16 v[224:227], a[8:11], a[32:35], v[224:227]
    ds_read_b64_tr_b16 a[0:1], v10 offset:16384
    ds_read_b64_tr_b16 a[2:3], v10 offset:16896
    v_mfma_f32_16x16x32_bf16 v[240:243], a[12:15], a[32:35], v[240:243]
    buffer_load_dwordx4 v24, s[16:19], s66 offen offset:2048 lds
    v_mfma_f32_16x16x32_bf16 v[228:231], a[8:11], a[36:39], v[228:231]
    ds_read_b64_tr_b16 a[4:5], v11 offset:16384
    ds_read_b64_tr_b16 a[6:7], v11 offset:16896
    v_mfma_f32_16x16x32_bf16 v[244:247], a[12:15], a[36:39], v[244:247]
    v_mfma_f32_16x16x32_bf16 v[232:235], a[8:11], a[40:43], v[232:235]
    ds_read_b128 a[60:63], v1 offset:60416
    v_mfma_f32_16x16x32_bf16 v[248:251], a[12:15], a[40:43], v[248:251]
    buffer_load_dwordx4 v25, s[16:19], s66 offen offset:3072 lds
    v_mfma_f32_16x16x32_bf16 v[236:239], a[8:11], a[44:47], v[236:239]
    v_mfma_f32_16x16x32_bf16 v[252:255], a[12:15], a[44:47], v[252:255]
    s_waitcnt lgkmcnt(0)
    v_mfma_f32_16x16x32_bf16 v[128:131], a[0:3], a[48:51], v[128:131]
    s_add_u32 m0, s45, 12288
    ds_read_b64_tr_b16 a[8:9], v12 offset:16384
    ds_read_b64_tr_b16 a[10:11], v12 offset:16896
    v_mfma_f32_16x16x32_bf16 v[144:147], a[4:7], a[48:51], v[144:147]
    buffer_load_dwordx4 v22, s[16:19], s67 offen offset:0 lds
    v_mfma_f32_16x16x32_bf16 v[132:135], a[0:3], a[52:55], v[132:135]
    s_add_u32 s53, s67, 128
    ds_read_b64_tr_b16 a[12:13], v13 offset:16384
    ds_read_b64_tr_b16 a[14:15], v13 offset:16896
    v_mfma_f32_16x16x32_bf16 v[148:151], a[4:7], a[52:55], v[148:151]
    v_mfma_f32_16x16x32_bf16 v[136:139], a[0:3], a[56:59], v[136:139]
    ds_read_b128 a[64:67], v1 offset:61440
    v_mfma_f32_16x16x32_bf16 v[152:155], a[4:7], a[56:59], v[152:155]
    buffer_load_dwordx4 v23, s[16:19], s67 offen offset:1024 lds
    v_mfma_f32_16x16x32_bf16 v[140:143], a[0:3], a[60:63], v[140:143]
    v_mfma_f32_16x16x32_bf16 v[156:159], a[4:7], a[60:63], v[156:159]
    s_waitcnt vmcnt(14) lgkmcnt(1)
    v_mfma_f32_16x16x32_bf16 v[160:163], a[8:11], a[48:51], v[160:163]
    ds_read_b64_tr_b16 a[0:1], v10 offset:20480
    ds_read_b64_tr_b16 a[2:3], v10 offset:20992
    v_mfma_f32_16x16x32_bf16 v[176:179], a[12:15], a[48:51], v[176:179]
    buffer_load_dwordx4 v24, s[16:19], s67 offen offset:2048 lds
    v_mfma_f32_16x16x32_bf16 v[164:167], a[8:11], a[52:55], v[164:167]
    ds_read_b64_tr_b16 a[4:5], v11 offset:20480
    ds_read_b64_tr_b16 a[6:7], v11 offset:20992
    v_mfma_f32_16x16x32_bf16 v[180:183], a[12:15], a[52:55], v[180:183]
    v_mfma_f32_16x16x32_bf16 v[168:171], a[8:11], a[56:59], v[168:171]
    ds_read_b128 a[68:71], v1 offset:62464
    v_mfma_f32_16x16x32_bf16 v[184:187], a[12:15], a[56:59], v[184:187]
    buffer_load_dwordx4 v25, s[16:19], s67 offen offset:3072 lds
    v_mfma_f32_16x16x32_bf16 v[172:175], a[8:11], a[60:63], v[172:175]
    v_mfma_f32_16x16x32_bf16 v[188:191], a[12:15], a[60:63], v[188:191]
    s_waitcnt lgkmcnt(1)
    v_mfma_f32_16x16x32_bf16 v[192:195], a[0:3], a[48:51], v[192:195]
    s_add_u32 m0, s45, 16384
    ds_read_b64_tr_b16 a[8:9], v12 offset:20480
    ds_read_b64_tr_b16 a[10:11], v12 offset:20992
    v_mfma_f32_16x16x32_bf16 v[208:211], a[4:7], a[48:51], v[208:211]
    buffer_load_dwordx4 v22, s[16:19], s50 offen offset:0 lds
    v_mfma_f32_16x16x32_bf16 v[196:199], a[0:3], a[52:55], v[196:199]
    ds_read_b64_tr_b16 a[12:13], v13 offset:20480
    ds_read_b64_tr_b16 a[14:15], v13 offset:20992
    v_mfma_f32_16x16x32_bf16 v[212:215], a[4:7], a[52:55], v[212:215]
    v_mfma_f32_16x16x32_bf16 v[200:203], a[0:3], a[56:59], v[200:203]
    ds_read_b128 a[72:75], v1 offset:63488
    v_mfma_f32_16x16x32_bf16 v[216:219], a[4:7], a[56:59], v[216:219]
    buffer_load_dwordx4 v23, s[16:19], s50 offen offset:1024 lds
    v_mfma_f32_16x16x32_bf16 v[204:207], a[0:3], a[60:63], v[204:207]
    v_mfma_f32_16x16x32_bf16 v[220:223], a[4:7], a[60:63], v[220:223]
    s_waitcnt vmcnt(14) lgkmcnt(1)
    v_mfma_f32_16x16x32_bf16 v[224:227], a[8:11], a[48:51], v[224:227]
    ds_read_b64_tr_b16 a[0:1], v10 offset:0
    ds_read_b64_tr_b16 a[2:3], v10 offset:512
    v_mfma_f32_16x16x32_bf16 v[240:243], a[12:15], a[48:51], v[240:243]
    buffer_load_dwordx4 v24, s[16:19], s50 offen offset:2048 lds
    v_mfma_f32_16x16x32_bf16 v[228:231], a[8:11], a[52:55], v[228:231]
    ds_read_b64_tr_b16 a[4:5], v11 offset:0
    ds_read_b64_tr_b16 a[6:7], v11 offset:512
    v_mfma_f32_16x16x32_bf16 v[244:247], a[12:15], a[52:55], v[244:247]
    v_mfma_f32_16x16x32_bf16 v[232:235], a[8:11], a[56:59], v[232:235]
    ds_read_b128 a[76:79], v1 offset:64512
    v_mfma_f32_16x16x32_bf16 v[248:251], a[12:15], a[56:59], v[248:251]
    buffer_load_dwordx4 v25, s[16:19], s50 offen offset:3072 lds
    v_mfma_f32_16x16x32_bf16 v[236:239], a[8:11], a[60:63], v[236:239]
    v_mfma_f32_16x16x32_bf16 v[252:255], a[12:15], a[60:63], v[252:255]
    s_waitcnt lgkmcnt(0)
    v_mfma_f32_16x16x32_bf16 v[128:131], a[0:3], a[64:67], v[128:131]
    s_add_u32 m0, s45, 20480
    ds_read_b64_tr_b16 a[8:9], v12 offset:0
    ds_read_b64_tr_b16 a[10:11], v12 offset:512
    v_mfma_f32_16x16x32_bf16 v[144:147], a[4:7], a[64:67], v[144:147]
    buffer_load_dwordx4 v22, s[16:19], s53 offen offset:0 lds
    v_mfma_f32_16x16x32_bf16 v[132:135], a[0:3], a[68:71], v[132:135]
    s_add_u32 s66, s66, 524288
    ds_read_b64_tr_b16 a[12:13], v13 offset:0
    ds_read_b64_tr_b16 a[14:15], v13 offset:512
    v_mfma_f32_16x16x32_bf16 v[148:151], a[4:7], a[68:71], v[148:151]
    s_sub_u32 s48, s66, 4194304
    v_mfma_f32_16x16x32_bf16 v[136:139], a[0:3], a[72:75], v[136:139]
    s_min_u32 s66, s66, s48
    ds_read_b128 a[16:19], v1 offset:0
    ds_read_b128 a[20:23], v1 offset:1024
    v_mfma_f32_16x16x32_bf16 v[152:155], a[4:7], a[72:75], v[152:155]
    buffer_load_dwordx4 v23, s[16:19], s53 offen offset:1024 lds
    v_mfma_f32_16x16x32_bf16 v[140:143], a[0:3], a[76:79], v[140:143]
    v_mfma_f32_16x16x32_bf16 v[156:159], a[4:7], a[76:79], v[156:159]
    s_waitcnt vmcnt(14) lgkmcnt(2)
    v_mfma_f32_16x16x32_bf16 v[160:163], a[8:11], a[64:67], v[160:163]
    ds_read_b64_tr_b16 a[0:1], v10 offset:4096
    ds_read_b64_tr_b16 a[2:3], v10 offset:4608
    v_mfma_f32_16x16x32_bf16 v[176:179], a[12:15], a[64:67], v[176:179]
    buffer_load_dwordx4 v24, s[16:19], s53 offen offset:2048 lds
    v_mfma_f32_16x16x32_bf16 v[164:167], a[8:11], a[68:71], v[164:167]
    ds_read_b64_tr_b16 a[4:5], v11 offset:4096
    ds_read_b64_tr_b16 a[6:7], v11 offset:4608
    v_mfma_f32_16x16x32_bf16 v[180:183], a[12:15], a[68:71], v[180:183]
    v_mfma_f32_16x16x32_bf16 v[168:171], a[8:11], a[72:75], v[168:171]
    ds_read_b128 a[24:27], v1 offset:2048
    ds_read_b128 a[28:31], v1 offset:3072
    v_mfma_f32_16x16x32_bf16 v[184:187], a[12:15], a[72:75], v[184:187]
    buffer_load_dwordx4 v25, s[16:19], s53 offen offset:3072 lds
    v_mfma_f32_16x16x32_bf16 v[172:175], a[8:11], a[76:79], v[172:175]
    v_mfma_f32_16x16x32_bf16 v[188:191], a[12:15], a[76:79], v[188:191]
    s_waitcnt lgkmcnt(2)
    v_mfma_f32_16x16x32_bf16 v[192:195], a[0:3], a[64:67], v[192:195]
    s_add_u32 m0, s45, 0
    ds_read_b64_tr_b16 a[8:9], v12 offset:4096
    ds_read_b64_tr_b16 a[10:11], v12 offset:4608
    v_mfma_f32_16x16x32_bf16 v[208:211], a[4:7], a[64:67], v[208:211]
    buffer_load_dwordx4 v22, s[16:19], s66 offen offset:0 lds
    v_mfma_f32_16x16x32_bf16 v[196:199], a[0:3], a[68:71], v[196:199]
    s_add_u32 s67, s67, 524288
    ds_read_b64_tr_b16 a[12:13], v13 offset:4096
    ds_read_b64_tr_b16 a[14:15], v13 offset:4608
    v_mfma_f32_16x16x32_bf16 v[212:215], a[4:7], a[68:71], v[212:215]
    s_sub_u32 s48, s67, 4194304
    v_mfma_f32_16x16x32_bf16 v[200:203], a[0:3], a[72:75], v[200:203]
    s_min_u32 s67, s67, s48
    ds_read_b128 a[32:35], v1 offset:4096
    ds_read_b128 a[36:39], v1 offset:5120
    v_mfma_f32_16x16x32_bf16 v[216:219], a[4:7], a[72:75], v[216:219]
    buffer_load_dwordx4 v23, s[16:19], s66 offen offset:1024 lds
    v_mfma_f32_16x16x32_bf16 v[204:207], a[0:3], a[76:79], v[204:207]
    s_add_u32 s50, s66, 128
    v_mfma_f32_16x16x32_bf16 v[220:223], a[4:7], a[76:79], v[220:223]
    s_waitcnt vmcnt(10) lgkmcnt(2)
    v_mfma_f32_16x16x32_bf16 v[224:227], a[8:11], a[64:67], v[224:227]
    ds_read_b64_tr_b16 a[0:1], v10 offset:8192
    ds_read_b64_tr_b16 a[2:3], v10 offset:8704
    v_mfma_f32_16x16x32_bf16 v[240:243], a[12:15], a[64:67], v[240:243]
    buffer_load_dwordx4 v24, s[16:19], s66 offen offset:2048 lds
    v_mfma_f32_16x16x32_bf16 v[228:231], a[8:11], a[68:71], v[228:231]
    ds_read_b64_tr_b16 a[4:5], v10 offset:12288
    ds_read_b64_tr_b16 a[6:7], v10 offset:12800
    v_mfma_f32_16x16x32_bf16 v[244:247], a[12:15], a[68:71], v[244:247]
    v_mfma_f32_16x16x32_bf16 v[232:235], a[8:11], a[72:75], v[232:235]
    ds_read_b128 a[40:43], v1 offset:6144
    ds_read_b128 a[44:47], v1 offset:7168
    v_mfma_f32_16x16x32_bf16 v[248:251], a[12:15], a[72:75], v[248:251]
    buffer_load_dwordx4 v25, s[16:19], s66 offen offset:3072 lds
    v_mfma_f32_16x16x32_bf16 v[236:239], a[8:11], a[76:79], v[236:239]
    v_mfma_f32_16x16x32_bf16 v[252:255], a[12:15], a[76:79], v[252:255]
    s_waitcnt lgkmcnt(0)
    v_mfma_f32_16x16x32_bf16 a[128:131], a[0:3], a[16:19], 0
    s_add_u32 m0, s45, 4096
    ds_read_b64_tr_b16 a[8:9], v11 offset:8192
    ds_read_b64_tr_b16 a[10:11], v11 offset:8704
    v_mfma_f32_16x16x32_bf16 a[128:131], a[4:7], a[32:35], a[128:131]
    buffer_load_dwordx4 v22, s[16:19], s67 offen offset:0 lds
    v_mul_f32 v128, s44, v128
    v_mfma_f32_16x16x32_bf16 a[132:135], a[0:3], a[20:23], 0
    s_add_u32 s53, s67, 128
    ds_read_b64_tr_b16 a[12:13], v11 offset:12288
    ds_read_b64_tr_b16 a[14:15], v11 offset:12800
    v_mfma_f32_16x16x32_bf16 a[132:135], a[4:7], a[36:39], a[132:135]
    v_exp_f32 v128, v128
    v_mfma_f32_16x16x32_bf16 a[136:139], a[0:3], a[24:27], 0
    ds_read_b128 a[48:51], v1 offset:8192
    v_mul_f32 v129, s44, v129
    v_mfma_f32_16x16x32_bf16 a[136:139], a[4:7], a[40:43], a[136:139]
    buffer_load_dwordx4 v23, s[16:19], s67 offen offset:1024 lds
    v_mul_f32 v130, s44, v130
    v_mfma_f32_16x16x32_bf16 a[140:143], a[0:3], a[28:31], 0
    v_exp_f32 v129, v129
    v_mfma_f32_16x16x32_bf16 a[140:143], a[4:7], a[44:47], a[140:143]
    s_waitcnt lgkmcnt(1)
    v_exp_f32 v130, v130
    v_mfma_f32_16x16x32_bf16 a[144:147], a[8:11], a[16:19], 0
    ds_read_b64_tr_b16 a[0:1], v12 offset:8192
    ds_read_b64_tr_b16 a[2:3], v12 offset:8704
    v_mfma_f32_16x16x32_bf16 a[144:147], a[12:15], a[32:35], a[144:147]
    buffer_load_dwordx4 v24, s[16:19], s67 offen offset:2048 lds
    v_mul_f32 v131, s44, v131
    v_mfma_f32_16x16x32_bf16 a[148:151], a[8:11], a[20:23], 0
    ds_read_b64_tr_b16 a[4:5], v12 offset:12288
    ds_read_b64_tr_b16 a[6:7], v12 offset:12800
    v_mfma_f32_16x16x32_bf16 a[148:151], a[12:15], a[36:39], a[148:151]
    v_exp_f32 v131, v131
    v_mfma_f32_16x16x32_bf16 a[152:155], a[8:11], a[24:27], 0
    ds_read_b128 a[52:55], v1 offset:9216
    v_fma_f32 v128, v128, s62, s62
    v_mfma_f32_16x16x32_bf16 a[152:155], a[12:15], a[40:43], a[152:155]
    buffer_load_dwordx4 v25, s[16:19], s67 offen offset:3072 lds
    v_fma_f32 v129, v129, s62, s62
    v_mfma_f32_16x16x32_bf16 a[156:159], a[8:11], a[28:31], 0
    v_rcp_f32 v128, v128
    v_mfma_f32_16x16x32_bf16 a[156:159], a[12:15], a[44:47], a[156:159]
    s_waitcnt lgkmcnt(1)
    v_rcp_f32 v129, v129
    v_mfma_f32_16x16x32_bf16 a[160:163], a[0:3], a[16:19], 0
    ds_read_b64_tr_b16 a[8:9], v13 offset:8192
    ds_read_b64_tr_b16 a[10:11], v13 offset:8704
    v_mfma_f32_16x16x32_bf16 a[160:163], a[4:7], a[32:35], a[160:163]
    v_fma_f32 v130, v130, s62, s62
    v_fma_f32 v131, v131, s62, s62
    v_mfma_f32_16x16x32_bf16 a[164:167], a[0:3], a[20:23], 0
    ds_read_b64_tr_b16 a[12:13], v13 offset:12288
    ds_read_b64_tr_b16 a[14:15], v13 offset:12800
    v_mfma_f32_16x16x32_bf16 a[164:167], a[4:7], a[36:39], a[164:167]
    v_rcp_f32 v130, v130
    v_mfma_f32_16x16x32_bf16 a[168:171], a[0:3], a[24:27], 0
    ds_read_b128 a[56:59], v1 offset:10240
    v_mul_f32 v128, v128, v192
    v_mfma_f32_16x16x32_bf16 a[168:171], a[4:7], a[40:43], a[168:171]
    v_rcp_f32 v131, v131
    v_mfma_f32_16x16x32_bf16 a[172:175], a[0:3], a[28:31], 0
    v_mul_f32 v129, v129, v193
    v_mfma_f32_16x16x32_bf16 a[172:175], a[4:7], a[44:47], a[172:175]
    s_waitcnt vmcnt(8) lgkmcnt(1)
    v_mfma_f32_16x16x32_bf16 a[176:179], a[8:11], a[16:19], 0
    ds_read_b64_tr_b16 a[0:1], v10 offset:16384
    ds_read_b64_tr_b16 a[2:3], v10 offset:16896
    v_mfma_f32_16x16x32_bf16 a[176:179], a[12:15], a[32:35], a[176:179]
    v_mul_f32 v130, v130, v194
    v_mul_f32 v131, v131, v195
    v_mfma_f32_16x16x32_bf16 a[180:183], a[8:11], a[20:23], 0
    ds_read_b64_tr_b16 a[4:5], v10 offset:20480
    ds_read_b64_tr_b16 a[6:7], v10 offset:20992
    v_mfma_f32_16x16x32_bf16 a[180:183], a[12:15], a[36:39], a[180:183]
    v_cvt_pk_bf16_f32 v64, v128, v129
    v_cvt_pk_bf16_f32 v65, v130, v131
    v_mfma_f32_16x16x32_bf16 a[184:187], a[8:11], a[24:27], 0
    ds_read_b128 a[60:63], v1 offset:11264
    v_mul_f32 v144, s44, v144
    v_mfma_f32_16x16x32_bf16 a[184:187], a[12:15], a[40:43], a[184:187]
    v_exp_f32 v144, v144
    v_mfma_f32_16x16x32_bf16 a[188:191], a[8:11], a[28:31], 0
    v_mul_f32 v145, s44, v145
    v_mul_f32 v146, s44, v146
    v_mfma_f32_16x16x32_bf16 a[188:191], a[12:15], a[44:47], a[188:191]
    s_waitcnt lgkmcnt(1)
    v_mfma_f32_16x16x32_bf16 a[192:195], a[0:3], a[16:19], 0
    s_add_u32 m0, s45, 8192
    ds_read_b64_tr_b16 a[8:9], v11 offset:16384
    ds_read_b64_tr_b16 a[10:11], v11 offset:16896
    v_mfma_f32_16x16x32_bf16 a[192:195], a[4:7], a[32:35], a[192:195]
    buffer_load_dwordx4 v22, s[16:19], s50 offen offset:0 lds
    v_mul_f32 v147, s44, v147
    v_mfma_f32_16x16x32_bf16 a[196:199], a[0:3], a[20:23], 0
    ds_read_b64_tr_b16 a[12:13], v11 offset:20480
    ds_read_b64_tr_b16 a[14:15], v11 offset:20992
    v_mfma_f32_16x16x32_bf16 a[196:199], a[4:7], a[36:39], a[196:199]
    v_exp_f32 v145, v145
    v_mfma_f32_16x16x32_bf16 a[200:203], a[0:3], a[24:27], 0
    ds_read_b128 a[64:67], v1 offset:12288
    v_fma_f32 v144, v144, s62, s62
    v_mfma_f32_16x16x32_bf16 a[200:203], a[4:7], a[40:43], a[200:203]
    buffer_load_dwordx4 v23, s[16:19], s50 offen offset:1024 lds
    v_fma_f32 v145, v145, s62, s62
    v_mfma_f32_16x16x32_bf16 a[204:207], a[0:3], a[28:31], 0
    v_exp_f32 v146, v146
    v_mfma_f32_16x16x32_bf16 a[204:207], a[4:7], a[44:47], a[204:207]
    s_waitcnt lgkmcnt(1)
    v_exp_f32 v147, v147
    v_mfma_f32_16x16x32_bf16 a[208:211], a[8:11], a[16:19], 0
    ds_read_b64_tr_b16 a[0:1], v12 offset:16384
    ds_read_b64_tr_b16 a[2:3], v12 offset:16896
    v_mfma_f32_16x16x32_bf16 a[208:211], a[12:15], a[32:35], a[208:211]
    buffer_load_dwordx4 v24, s[16:19], s50 offen offset:2048 lds
    v_fma_f32 v146, v146, s62, s62
    v_mfma_f32_16x16x32_bf16 a[212:215], a[8:11], a[20:23], 0
    ds_read_b64_tr_b16 a[4:5], v12 offset:20480
    ds_read_b64_tr_b16 a[6:7], v12 offset:20992
    v_mfma_f32_16x16x32_bf16 a[212:215], a[12:15], a[36:39], a[212:215]
    v_rcp_f32 v144, v144
    v_mfma_f32_16x16x32_bf16 a[216:219], a[8:11], a[24:27], 0
    ds_read_b128 a[68:71], v1 offset:13312
    v_fma_f32 v147, v147, s62, s62
    v_mfma_f32_16x16x32_bf16 a[216:219], a[12:15], a[40:43], a[216:219]
    buffer_load_dwordx4 v25, s[16:19], s50 offen offset:3072 lds
    v_mul_f32 v144, v144, v208
    v_mfma_f32_16x16x32_bf16 a[220:223], a[8:11], a[28:31], 0
    v_rcp_f32 v145, v145
    v_mfma_f32_16x16x32_bf16 a[220:223], a[12:15], a[44:47], a[220:223]
    s_waitcnt lgkmcnt(1)
    v_rcp_f32 v146, v146
    v_mfma_f32_16x16x32_bf16 a[224:227], a[0:3], a[16:19], 0
    s_add_u32 m0, s45, 12288
    ds_read_b64_tr_b16 a[8:9], v13 offset:16384
    ds_read_b64_tr_b16 a[10:11], v13 offset:16896
    v_mfma_f32_16x16x32_bf16 a[224:227], a[4:7], a[32:35], a[224:227]
    buffer_load_dwordx4 v22, s[16:19], s53 offen offset:0 lds
    v_mul_f32 v145, v145, v209
    v_mfma_f32_16x16x32_bf16 a[228:231], a[0:3], a[20:23], 0
    s_add_u32 s66, s66, 524288
    ds_read_b64_tr_b16 a[12:13], v13 offset:20480
    ds_read_b64_tr_b16 a[14:15], v13 offset:20992
    v_mfma_f32_16x16x32_bf16 a[228:231], a[4:7], a[36:39], a[228:231]
    s_sub_u32 s48, s66, 4194304
    v_rcp_f32 v147, v147
    v_mfma_f32_16x16x32_bf16 a[232:235], a[0:3], a[24:27], 0
    s_min_u32 s66, s66, s48
    ds_read_b128 a[72:75], v1 offset:14336
    v_mul_f32 v146, v146, v210
    v_mfma_f32_16x16x32_bf16 a[232:235], a[4:7], a[40:43], a[232:235]
    buffer_load_dwordx4 v23, s[16:19], s53 offen offset:1024 lds
    v_mul_f32 v147, v147, v211
    v_mfma_f32_16x16x32_bf16 a[236:239], a[0:3], a[28:31], 0
    v_cvt_pk_bf16_f32 v66, v144, v145
    v_cvt_pk_bf16_f32 v67, v146, v147
    v_mfma_f32_16x16x32_bf16 a[236:239], a[4:7], a[44:47], a[236:239]
    s_waitcnt vmcnt(6) lgkmcnt(1)
    v_mfma_f32_16x16x32_bf16 a[240:243], a[8:11], a[16:19], 0
    ds_read_b64_tr_b16 a[0:1], v10 offset:0
    ds_read_b64_tr_b16 a[2:3], v10 offset:512
    v_mfma_f32_16x16x32_bf16 a[240:243], a[12:15], a[32:35], a[240:243]
    buffer_load_dwordx4 v24, s[16:19], s53 offen offset:2048 lds
    v_mul_f32 v132, s44, v132
    v_mfma_f32_16x16x32_bf16 a[244:247], a[8:11], a[20:23], 0
    ds_read_b64_tr_b16 a[4:5], v10 offset:4096
    ds_read_b64_tr_b16 a[6:7], v10 offset:4608
    v_mfma_f32_16x16x32_bf16 a[244:247], a[12:15], a[36:39], a[244:247]
    v_exp_f32 v132, v132
    v_mfma_f32_16x16x32_bf16 a[248:251], a[8:11], a[24:27], 0
    ds_read_b128 a[76:79], v1 offset:15360
    v_mul_f32 v133, s44, v133
    v_mfma_f32_16x16x32_bf16 a[248:251], a[12:15], a[40:43], a[248:251]
    buffer_load_dwordx4 v25, s[16:19], s53 offen offset:3072 lds
    v_mul_f32 v134, s44, v134
    v_mfma_f32_16x16x32_bf16 a[252:255], a[8:11], a[28:31], 0
    v_exp_f32 v133, v133
    v_mfma_f32_16x16x32_bf16 a[252:255], a[12:15], a[44:47], a[252:255]
    s_waitcnt lgkmcnt(0)
    v_exp_f32 v134, v134
    v_mfma_f32_16x16x32_bf16 a[128:131], a[0:3], a[48:51], a[128:131]
    s_add_u32 m0, s45, 16384
    ds_read_b64_tr_b16 a[8:9], v11 offset:0
    ds_read_b64_tr_b16 a[10:11], v11 offset:512
    v_mfma_f32_16x16x32_bf16 a[128:131], a[4:7], a[64:67], a[128:131]
    buffer_load_dwordx4 v22, s[16:19], s66 offen offset:0 lds
    v_mul_f32 v135, s44, v135
    v_mfma_f32_16x16x32_bf16 a[132:135], a[0:3], a[52:55], a[132:135]
    s_add_u32 s67, s67, 524288
    ds_read_b64_tr_b16 a[12:13], v11 offset:4096
    ds_read_b64_tr_b16 a[14:15], v11 offset:4608
    v_mfma_f32_16x16x32_bf16 a[132:135], a[4:7], a[68:71], a[132:135]
    s_sub_u32 s48, s67, 4194304
    v_exp_f32 v135, v135
    v_mfma_f32_16x16x32_bf16 a[136:139], a[0:3], a[56:59], a[136:139]
    s_min_u32 s67, s67, s48
    ds_read_b128 a[16:19], v1 offset:16384
    v_fma_f32 v132, v132, s62, s62
    v_mfma_f32_16x16x32_bf16 a[136:139], a[4:7], a[72:75], a[136:139]
    buffer_load_dwordx4 v23, s[16:19], s66 offen offset:1024 lds
    v_fma_f32 v133, v133, s62, s62
    v_mfma_f32_16x16x32_bf16 a[140:143], a[0:3], a[60:63], a[140:143]
    s_add_u32 s50, s66, 128
    v_rcp_f32 v132, v132
    v_mfma_f32_16x16x32_bf16 a[140:143], a[4:7], a[76:79], a[140:143]
    s_waitcnt lgkmcnt(1)
    v_rcp_f32 v133, v133
    v_mfma_f32_16x16x32_bf16 a[144:147], a[8:11], a[48:51], a[144:147]
    ds_read_b64_tr_b16 a[0:1], v12 offset:0
    ds_read_b64_tr_b16 a[2:3], v12 offset:512
    v_mfma_f32_16x16x32_bf16 a[144:147], a[12:15], a[64:67], a[144:147]
    buffer_load_dwordx4 v24, s[16:19], s66 offen offset:2048 lds
    v_fma_f32 v134, v134, s62, s62
    v_mfma_f32_16x16x32_bf16 a[148:151], a[8:11], a[52:55], a[148:151]
    ds_read_b64_tr_b16 a[4:5], v12 offset:4096
    ds_read_b64_tr_b16 a[6:7], v12 offset:4608
    v_mfma_f32_16x16x32_bf16 a[148:151], a[12:15], a[68:71], a[148:151]
    v_rcp_f32 v134, v134
    v_mfma_f32_16x16x32_bf16 a[152:155], a[8:11], a[56:59], a[152:155]
    ds_read_b128 a[20:23], v1 offset:17408
    v_fma_f32 v135, v135, s62, s62
    v_mfma_f32_16x16x32_bf16 a[152:155], a[12:15], a[72:75], a[152:155]
    buffer_load_dwordx4 v25, s[16:19], s66 offen offset:3072 lds
    v_mul_f32 v132, v132, v196
    v_mfma_f32_16x16x32_bf16 a[156:159], a[8:11], a[60:63], a[156:159]
    v_rcp_f32 v135, v135
    v_mfma_f32_16x16x32_bf16 a[156:159], a[12:15], a[76:79], a[156:159]
    s_waitcnt lgkmcnt(1)
    v_mul_f32 v133, v133, v197
    v_mfma_f32_16x16x32_bf16 a[160:163], a[0:3], a[48:51], a[160:163]
    s_add_u32 m0, s45, 20480
    ds_read_b64_tr_b16 a[8:9], v13 offset:0
    ds_read_b64_tr_b16 a[10:11], v13 offset:512
    v_mfma_f32_16x16x32_bf16 a[160:163], a[4:7], a[64:67], a[160:163]
    buffer_load_dwordx4 v22, s[16:19], s67 offen offset:0 lds
    v_mul_f32 v134, v134, v198
    v_mfma_f32_16x16x32_bf16 a[164:167], a[0:3], a[52:55], a[164:167]
    s_add_u32 s53, s67, 128
    ds_read_b64_tr_b16 a[12:13], v13 offset:4096
    ds_read_b64_tr_b16 a[14:15], v13 offset:4608
    v_mfma_f32_16x16x32_bf16 a[164:167], a[4:7], a[68:71], a[164:167]
    v_mul_f32 v135, v135, v199
    v_cvt_pk_bf16_f32 v68, v132, v133
    v_mfma_f32_16x16x32_bf16 a[168:171], a[0:3], a[56:59], a[168:171]
    ds_read_b128 a[24:27], v1 offset:18432
    v_cvt_pk_bf16_f32 v69, v134, v135
    v_mfma_f32_16x16x32_bf16 a[168:171], a[4:7], a[72:75], a[168:171]
    buffer_load_dwordx4 v23, s[16:19], s67 offen offset:1024 lds
    v_mul_f32 v148, s44, v148
    v_mfma_f32_16x16x32_bf16 a[172:175], a[0:3], a[60:63], a[172:175]
    v_exp_f32 v148, v148
    v_mfma_f32_16x16x32_bf16 a[172:175], a[4:7], a[76:79], a[172:175]
    s_waitcnt vmcnt(6) lgkmcnt(1)
    v_mul_f32 v149, s44, v149
    v_mul_f32 v150, s44, v150
    v_mfma_f32_16x16x32_bf16 a[176:179], a[8:11], a[48:51], a[176:179]
    ds_read_b64_tr_b16 a[0:1], v10 offset:8192
    ds_read_b64_tr_b16 a[2:3], v10 offset:8704
    v_mfma_f32_16x16x32_bf16 a[176:179], a[12:15], a[64:67], a[176:179]
    buffer_load_dwordx4 v24, s[16:19], s67 offen offset:2048 lds
    v_mul_f32 v151, s44, v151
    v_mfma_f32_16x16x32_bf16 a[180:183], a[8:11], a[52:55], a[180:183]
    ds_read_b64_tr_b16 a[4:5], v10 offset:12288
    ds_read_b64_tr_b16 a[6:7], v10 offset:12800
    v_mfma_f32_16x16x32_bf16 a[180:183], a[12:15], a[68:71], a[180:183]
    v_exp_f32 v149, v149
    v_mfma_f32_16x16x32_bf16 a[184:187], a[8:11], a[56:59], a[184:187]
    ds_read_b128 a[28:31], v1 offset:19456
    v_fma_f32 v148, v148, s62, s62
    v_mfma_f32_16x16x32_bf16 a[184:187], a[12:15], a[72:75], a[184:187]
    buffer_load_dwordx4 v25, s[16:19], s67 offen offset:3072 lds
    v_fma_f32 v149, v149, s62, s62
    v_mfma_f32_16x16x32_bf16 a[188:191], a[8:11], a[60:63], a[188:191]
    v_exp_f32 v150, v150
    v_mfma_f32_16x16x32_bf16 a[188:191], a[12:15], a[76:79], a[188:191]
    s_waitcnt lgkmcnt(1)
    v_exp_f32 v151, v151
    v_mfma_f32_16x16x32_bf16 a[192:195], a[0:3], a[48:51], a[192:195]
    s_add_u32 m0, s45, 0
    ds_read_b64_tr_b16 a[8:9], v11 offset:8192
    ds_read_b64_tr_b16 a[10:11], v11 offset:8704
    v_mfma_f32_16x16x32_bf16 a[192:195], a[4:7], a[64:67], a[192:195]
    buffer_load_dwordx4 v22, s[16:19], s50 offen offset:0 lds
    v_fma_f32 v150, v150, s62, s62
    v_mfma_f32_16x16x32_bf16 a[196:199], a[0:3], a[52:55], a[196:199]
    ds_read_b64_tr_b16 a[12:13], v11 offset:12288
    ds_read_b64_tr_b16 a[14:15], v11 offset:12800
    v_mfma_f32_16x16x32_bf16 a[196:199], a[4:7], a[68:71], a[196:199]
    v_rcp_f32 v148, v148
    v_mfma_f32_16x16x32_bf16 a[200:203], a[0:3], a[56:59], a[200:203]
    ds_read_b128 a[32:35], v1 offset:20480
    v_fma_f32 v151, v151, s62, s62
    v_mfma_f32_16x16x32_bf16 a[200:203], a[4:7], a[72:75], a[200:203]
    buffer_load_dwordx4 v23, s[16:19], s50 offen offset:1024 lds
    v_mul_f32 v148, v148, v212
    v_mfma_f32_16x16x32_bf16 a[204:207], a[0:3], a[60:63], a[204:207]
    v_rcp_f32 v149, v149
    v_mfma_f32_16x16x32_bf16 a[204:207], a[4:7], a[76:79], a[204:207]
    s_waitcnt lgkmcnt(1)
    v_rcp_f32 v150, v150
    v_mfma_f32_16x16x32_bf16 a[208:211], a[8:11], a[48:51], a[208:211]
    ds_read_b64_tr_b16 a[0:1], v12 offset:8192
    ds_read_b64_tr_b16 a[2:3], v12 offset:8704
    v_mfma_f32_16x16x32_bf16 a[208:211], a[12:15], a[64:67], a[208:211]
    buffer_load_dwordx4 v24, s[16:19], s50 offen offset:2048 lds
    v_mul_f32 v149, v149, v213
    v_mfma_f32_16x16x32_bf16 a[212:215], a[8:11], a[52:55], a[212:215]
    ds_read_b64_tr_b16 a[4:5], v12 offset:12288
    ds_read_b64_tr_b16 a[6:7], v12 offset:12800
    v_mfma_f32_16x16x32_bf16 a[212:215], a[12:15], a[68:71], a[212:215]
    v_rcp_f32 v151, v151
    v_mfma_f32_16x16x32_bf16 a[216:219], a[8:11], a[56:59], a[216:219]
    ds_read_b128 a[36:39], v1 offset:21504
    v_mul_f32 v150, v150, v214
    v_mfma_f32_16x16x32_bf16 a[216:219], a[12:15], a[72:75], a[216:219]
    buffer_load_dwordx4 v25, s[16:19], s50 offen offset:3072 lds
    v_mul_f32 v151, v151, v215
    v_mfma_f32_16x16x32_bf16 a[220:223], a[8:11], a[60:63], a[220:223]
    v_cvt_pk_bf16_f32 v70, v148, v149
    v_cvt_pk_bf16_f32 v71, v150, v151
    v_mfma_f32_16x16x32_bf16 a[220:223], a[12:15], a[76:79], a[220:223]
    s_waitcnt lgkmcnt(1)
    v_mfma_f32_16x16x32_bf16 a[224:227], a[0:3], a[48:51], a[224:227]
    s_add_u32 m0, s45, 4096
    ds_read_b64_tr_b16 a[8:9], v13 offset:8192
    ds_read_b64_tr_b16 a[10:11], v13 offset:8704
    v_mfma_f32_16x16x32_bf16 a[224:227], a[4:7], a[64:67], a[224:227]
    buffer_load_dwordx4 v22, s[16:19], s53 offen offset:0 lds
    v_mul_f32 v136, s44, v136
    v_mfma_f32_16x16x32_bf16 a[228:231], a[0:3], a[52:55], a[228:231]
    s_add_u32 s66, s66, 524288
    ds_read_b64_tr_b16 a[12:13], v13 offset:12288
    ds_read_b64_tr_b16 a[14:15], v13 offset:12800
    v_mfma_f32_16x16x32_bf16 a[228:231], a[4:7], a[68:71], a[228:231]
    s_sub_u32 s48, s66, 4194304
    v_exp_f32 v136, v136
    v_mfma_f32_16x16x32_bf16 a[232:235], a[0:3], a[56:59], a[232:235]
    s_min_u32 s66, s66, s48
    ds_read_b128 a[40:43], v1 offset:22528
    v_mul_f32 v137, s44, v137
    v_mfma_f32_16x16x32_bf16 a[232:235], a[4:7], a[72:75], a[232:235]
    buffer_load_dwordx4 v23, s[16:19], s53 offen offset:1024 lds
    v_mul_f32 v138, s44, v138
    v_mfma_f32_16x16x32_bf16 a[236:239], a[0:3], a[60:63], a[236:239]
    v_exp_f32 v137, v137
    v_mfma_f32_16x16x32_bf16 a[236:239], a[4:7], a[76:79], a[236:239]
    s_waitcnt vmcnt(6) lgkmcnt(1)
    v_exp_f32 v138, v138
    v_mfma_f32_16x16x32_bf16 a[240:243], a[8:11], a[48:51], a[240:243]
    ds_read_b64_tr_b16 a[0:1], v10 offset:16384
    ds_read_b64_tr_b16 a[2:3], v10 offset:16896
    v_mfma_f32_16x16x32_bf16 a[240:243], a[12:15], a[64:67], a[240:243]
    buffer_load_dwordx4 v24, s[16:19], s53 offen offset:2048 lds
    v_mul_f32 v139, s44, v139
    v_mfma_f32_16x16x32_bf16 a[244:247], a[8:11], a[52:55], a[244:247]
    ds_read_b64_tr_b16 a[4:5], v10 offset:20480
    ds_read_b64_tr_b16 a[6:7], v10 offset:20992
    v_mfma_f32_16x16x32_bf16 a[244:247], a[12:15], a[68:71], a[244:247]
    v_exp_f32 v139, v139
    v_mfma_f32_16x16x32_bf16 a[248:251], a[8:11], a[56:59], a[248:251]
    ds_read_b128 a[44:47], v1 offset:23552
    v_fma_f32 v136, v136, s62, s62
    v_mfma_f32_16x16x32_bf16 a[248:251], a[12:15], a[72:75], a[248:251]
    buffer_load_dwordx4 v25, s[16:19], s53 offen offset:3072 lds
    v_fma_f32 v137, v137, s62, s62
    v_mfma_f32_16x16x32_bf16 a[252:255], a[8:11], a[60:63], a[252:255]
    v_rcp_f32 v136, v136
    v_mfma_f32_16x16x32_bf16 a[252:255], a[12:15], a[76:79], a[252:255]
    s_waitcnt lgkmcnt(0)
    v_rcp_f32 v137, v137
    v_mfma_f32_16x16x32_bf16 a[128:131], a[0:3], a[16:19], a[128:131]
    s_add_u32 m0, s45, 8192
    ds_read_b64_tr_b16 a[8:9], v11 offset:16384
    ds_read_b64_tr_b16 a[10:11], v11 offset:16896
    v_mfma_f32_16x16x32_bf16 a[128:131], a[4:7], a[32:35], a[128:131]
    buffer_load_dwordx4 v22, s[16:19], s66 offen offset:0 lds
    v_fma_f32 v138, v138, s62, s62
    v_mfma_f32_16x16x32_bf16 a[132:135], a[0:3], a[20:23], a[132:135]
    s_add_u32 s67, s67, 524288
    ds_read_b64_tr_b16 a[12:13], v11 offset:20480
    ds_read_b64_tr_b16 a[14:15], v11 offset:20992
    v_mfma_f32_16x16x32_bf16 a[132:135], a[4:7], a[36:39], a[132:135]
    s_sub_u32 s48, s67, 4194304
    v_rcp_f32 v138, v138
    v_mfma_f32_16x16x32_bf16 a[136:139], a[0:3], a[24:27], a[136:139]
    s_min_u32 s67, s67, s48
    ds_read_b128 a[48:51], v1 offset:24576
    v_fma_f32 v139, v139, s62, s62
    v_mfma_f32_16x16x32_bf16 a[136:139], a[4:7], a[40:43], a[136:139]
    buffer_load_dwordx4 v23, s[16:19], s66 offen offset:1024 lds
    v_mul_f32 v136, v136, v200
    v_mfma_f32_16x16x32_bf16 a[140:143], a[0:3], a[28:31], a[140:143]
    s_add_u32 s50, s66, 128
    v_rcp_f32 v139, v139
    v_mfma_f32_16x16x32_bf16 a[140:143], a[4:7], a[44:47], a[140:143]
    s_waitcnt lgkmcnt(1)
    v_mul_f32 v137, v137, v201
    v_mfma_f32_16x16x32_bf16 a[144:147], a[8:11], a[16:19], a[144:147]
    ds_read_b64_tr_b16 a[0:1], v12 offset:16384
    ds_read_b64_tr_b16 a[2:3], v12 offset:16896
    v_mfma_f32_16x16x32_bf16 a[144:147], a[12:15], a[32:35], a[144:147]
    buffer_load_dwordx4 v24, s[16:19], s66 offen offset:2048 lds
    v_mul_f32 v138, v138, v202
    v_mfma_f32_16x16x32_bf16 a[148:151], a[8:11], a[20:23], a[148:151]
    ds_read_b64_tr_b16 a[4:5], v12 offset:20480
    ds_read_b64_tr_b16 a[6:7], v12 offset:20992
    v_mfma_f32_16x16x32_bf16 a[148:151], a[12:15], a[36:39], a[148:151]
    v_mul_f32 v139, v139, v203
    v_cvt_pk_bf16_f32 v72, v136, v137
    v_mfma_f32_16x16x32_bf16 a[152:155], a[8:11], a[24:27], a[152:155]
    ds_read_b128 a[52:55], v1 offset:25600
    v_cvt_pk_bf16_f32 v73, v138, v139
    v_mfma_f32_16x16x32_bf16 a[152:155], a[12:15], a[40:43], a[152:155]
    buffer_load_dwordx4 v25, s[16:19], s66 offen offset:3072 lds
    v_mul_f32 v152, s44, v152
    v_mfma_f32_16x16x32_bf16 a[156:159], a[8:11], a[28:31], a[156:159]
    v_exp_f32 v152, v152
    v_mfma_f32_16x16x32_bf16 a[156:159], a[12:15], a[44:47], a[156:159]
    s_waitcnt lgkmcnt(1)
    v_mul_f32 v153, s44, v153
    v_mul_f32 v154, s44, v154
    v_mfma_f32_16x16x32_bf16 a[160:163], a[0:3], a[16:19], a[160:163]
    s_add_u32 m0, s45, 12288
    ds_read_b64_tr_b16 a[8:9], v13 offset:16384
    ds_read_b64_tr_b16 a[10:11], v13 offset:16896
    v_mfma_f32_16x16x32_bf16 a[160:163], a[4:7], a[32:35], a[160:163]
    buffer_load_dwordx4 v22, s[16:19], s67 offen offset:0 lds
    v_mul_f32 v155, s44, v155
    v_mfma_f32_16x16x32_bf16 a[164:167], a[0:3], a[20:23], a[164:167]
    s_add_u32 s53, s67, 128
    ds_read_b64_tr_b16 a[12:13], v13 offset:20480
    ds_read_b64_tr_b16 a[14:15], v13 offset:20992
    v_mfma_f32_16x16x32_bf16 a[164:167], a[4:7], a[36:39], a[164:167]
    v_exp_f32 v153, v153
    v_mfma_f32_16x16x32_bf16 a[168:171], a[0:3], a[24:27], a[168:171]
    ds_read_b128 a[56:59], v1 offset:26624
    v_fma_f32 v152, v152, s62, s62
    v_mfma_f32_16x16x32_bf16 a[168:171], a[4:7], a[40:43], a[168:171]
    buffer_load_dwordx4 v23, s[16:19], s67 offen offset:1024 lds
    v_fma_f32 v153, v153, s62, s62
    v_mfma_f32_16x16x32_bf16 a[172:175], a[0:3], a[28:31], a[172:175]
    v_exp_f32 v154, v154
    v_mfma_f32_16x16x32_bf16 a[172:175], a[4:7], a[44:47], a[172:175]
    s_waitcnt vmcnt(6) lgkmcnt(1)
    v_exp_f32 v155, v155
    v_mfma_f32_16x16x32_bf16 a[176:179], a[8:11], a[16:19], a[176:179]
    ds_read_b64_tr_b16 a[0:1], v10 offset:0
    ds_read_b64_tr_b16 a[2:3], v10 offset:512
    v_mfma_f32_16x16x32_bf16 a[176:179], a[12:15], a[32:35], a[176:179]
    buffer_load_dwordx4 v24, s[16:19], s67 offen offset:2048 lds
    v_fma_f32 v154, v154, s62, s62
    v_mfma_f32_16x16x32_bf16 a[180:183], a[8:11], a[20:23], a[180:183]
    ds_read_b64_tr_b16 a[4:5], v10 offset:4096
    ds_read_b64_tr_b16 a[6:7], v10 offset:4608
    v_mfma_f32_16x16x32_bf16 a[180:183], a[12:15], a[36:39], a[180:183]
    v_rcp_f32 v152, v152
    v_mfma_f32_16x16x32_bf16 a[184:187], a[8:11], a[24:27], a[184:187]
    ds_read_b128 a[60:63], v1 offset:27648
    v_fma_f32 v155, v155, s62, s62
    v_mfma_f32_16x16x32_bf16 a[184:187], a[12:15], a[40:43], a[184:187]
    buffer_load_dwordx4 v25, s[16:19], s67 offen offset:3072 lds
    v_mul_f32 v152, v152, v216
    v_mfma_f32_16x16x32_bf16 a[188:191], a[8:11], a[28:31], a[188:191]
    v_rcp_f32 v153, v153
    v_mfma_f32_16x16x32_bf16 a[188:191], a[12:15], a[44:47], a[188:191]
    s_waitcnt lgkmcnt(1)
    v_rcp_f32 v154, v154
    v_mfma_f32_16x16x32_bf16 a[192:195], a[0:3], a[16:19], a[192:195]
    s_add_u32 m0, s45, 16384
    ds_read_b64_tr_b16 a[8:9], v11 offset:0
    ds_read_b64_tr_b16 a[10:11], v11 offset:512
    v_mfma_f32_16x16x32_bf16 a[192:195], a[4:7], a[32:35], a[192:195]
    buffer_load_dwordx4 v22, s[16:19], s50 offen offset:0 lds
    v_mul_f32 v153, v153, v217
    v_mfma_f32_16x16x32_bf16 a[196:199], a[0:3], a[20:23], a[196:199]
    ds_read_b64_tr_b16 a[12:13], v11 offset:4096
    ds_read_b64_tr_b16 a[14:15], v11 offset:4608
    v_mfma_f32_16x16x32_bf16 a[196:199], a[4:7], a[36:39], a[196:199]
    v_rcp_f32 v155, v155
    v_mfma_f32_16x16x32_bf16 a[200:203], a[0:3], a[24:27], a[200:203]
    ds_read_b128 a[64:67], v1 offset:28672
    v_mul_f32 v154, v154, v218
    v_mfma_f32_16x16x32_bf16 a[200:203], a[4:7], a[40:43], a[200:203]
    buffer_load_dwordx4 v23, s[16:19], s50 offen offset:1024 lds
    v_mul_f32 v155, v155, v219
    v_mfma_f32_16x16x32_bf16 a[204:207], a[0:3], a[28:31], a[204:207]
    v_cvt_pk_bf16_f32 v74, v152, v153
    v_cvt_pk_bf16_f32 v75, v154, v155
    v_mfma_f32_16x16x32_bf16 a[204:207], a[4:7], a[44:47], a[204:207]
    s_waitcnt lgkmcnt(1)
    v_mfma_f32_16x16x32_bf16 a[208:211], a[8:11], a[16:19], a[208:211]
    ds_read_b64_tr_b16 a[0:1], v12 offset:0
    ds_read_b64_tr_b16 a[2:3], v12 offset:512
    v_mfma_f32_16x16x32_bf16 a[208:211], a[12:15], a[32:35], a[208:211]
    buffer_load_dwordx4 v24, s[16:19], s50 offen offset:2048 lds
    v_mul_f32 v140, s44, v140
    v_mfma_f32_16x16x32_bf16 a[212:215], a[8:11], a[20:23], a[212:215]
    ds_read_b64_tr_b16 a[4:5], v12 offset:4096
    ds_read_b64_tr_b16 a[6:7], v12 offset:4608
    v_mfma_f32_16x16x32_bf16 a[212:215], a[12:15], a[36:39], a[212:215]
    v_exp_f32 v140, v140
    v_mfma_f32_16x16x32_bf16 a[216:219], a[8:11], a[24:27], a[216:219]
    ds_read_b128 a[68:71], v1 offset:29696
    v_mul_f32 v141, s44, v141
    v_mfma_f32_16x16x32_bf16 a[216:219], a[12:15], a[40:43], a[216:219]
    buffer_load_dwordx4 v25, s[16:19], s50 offen offset:3072 lds
    v_mul_f32 v142, s44, v142
    v_mfma_f32_16x16x32_bf16 a[220:223], a[8:11], a[28:31], a[220:223]
    v_exp_f32 v141, v141
    v_mfma_f32_16x16x32_bf16 a[220:223], a[12:15], a[44:47], a[220:223]
    s_waitcnt lgkmcnt(1)
    v_exp_f32 v142, v142
    v_mfma_f32_16x16x32_bf16 a[224:227], a[0:3], a[16:19], a[224:227]
    s_add_u32 m0, s45, 20480
    ds_read_b64_tr_b16 a[8:9], v13 offset:0
    ds_read_b64_tr_b16 a[10:11], v13 offset:512
    v_mfma_f32_16x16x32_bf16 a[224:227], a[4:7], a[32:35], a[224:227]
    buffer_load_dwordx4 v22, s[16:19], s53 offen offset:0 lds
    v_mul_f32 v143, s44, v143
    v_mfma_f32_16x16x32_bf16 a[228:231], a[0:3], a[20:23], a[228:231]
    s_add_u32 s66, s66, 524288
    ds_read_b64_tr_b16 a[12:13], v13 offset:4096
    ds_read_b64_tr_b16 a[14:15], v13 offset:4608
    v_mfma_f32_16x16x32_bf16 a[228:231], a[4:7], a[36:39], a[228:231]
    s_sub_u32 s48, s66, 4194304
    v_exp_f32 v143, v143
    v_mfma_f32_16x16x32_bf16 a[232:235], a[0:3], a[24:27], a[232:235]
    s_min_u32 s66, s66, s48
    ds_read_b128 a[72:75], v1 offset:30720
    v_fma_f32 v140, v140, s62, s62
    v_mfma_f32_16x16x32_bf16 a[232:235], a[4:7], a[40:43], a[232:235]
    buffer_load_dwordx4 v23, s[16:19], s53 offen offset:1024 lds
    v_fma_f32 v141, v141, s62, s62
    v_mfma_f32_16x16x32_bf16 a[236:239], a[0:3], a[28:31], a[236:239]
    v_rcp_f32 v140, v140
    v_mfma_f32_16x16x32_bf16 a[236:239], a[4:7], a[44:47], a[236:239]
    s_waitcnt vmcnt(6) lgkmcnt(1)
    v_rcp_f32 v141, v141
    v_mfma_f32_16x16x32_bf16 a[240:243], a[8:11], a[16:19], a[240:243]
    ds_read_b64_tr_b16 a[0:1], v10 offset:8192
    ds_read_b64_tr_b16 a[2:3], v10 offset:8704
    v_mfma_f32_16x16x32_bf16 a[240:243], a[12:15], a[32:35], a[240:243]
    buffer_load_dwordx4 v24, s[16:19], s53 offen offset:2048 lds
    v_fma_f32 v142, v142, s62, s62
    v_mfma_f32_16x16x32_bf16 a[244:247], a[8:11], a[20:23], a[244:247]
    ds_read_b64_tr_b16 a[4:5], v10 offset:12288
    ds_read_b64_tr_b16 a[6:7], v10 offset:12800
    v_mfma_f32_16x16x32_bf16 a[244:247], a[12:15], a[36:39], a[244:247]
    v_rcp_f32 v142, v142
    v_mfma_f32_16x16x32_bf16 a[248:251], a[8:11], a[24:27], a[248:251]
    ds_read_b128 a[76:79], v1 offset:31744
    v_fma_f32 v143, v143, s62, s62
    v_mfma_f32_16x16x32_bf16 a[248:251], a[12:15], a[40:43], a[248:251]
    buffer_load_dwordx4 v25, s[16:19], s53 offen offset:3072 lds
    v_mul_f32 v140, v140, v204
    v_mfma_f32_16x16x32_bf16 a[252:255], a[8:11], a[28:31], a[252:255]
    v_rcp_f32 v143, v143
    v_mfma_f32_16x16x32_bf16 a[252:255], a[12:15], a[44:47], a[252:255]
    s_waitcnt lgkmcnt(0)
    v_mul_f32 v141, v141, v205
    v_mfma_f32_16x16x32_bf16 a[128:131], a[0:3], a[48:51], a[128:131]
    s_add_u32 m0, s45, 0
    ds_read_b64_tr_b16 a[8:9], v11 offset:8192
    ds_read_b64_tr_b16 a[10:11], v11 offset:8704
    v_mfma_f32_16x16x32_bf16 a[128:131], a[4:7], a[64:67], a[128:131]
    buffer_load_dwordx4 v22, s[16:19], s66 offen offset:0 lds
    v_mul_f32 v142, v142, v206
    v_mfma_f32_16x16x32_bf16 a[132:135], a[0:3], a[52:55], a[132:135]
    s_add_u32 s67, s67, 524288
    ds_read_b64_tr_b16 a[12:13], v11 offset:12288
    ds_read_b64_tr_b16 a[14:15], v11 offset:12800
    v_mfma_f32_16x16x32_bf16 a[132:135], a[4:7], a[68:71], a[132:135]
    s_sub_u32 s48, s67, 4194304
    v_mul_f32 v143, v143, v207
    v_cvt_pk_bf16_f32 v76, v140, v141
    v_mfma_f32_16x16x32_bf16 a[136:139], a[0:3], a[56:59], a[136:139]
    s_min_u32 s67, s67, s48
    ds_read_b128 a[16:19], v1 offset:32768
    v_cvt_pk_bf16_f32 v77, v142, v143
    v_mfma_f32_16x16x32_bf16 a[136:139], a[4:7], a[72:75], a[136:139]
    buffer_load_dwordx4 v23, s[16:19], s66 offen offset:1024 lds
    v_mul_f32 v156, s44, v156
    v_mfma_f32_16x16x32_bf16 a[140:143], a[0:3], a[60:63], a[140:143]
    s_add_u32 s50, s66, 128
    v_exp_f32 v156, v156
    v_mfma_f32_16x16x32_bf16 a[140:143], a[4:7], a[76:79], a[140:143]
    s_waitcnt lgkmcnt(1)
    v_mul_f32 v157, s44, v157
    v_mul_f32 v158, s44, v158
    v_mfma_f32_16x16x32_bf16 a[144:147], a[8:11], a[48:51], a[144:147]
    ds_read_b64_tr_b16 a[0:1], v12 offset:8192
    ds_read_b64_tr_b16 a[2:3], v12 offset:8704
    v_mfma_f32_16x16x32_bf16 a[144:147], a[12:15], a[64:67], a[144:147]
    buffer_load_dwordx4 v24, s[16:19], s66 offen offset:2048 lds
    v_mul_f32 v159, s44, v159
    v_mfma_f32_16x16x32_bf16 a[148:151], a[8:11], a[52:55], a[148:151]
    ds_read_b64_tr_b16 a[4:5], v12 offset:12288
    ds_read_b64_tr_b16 a[6:7], v12 offset:12800
    v_mfma_f32_16x16x32_bf16 a[148:151], a[12:15], a[68:71], a[148:151]
    v_exp_f32 v157, v157
    v_mfma_f32_16x16x32_bf16 a[152:155], a[8:11], a[56:59], a[152:155]
    ds_read_b128 a[20:23], v1 offset:33792
    v_fma_f32 v156, v156, s62, s62
    v_mfma_f32_16x16x32_bf16 a[152:155], a[12:15], a[72:75], a[152:155]
    buffer_load_dwordx4 v25, s[16:19], s66 offen offset:3072 lds
    v_fma_f32 v157, v157, s62, s62
    v_mfma_f32_16x16x32_bf16 a[156:159], a[8:11], a[60:63], a[156:159]
    v_exp_f32 v158, v158
    v_mfma_f32_16x16x32_bf16 a[156:159], a[12:15], a[76:79], a[156:159]
    s_waitcnt lgkmcnt(1)
    v_exp_f32 v159, v159
    v_mfma_f32_16x16x32_bf16 a[160:163], a[0:3], a[48:51], a[160:163]
    s_add_u32 m0, s45, 4096
    ds_read_b64_tr_b16 a[8:9], v13 offset:8192
    ds_read_b64_tr_b16 a[10:11], v13 offset:8704
    v_mfma_f32_16x16x32_bf16 a[160:163], a[4:7], a[64:67], a[160:163]
    buffer_load_dwordx4 v22, s[16:19], s67 offen offset:0 lds
    v_fma_f32 v158, v158, s62, s62
    v_mfma_f32_16x16x32_bf16 a[164:167], a[0:3], a[52:55], a[164:167]
    s_add_u32 s53, s67, 128
    ds_read_b64_tr_b16 a[12:13], v13 offset:12288
    ds_read_b64_tr_b16 a[14:15], v13 offset:12800
    v_mfma_f32_16x16x32_bf16 a[164:167], a[4:7], a[68:71], a[164:167]
    v_rcp_f32 v156, v156
    v_mfma_f32_16x16x32_bf16 a[168:171], a[0:3], a[56:59], a[168:171]
    ds_read_b128 a[24:27], v1 offset:34816
    v_fma_f32 v159, v159, s62, s62
    v_mfma_f32_16x16x32_bf16 a[168:171], a[4:7], a[72:75], a[168:171]
    buffer_load_dwordx4 v23, s[16:19], s67 offen offset:1024 lds
    v_mul_f32 v156, v156, v220
    v_mfma_f32_16x16x32_bf16 a[172:175], a[0:3], a[60:63], a[172:175]
    v_rcp_f32 v157, v157
    v_mfma_f32_16x16x32_bf16 a[172:175], a[4:7], a[76:79], a[172:175]
    s_waitcnt vmcnt(6) lgkmcnt(1)
    v_rcp_f32 v158, v158
    v_mfma_f32_16x16x32_bf16 a[176:179], a[8:11], a[48:51], a[176:179]
    ds_read_b64_tr_b16 a[0:1], v10 offset:16384
    ds_read_b64_tr_b16 a[2:3], v10 offset:16896
    v_mfma_f32_16x16x32_bf16 a[176:179], a[12:15], a[64:67], a[176:179]
    buffer_load_dwordx4 v24, s[16:19], s67 offen offset:2048 lds
    v_mul_f32 v157, v157, v221
    v_mfma_f32_16x16x32_bf16 a[180:183], a[8:11], a[52:55], a[180:183]
    ds_read_b64_tr_b16 a[4:5], v10 offset:20480
    ds_read_b64_tr_b16 a[6:7], v10 offset:20992
    v_mfma_f32_16x16x32_bf16 a[180:183], a[12:15], a[68:71], a[180:183]
    v_rcp_f32 v159, v159
    v_mfma_f32_16x16x32_bf16 a[184:187], a[8:11], a[56:59], a[184:187]
    ds_read_b128 a[28:31], v1 offset:35840
    v_mul_f32 v158, v158, v222
    v_mfma_f32_16x16x32_bf16 a[184:187], a[12:15], a[72:75], a[184:187]
    buffer_load_dwordx4 v25, s[16:19], s67 offen offset:3072 lds
    v_mul_f32 v159, v159, v223
    v_mfma_f32_16x16x32_bf16 a[188:191], a[8:11], a[60:63], a[188:191]
    v_cvt_pk_bf16_f32 v78, v156, v157
    v_cvt_pk_bf16_f32 v79, v158, v159
    v_mfma_f32_16x16x32_bf16 a[188:191], a[12:15], a[76:79], a[188:191]
    s_waitcnt lgkmcnt(1)
    v_mfma_f32_16x16x32_bf16 a[192:195], a[0:3], a[48:51], a[192:195]
    s_add_u32 m0, s45, 8192
    ds_read_b64_tr_b16 a[8:9], v11 offset:16384
    ds_read_b64_tr_b16 a[10:11], v11 offset:16896
    v_mfma_f32_16x16x32_bf16 a[192:195], a[4:7], a[64:67], a[192:195]
    buffer_load_dwordx4 v22, s[16:19], s50 offen offset:0 lds
    v_mul_f32 v160, s44, v160
    v_mfma_f32_16x16x32_bf16 a[196:199], a[0:3], a[52:55], a[196:199]
    ds_read_b64_tr_b16 a[12:13], v11 offset:20480
    ds_read_b64_tr_b16 a[14:15], v11 offset:20992
    v_mfma_f32_16x16x32_bf16 a[196:199], a[4:7], a[68:71], a[196:199]
    v_exp_f32 v160, v160
    v_mfma_f32_16x16x32_bf16 a[200:203], a[0:3], a[56:59], a[200:203]
    ds_read_b128 a[32:35], v1 offset:36864
    v_mul_f32 v161, s44, v161
    v_mfma_f32_16x16x32_bf16 a[200:203], a[4:7], a[72:75], a[200:203]
    buffer_load_dwordx4 v23, s[16:19], s50 offen offset:1024 lds
    v_mul_f32 v162, s44, v162
    v_mfma_f32_16x16x32_bf16 a[204:207], a[0:3], a[60:63], a[204:207]
    v_exp_f32 v161, v161
    v_mfma_f32_16x16x32_bf16 a[204:207], a[4:7], a[76:79], a[204:207]
    s_waitcnt lgkmcnt(1)
    v_exp_f32 v162, v162
    v_mfma_f32_16x16x32_bf16 a[208:211], a[8:11], a[48:51], a[208:211]
    ds_read_b64_tr_b16 a[0:1], v12 offset:16384
    ds_read_b64_tr_b16 a[2:3], v12 offset:16896
    v_mfma_f32_16x16x32_bf16 a[208:211], a[12:15], a[64:67], a[208:211]
    buffer_load_dwordx4 v24, s[16:19], s50 offen offset:2048 lds
    v_mul_f32 v163, s44, v163
    v_mfma_f32_16x16x32_bf16 a[212:215], a[8:11], a[52:55], a[212:215]
    ds_read_b64_tr_b16 a[4:5], v12 offset:20480
    ds_read_b64_tr_b16 a[6:7], v12 offset:20992
    v_mfma_f32_16x16x32_bf16 a[212:215], a[12:15], a[68:71], a[212:215]
    v_exp_f32 v163, v163
    v_mfma_f32_16x16x32_bf16 a[216:219], a[8:11], a[56:59], a[216:219]
    ds_read_b128 a[36:39], v1 offset:37888
    v_fma_f32 v160, v160, s62, s62
    v_mfma_f32_16x16x32_bf16 a[216:219], a[12:15], a[72:75], a[216:219]
    buffer_load_dwordx4 v25, s[16:19], s50 offen offset:3072 lds
    v_fma_f32 v161, v161, s62, s62
    v_mfma_f32_16x16x32_bf16 a[220:223], a[8:11], a[60:63], a[220:223]
    v_rcp_f32 v160, v160
    v_mfma_f32_16x16x32_bf16 a[220:223], a[12:15], a[76:79], a[220:223]
    s_waitcnt lgkmcnt(1)
    v_rcp_f32 v161, v161
    v_mfma_f32_16x16x32_bf16 a[224:227], a[0:3], a[48:51], a[224:227]
    s_add_u32 m0, s45, 12288
    ds_read_b64_tr_b16 a[8:9], v13 offset:16384
    ds_read_b64_tr_b16 a[10:11], v13 offset:16896
    v_mfma_f32_16x16x32_bf16 a[224:227], a[4:7], a[64:67], a[224:227]
    buffer_load_dwordx4 v22, s[16:19], s53 offen offset:0 lds
    v_fma_f32 v162, v162, s62, s62
    v_mfma_f32_16x16x32_bf16 a[228:231], a[0:3], a[52:55], a[228:231]
    s_add_u32 s66, s66, 524288
    ds_read_b64_tr_b16 a[12:13], v13 offset:20480
    ds_read_b64_tr_b16 a[14:15], v13 offset:20992
    v_mfma_f32_16x16x32_bf16 a[228:231], a[4:7], a[68:71], a[228:231]
    s_sub_u32 s48, s66, 4194304
    v_rcp_f32 v162, v162
    v_mfma_f32_16x16x32_bf16 a[232:235], a[0:3], a[56:59], a[232:235]
    s_min_u32 s66, s66, s48
    ds_read_b128 a[40:43], v1 offset:38912
    v_fma_f32 v163, v163, s62, s62
    v_mfma_f32_16x16x32_bf16 a[232:235], a[4:7], a[72:75], a[232:235]
    buffer_load_dwordx4 v23, s[16:19], s53 offen offset:1024 lds
    v_mul_f32 v160, v160, v224
    v_mfma_f32_16x16x32_bf16 a[236:239], a[0:3], a[60:63], a[236:239]
    s_barrier
    v_mfma_f32_16x16x32_bf16 a[236:239], a[4:7], a[76:79], a[236:239]
    s_waitcnt vmcnt(6) lgkmcnt(1)
    v_rcp_f32 v163, v163
    v_mfma_f32_16x16x32_bf16 a[240:243], a[8:11], a[48:51], a[240:243]
    ds_read_b64_tr_b16 a[0:1], v10 offset:0
    ds_read_b64_tr_b16 a[2:3], v10 offset:512
    v_mfma_f32_16x16x32_bf16 a[240:243], a[12:15], a[64:67], a[240:243]
    buffer_load_dwordx4 v24, s[16:19], s53 offen offset:2048 lds
    v_mul_f32 v161, v161, v225
    v_mfma_f32_16x16x32_bf16 a[244:247], a[8:11], a[52:55], a[244:247]
    ds_read_b64_tr_b16 a[4:5], v10 offset:4096
    ds_read_b64_tr_b16 a[6:7], v10 offset:4608
    v_mfma_f32_16x16x32_bf16 a[244:247], a[12:15], a[68:71], a[244:247]
    v_mul_f32 v162, v162, v226
    v_mul_f32 v163, v163, v227
    v_mfma_f32_16x16x32_bf16 a[248:251], a[8:11], a[56:59], a[248:251]
    ds_read_b128 a[44:47], v1 offset:39936
    v_cvt_pk_bf16_f32 v80, v160, v161
    v_mfma_f32_16x16x32_bf16 a[248:251], a[12:15], a[72:75], a[248:251]
    buffer_load_dwordx4 v25, s[16:19], s53 offen offset:3072 lds
    v_cvt_pk_bf16_f32 v81, v162, v163
    v_mfma_f32_16x16x32_bf16 a[252:255], a[8:11], a[60:63], a[252:255]
    v_mul_f32 v176, s44, v176
    v_mul_f32 v177, s44, v177
    v_mfma_f32_16x16x32_bf16 a[252:255], a[12:15], a[76:79], a[252:255]
    s_waitcnt lgkmcnt(0)
    v_exp_f32 v176, v176
    v_mfma_f32_16x16x32_bf16 a[128:131], a[0:3], a[16:19], a[128:131]
    s_add_u32 m0, s45, 16384
    ds_read_b64_tr_b16 a[8:9], v11 offset:0
    ds_read_b64_tr_b16 a[10:11], v11 offset:512
    v_mfma_f32_16x16x32_bf16 a[128:131], a[4:7], a[32:35], a[128:131]
    buffer_load_dwordx4 v22, s[16:19], s66 offen offset:0 lds
    v_mul_f32 v178, s44, v178
    v_mfma_f32_16x16x32_bf16 a[132:135], a[0:3], a[20:23], a[132:135]
    s_add_u32 s67, s67, 524288
    ds_read_b64_tr_b16 a[12:13], v11 offset:4096
    ds_read_b64_tr_b16 a[14:15], v11 offset:4608
    v_mfma_f32_16x16x32_bf16 a[132:135], a[4:7], a[36:39], a[132:135]
    s_sub_u32 s48, s67, 4194304
    v_exp_f32 v177, v177
    v_mfma_f32_16x16x32_bf16 a[136:139], a[0:3], a[24:27], a[136:139]
    s_min_u32 s67, s67, s48
    ds_read_b128 a[48:51], v1 offset:40960
    v_mul_f32 v179, s44, v179
    v_mfma_f32_16x16x32_bf16 a[136:139], a[4:7], a[40:43], a[136:139]
    buffer_load_dwordx4 v23, s[16:19], s66 offen offset:1024 lds
    v_fma_f32 v176, v176, s62, s62
    v_mfma_f32_16x16x32_bf16 a[140:143], a[0:3], a[28:31], a[140:143]
    s_add_u32 s50, s66, 128
    v_exp_f32 v178, v178
    v_mfma_f32_16x16x32_bf16 a[140:143], a[4:7], a[44:47], a[140:143]
    s_waitcnt lgkmcnt(1)
    v_exp_f32 v179, v179
    v_mfma_f32_16x16x32_bf16 a[144:147], a[8:11], a[16:19], a[144:147]
    ds_read_b64_tr_b16 a[0:1], v12 offset:0
    ds_read_b64_tr_b16 a[2:3], v12 offset:512
    v_mfma_f32_16x16x32_bf16 a[144:147], a[12:15], a[32:35], a[144:147]
    buffer_load_dwordx4 v24, s[16:19], s66 offen offset:2048 lds
    v_fma_f32 v177, v177, s62, s62
    v_mfma_f32_16x16x32_bf16 a[148:151], a[8:11], a[20:23], a[148:151]
    ds_read_b64_tr_b16 a[4:5], v12 offset:4096
    ds_read_b64_tr_b16 a[6:7], v12 offset:4608
    v_mfma_f32_16x16x32_bf16 a[148:151], a[12:15], a[36:39], a[148:151]
    v_rcp_f32 v176, v176
    v_mfma_f32_16x16x32_bf16 a[152:155], a[8:11], a[24:27], a[152:155]
    ds_read_b128 a[52:55], v1 offset:41984
    v_fma_f32 v178, v178, s62, s62
    v_mfma_f32_16x16x32_bf16 a[152:155], a[12:15], a[40:43], a[152:155]
    buffer_load_dwordx4 v25, s[16:19], s66 offen offset:3072 lds
    v_fma_f32 v179, v179, s62, s62
    v_mfma_f32_16x16x32_bf16 a[156:159], a[8:11], a[28:31], a[156:159]
    v_rcp_f32 v177, v177
    v_mfma_f32_16x16x32_bf16 a[156:159], a[12:15], a[44:47], a[156:159]
    s_waitcnt lgkmcnt(1)
    v_rcp_f32 v178, v178
    v_mfma_f32_16x16x32_bf16 a[160:163], a[0:3], a[16:19], a[160:163]
    s_add_u32 m0, s45, 20480
    ds_read_b64_tr_b16 a[8:9], v13 offset:0
    ds_read_b64_tr_b16 a[10:11], v13 offset:512
    v_mfma_f32_16x16x32_bf16 a[160:163], a[4:7], a[32:35], a[160:163]
    buffer_load_dwordx4 v22, s[16:19], s67 offen offset:0 lds
    v_mul_f32 v176, v176, v240
    v_mfma_f32_16x16x32_bf16 a[164:167], a[0:3], a[20:23], a[164:167]
    s_add_u32 s53, s67, 128
    ds_read_b64_tr_b16 a[12:13], v13 offset:4096
    ds_read_b64_tr_b16 a[14:15], v13 offset:4608
    v_mfma_f32_16x16x32_bf16 a[164:167], a[4:7], a[36:39], a[164:167]
    v_rcp_f32 v179, v179
    v_mfma_f32_16x16x32_bf16 a[168:171], a[0:3], a[24:27], a[168:171]
    ds_read_b128 a[56:59], v1 offset:43008
    v_mul_f32 v177, v177, v241
    v_mfma_f32_16x16x32_bf16 a[168:171], a[4:7], a[40:43], a[168:171]
    buffer_load_dwordx4 v23, s[16:19], s67 offen offset:1024 lds
    v_mul_f32 v178, v178, v242
    v_mfma_f32_16x16x32_bf16 a[172:175], a[0:3], a[28:31], a[172:175]
    v_mul_f32 v179, v179, v243
    v_cvt_pk_bf16_f32 v82, v176, v177
    v_mfma_f32_16x16x32_bf16 a[172:175], a[4:7], a[44:47], a[172:175]
    s_waitcnt vmcnt(6) lgkmcnt(1)
    v_cvt_pk_bf16_f32 v83, v178, v179
    v_mfma_f32_16x16x32_bf16 a[176:179], a[8:11], a[16:19], a[176:179]
    ds_read_b64_tr_b16 a[0:1], v10 offset:8192
    ds_read_b64_tr_b16 a[2:3], v10 offset:8704
    v_mfma_f32_16x16x32_bf16 a[176:179], a[12:15], a[32:35], a[176:179]
    buffer_load_dwordx4 v24, s[16:19], s67 offen offset:2048 lds
    v_mul_f32 v164, s44, v164
    v_mfma_f32_16x16x32_bf16 a[180:183], a[8:11], a[20:23], a[180:183]
    ds_read_b64_tr_b16 a[4:5], v10 offset:12288
    ds_read_b64_tr_b16 a[6:7], v10 offset:12800
    v_mfma_f32_16x16x32_bf16 a[180:183], a[12:15], a[36:39], a[180:183]
    v_exp_f32 v164, v164
    v_mfma_f32_16x16x32_bf16 a[184:187], a[8:11], a[24:27], a[184:187]
    ds_read_b128 a[60:63], v1 offset:44032
    v_mul_f32 v165, s44, v165
    v_mfma_f32_16x16x32_bf16 a[184:187], a[12:15], a[40:43], a[184:187]
    buffer_load_dwordx4 v25, s[16:19], s67 offen offset:3072 lds
    v_mul_f32 v166, s44, v166
    v_mfma_f32_16x16x32_bf16 a[188:191], a[8:11], a[28:31], a[188:191]
    ds_write_b128 v52, v[64:67] offset:0
    ds_write_b128 v52, v[68:71] offset:1024
    ds_write_b128 v52, v[72:75] offset:2048
    ds_write_b128 v52, v[76:79] offset:3072
    v_mfma_f32_16x16x32_bf16 a[188:191], a[12:15], a[44:47], a[188:191]
    s_waitcnt lgkmcnt(5)
    v_exp_f32 v165, v165
    v_mfma_f32_16x16x32_bf16 a[192:195], a[0:3], a[16:19], a[192:195]
    s_add_u32 m0, s45, 0
    ds_read_b64_tr_b16 a[8:9], v11 offset:8192
    ds_read_b64_tr_b16 a[10:11], v11 offset:8704
    v_mfma_f32_16x16x32_bf16 a[192:195], a[4:7], a[32:35], a[192:195]
    buffer_load_dwordx4 v22, s[16:19], s50 offen offset:0 lds
    v_mul_f32 v167, s44, v167
    v_mfma_f32_16x16x32_bf16 a[196:199], a[0:3], a[20:23], a[196:199]
    ds_read_b64_tr_b16 a[12:13], v11 offset:12288
    ds_read_b64_tr_b16 a[14:15], v11 offset:12800
    v_mfma_f32_16x16x32_bf16 a[196:199], a[4:7], a[36:39], a[196:199]
    v_exp_f32 v166, v166
    v_mfma_f32_16x16x32_bf16 a[200:203], a[0:3], a[24:27], a[200:203]
    ds_read_b128 a[64:67], v1 offset:45056
    v_fma_f32 v164, v164, s62, s62
    v_mfma_f32_16x16x32_bf16 a[200:203], a[4:7], a[40:43], a[200:203]
    buffer_load_dwordx4 v23, s[16:19], s50 offen offset:1024 lds
    v_fma_f32 v165, v165, s62, s62
    v_mfma_f32_16x16x32_bf16 a[204:207], a[0:3], a[28:31], a[204:207]
    v_exp_f32 v167, v167
    v_mfma_f32_16x16x32_bf16 a[204:207], a[4:7], a[44:47], a[204:207]
    s_waitcnt lgkmcnt(1)
    v_rcp_f32 v164, v164
    v_mfma_f32_16x16x32_bf16 a[208:211], a[8:11], a[16:19], a[208:211]
    ds_read_b64_tr_b16 a[0:1], v12 offset:8192
    ds_read_b64_tr_b16 a[2:3], v12 offset:8704
    v_mfma_f32_16x16x32_bf16 a[208:211], a[12:15], a[32:35], a[208:211]
    buffer_load_dwordx4 v24, s[16:19], s50 offen offset:2048 lds
    v_fma_f32 v166, v166, s62, s62
    v_mfma_f32_16x16x32_bf16 a[212:215], a[8:11], a[20:23], a[212:215]
    ds_read_b64_tr_b16 a[4:5], v12 offset:12288
    ds_read_b64_tr_b16 a[6:7], v12 offset:12800
    v_mfma_f32_16x16x32_bf16 a[212:215], a[12:15], a[36:39], a[212:215]
    v_rcp_f32 v165, v165
    v_mfma_f32_16x16x32_bf16 a[216:219], a[8:11], a[24:27], a[216:219]
    ds_read_b128 a[68:71], v1 offset:46080
    v_fma_f32 v167, v167, s62, s62
    v_mfma_f32_16x16x32_bf16 a[216:219], a[12:15], a[40:43], a[216:219]
    buffer_load_dwordx4 v25, s[16:19], s50 offen offset:3072 lds
    v_mul_f32 v164, v164, v228
    v_mfma_f32_16x16x32_bf16 a[220:223], a[8:11], a[28:31], a[220:223]
    v_rcp_f32 v166, v166
    v_mfma_f32_16x16x32_bf16 a[220:223], a[12:15], a[44:47], a[220:223]
    s_waitcnt lgkmcnt(1)
    v_rcp_f32 v167, v167
    v_mfma_f32_16x16x32_bf16 a[224:227], a[0:3], a[16:19], a[224:227]
    s_add_u32 m0, s45, 4096
    ds_read_b64_tr_b16 a[8:9], v13 offset:8192
    ds_read_b64_tr_b16 a[10:11], v13 offset:8704
    v_mfma_f32_16x16x32_bf16 a[224:227], a[4:7], a[32:35], a[224:227]
    buffer_load_dwordx4 v22, s[16:19], s53 offen offset:0 lds
    v_mul_f32 v165, v165, v229
    v_mfma_f32_16x16x32_bf16 a[228:231], a[0:3], a[20:23], a[228:231]
    s_add_u32 s66, s66, 524288
    ds_read_b64_tr_b16 a[12:13], v13 offset:12288
    ds_read_b64_tr_b16 a[14:15], v13 offset:12800
    v_mfma_f32_16x16x32_bf16 a[228:231], a[4:7], a[36:39], a[228:231]
    s_sub_u32 s48, s66, 4194304
    v_mul_f32 v166, v166, v230
    v_mul_f32 v167, v167, v231
    v_mfma_f32_16x16x32_bf16 a[232:235], a[0:3], a[24:27], a[232:235]
    s_min_u32 s66, s66, s48
    ds_read_b128 a[72:75], v1 offset:47104
    v_cvt_pk_bf16_f32 v84, v164, v165
    v_mfma_f32_16x16x32_bf16 a[232:235], a[4:7], a[40:43], a[232:235]
    buffer_load_dwordx4 v23, s[16:19], s53 offen offset:1024 lds
    v_cvt_pk_bf16_f32 v85, v166, v167
    v_mfma_f32_16x16x32_bf16 a[236:239], a[0:3], a[28:31], a[236:239]
    v_mul_f32 v180, s44, v180
    v_mul_f32 v181, s44, v181
    v_mfma_f32_16x16x32_bf16 a[236:239], a[4:7], a[44:47], a[236:239]
    s_waitcnt vmcnt(6) lgkmcnt(1)
    v_exp_f32 v180, v180
    v_mfma_f32_16x16x32_bf16 a[240:243], a[8:11], a[16:19], a[240:243]
    ds_read_b64_tr_b16 a[0:1], v10 offset:16384
    ds_read_b64_tr_b16 a[2:3], v10 offset:16896
    v_mfma_f32_16x16x32_bf16 a[240:243], a[12:15], a[32:35], a[240:243]
    buffer_load_dwordx4 v24, s[16:19], s53 offen offset:2048 lds
    v_mul_f32 v182, s44, v182
    v_mfma_f32_16x16x32_bf16 a[244:247], a[8:11], a[20:23], a[244:247]
    ds_read_b64_tr_b16 a[4:5], v10 offset:20480
    ds_read_b64_tr_b16 a[6:7], v10 offset:20992
    v_mfma_f32_16x16x32_bf16 a[244:247], a[12:15], a[36:39], a[244:247]
    v_exp_f32 v181, v181
    v_mfma_f32_16x16x32_bf16 a[248:251], a[8:11], a[24:27], a[248:251]
    ds_read_b128 a[76:79], v1 offset:48128
    v_mul_f32 v183, s44, v183
    v_mfma_f32_16x16x32_bf16 a[248:251], a[12:15], a[40:43], a[248:251]
    buffer_load_dwordx4 v25, s[16:19], s53 offen offset:3072 lds
    v_fma_f32 v180, v180, s62, s62
    v_mfma_f32_16x16x32_bf16 a[252:255], a[8:11], a[28:31], a[252:255]
    v_exp_f32 v182, v182
    v_mfma_f32_16x16x32_bf16 a[252:255], a[12:15], a[44:47], a[252:255]
    s_waitcnt lgkmcnt(0)
    v_exp_f32 v183, v183
    v_mfma_f32_16x16x32_bf16 a[128:131], a[0:3], a[48:51], a[128:131]
    s_add_u32 m0, s45, 8192
    ds_read_b64_tr_b16 a[8:9], v11 offset:16384
    ds_read_b64_tr_b16 a[10:11], v11 offset:16896
    v_mfma_f32_16x16x32_bf16 a[128:131], a[4:7], a[64:67], a[128:131]
    buffer_load_dwordx4 v22, s[16:19], s66 offen offset:0 lds
    v_fma_f32 v181, v181, s62, s62
    v_mfma_f32_16x16x32_bf16 a[132:135], a[0:3], a[52:55], a[132:135]
    s_add_u32 s67, s67, 524288
    ds_read_b64_tr_b16 a[12:13], v11 offset:20480
    ds_read_b64_tr_b16 a[14:15], v11 offset:20992
    v_mfma_f32_16x16x32_bf16 a[132:135], a[4:7], a[68:71], a[132:135]
    s_sub_u32 s48, s67, 4194304
    v_rcp_f32 v180, v180
    v_mfma_f32_16x16x32_bf16 a[136:139], a[0:3], a[56:59], a[136:139]
    s_min_u32 s67, s67, s48
    ds_read_b128 a[16:19], v1 offset:49152
    v_fma_f32 v182, v182, s62, s62
    v_mfma_f32_16x16x32_bf16 a[136:139], a[4:7], a[72:75], a[136:139]
    buffer_load_dwordx4 v23, s[16:19], s66 offen offset:1024 lds
    v_fma_f32 v183, v183, s62, s62
    v_mfma_f32_16x16x32_bf16 a[140:143], a[0:3], a[60:63], a[140:143]
    s_add_u32 s50, s66, 128
    v_rcp_f32 v181, v181
    v_mfma_f32_16x16x32_bf16 a[140:143], a[4:7], a[76:79], a[140:143]
    s_waitcnt lgkmcnt(1)
    v_rcp_f32 v182, v182
    v_mfma_f32_16x16x32_bf16 a[144:147], a[8:11], a[48:51], a[144:147]
    ds_read_b64_tr_b16 a[0:1], v12 offset:16384
    ds_read_b64_tr_b16 a[2:3], v12 offset:16896
    v_mfma_f32_16x16x32_bf16 a[144:147], a[12:15], a[64:67], a[144:147]
    buffer_load_dwordx4 v24, s[16:19], s66 offen offset:2048 lds
    v_mul_f32 v180, v180, v244
    v_mfma_f32_16x16x32_bf16 a[148:151], a[8:11], a[52:55], a[148:151]
    ds_read_b64_tr_b16 a[4:5], v12 offset:20480
    ds_read_b64_tr_b16 a[6:7], v12 offset:20992
    v_mfma_f32_16x16x32_bf16 a[148:151], a[12:15], a[68:71], a[148:151]
    v_rcp_f32 v183, v183
    v_mfma_f32_16x16x32_bf16 a[152:155], a[8:11], a[56:59], a[152:155]
    ds_read_b128 a[20:23], v1 offset:50176
    v_mul_f32 v181, v181, v245
    v_mfma_f32_16x16x32_bf16 a[152:155], a[12:15], a[72:75], a[152:155]
    buffer_load_dwordx4 v25, s[16:19], s66 offen offset:3072 lds
    v_mul_f32 v182, v182, v246
    v_mfma_f32_16x16x32_bf16 a[156:159], a[8:11], a[60:63], a[156:159]
    v_mul_f32 v183, v183, v247
    v_cvt_pk_bf16_f32 v86, v180, v181
    v_mfma_f32_16x16x32_bf16 a[156:159], a[12:15], a[76:79], a[156:159]
    s_waitcnt lgkmcnt(1)
    v_cvt_pk_bf16_f32 v87, v182, v183
    v_mfma_f32_16x16x32_bf16 a[160:163], a[0:3], a[48:51], a[160:163]
    s_add_u32 m0, s45, 12288
    ds_read_b64_tr_b16 a[8:9], v13 offset:16384
    ds_read_b64_tr_b16 a[10:11], v13 offset:16896
    v_mfma_f32_16x16x32_bf16 a[160:163], a[4:7], a[64:67], a[160:163]
    buffer_load_dwordx4 v22, s[16:19], s67 offen offset:0 lds
    v_mul_f32 v168, s44, v168
    v_mfma_f32_16x16x32_bf16 a[164:167], a[0:3], a[52:55], a[164:167]
    s_add_u32 s53, s67, 128
    ds_read_b64_tr_b16 a[12:13], v13 offset:20480
    ds_read_b64_tr_b16 a[14:15], v13 offset:20992
    v_mfma_f32_16x16x32_bf16 a[164:167], a[4:7], a[68:71], a[164:167]
    v_exp_f32 v168, v168
    v_mfma_f32_16x16x32_bf16 a[168:171], a[0:3], a[56:59], a[168:171]
    ds_read_b128 a[24:27], v1 offset:51200
    v_mul_f32 v169, s44, v169
    v_mfma_f32_16x16x32_bf16 a[168:171], a[4:7], a[72:75], a[168:171]
    buffer_load_dwordx4 v23, s[16:19], s67 offen offset:1024 lds
    v_mul_f32 v170, s44, v170
    v_mfma_f32_16x16x32_bf16 a[172:175], a[0:3], a[60:63], a[172:175]
    v_exp_f32 v169, v169
    v_mfma_f32_16x16x32_bf16 a[172:175], a[4:7], a[76:79], a[172:175]
    s_waitcnt vmcnt(6) lgkmcnt(1)
    v_exp_f32 v170, v170
    v_mfma_f32_16x16x32_bf16 a[176:179], a[8:11], a[48:51], a[176:179]
    ds_read_b64_tr_b16 a[0:1], v10 offset:0
    ds_read_b64_tr_b16 a[2:3], v10 offset:512
    v_mfma_f32_16x16x32_bf16 a[176:179], a[12:15], a[64:67], a[176:179]
    buffer_load_dwordx4 v24, s[16:19], s67 offen offset:2048 lds
    v_mul_f32 v171, s44, v171
    v_mfma_f32_16x16x32_bf16 a[180:183], a[8:11], a[52:55], a[180:183]
    ds_read_b64_tr_b16 a[4:5], v10 offset:4096
    ds_read_b64_tr_b16 a[6:7], v10 offset:4608
    v_mfma_f32_16x16x32_bf16 a[180:183], a[12:15], a[68:71], a[180:183]
    v_exp_f32 v171, v171
    v_mfma_f32_16x16x32_bf16 a[184:187], a[8:11], a[56:59], a[184:187]
    ds_read_b128 a[28:31], v1 offset:52224
    v_fma_f32 v168, v168, s62, s62
    v_mfma_f32_16x16x32_bf16 a[184:187], a[12:15], a[72:75], a[184:187]
    buffer_load_dwordx4 v25, s[16:19], s67 offen offset:3072 lds
    v_fma_f32 v169, v169, s62, s62
    v_mfma_f32_16x16x32_bf16 a[188:191], a[8:11], a[60:63], a[188:191]
    v_rcp_f32 v168, v168
    v_mfma_f32_16x16x32_bf16 a[188:191], a[12:15], a[76:79], a[188:191]
    s_waitcnt lgkmcnt(1)
    v_rcp_f32 v169, v169
    v_mfma_f32_16x16x32_bf16 a[192:195], a[0:3], a[48:51], a[192:195]
    s_add_u32 m0, s45, 16384
    ds_read_b64_tr_b16 a[8:9], v11 offset:0
    ds_read_b64_tr_b16 a[10:11], v11 offset:512
    v_mfma_f32_16x16x32_bf16 a[192:195], a[4:7], a[64:67], a[192:195]
    buffer_load_dwordx4 v22, s[16:19], s50 offen offset:0 lds
    v_fma_f32 v170, v170, s62, s62
    v_mfma_f32_16x16x32_bf16 a[196:199], a[0:3], a[52:55], a[196:199]
    ds_read_b64_tr_b16 a[12:13], v11 offset:4096
    ds_read_b64_tr_b16 a[14:15], v11 offset:4608
    v_mfma_f32_16x16x32_bf16 a[196:199], a[4:7], a[68:71], a[196:199]
    v_rcp_f32 v170, v170
    v_mfma_f32_16x16x32_bf16 a[200:203], a[0:3], a[56:59], a[200:203]
    ds_read_b128 a[32:35], v1 offset:53248
    v_fma_f32 v171, v171, s62, s62
    v_mfma_f32_16x16x32_bf16 a[200:203], a[4:7], a[72:75], a[200:203]
    buffer_load_dwordx4 v23, s[16:19], s50 offen offset:1024 lds
    v_mul_f32 v168, v168, v232
    v_mfma_f32_16x16x32_bf16 a[204:207], a[0:3], a[60:63], a[204:207]
    v_rcp_f32 v171, v171
    v_mfma_f32_16x16x32_bf16 a[204:207], a[4:7], a[76:79], a[204:207]
    s_waitcnt lgkmcnt(1)
    v_mul_f32 v169, v169, v233
    v_mfma_f32_16x16x32_bf16 a[208:211], a[8:11], a[48:51], a[208:211]
    ds_read_b64_tr_b16 a[0:1], v12 offset:0
    ds_read_b64_tr_b16 a[2:3], v12 offset:512
    v_mfma_f32_16x16x32_bf16 a[208:211], a[12:15], a[64:67], a[208:211]
    buffer_load_dwordx4 v24, s[16:19], s50 offen offset:2048 lds
    v_mul_f32 v170, v170, v234
    v_mfma_f32_16x16x32_bf16 a[212:215], a[8:11], a[52:55], a[212:215]
    ds_read_b64_tr_b16 a[4:5], v12 offset:4096
    ds_read_b64_tr_b16 a[6:7], v12 offset:4608
    v_mfma_f32_16x16x32_bf16 a[212:215], a[12:15], a[68:71], a[212:215]
    v_mul_f32 v171, v171, v235
    v_cvt_pk_bf16_f32 v88, v168, v169
    v_mfma_f32_16x16x32_bf16 a[216:219], a[8:11], a[56:59], a[216:219]
    ds_read_b128 a[36:39], v1 offset:54272
    v_cvt_pk_bf16_f32 v89, v170, v171
    v_mfma_f32_16x16x32_bf16 a[216:219], a[12:15], a[72:75], a[216:219]
    buffer_load_dwordx4 v25, s[16:19], s50 offen offset:3072 lds
    v_mul_f32 v184, s44, v184
    v_mfma_f32_16x16x32_bf16 a[220:223], a[8:11], a[60:63], a[220:223]
    v_exp_f32 v184, v184
    v_mfma_f32_16x16x32_bf16 a[220:223], a[12:15], a[76:79], a[220:223]
    s_waitcnt lgkmcnt(1)
    v_mul_f32 v185, s44, v185
    v_mul_f32 v186, s44, v186
    v_mfma_f32_16x16x32_bf16 a[224:227], a[0:3], a[48:51], a[224:227]
    s_add_u32 m0, s45, 20480
    ds_read_b64_tr_b16 a[8:9], v13 offset:0
    ds_read_b64_tr_b16 a[10:11], v13 offset:512
    v_mfma_f32_16x16x32_bf16 a[224:227], a[4:7], a[64:67], a[224:227]
    buffer_load_dwordx4 v22, s[16:19], s53 offen offset:0 lds
    v_mul_f32 v187, s44, v187
    v_mfma_f32_16x16x32_bf16 a[228:231], a[0:3], a[52:55], a[228:231]
    s_add_u32 s66, s66, 524288
    ds_read_b64_tr_b16 a[12:13], v13 offset:4096
    ds_read_b64_tr_b16 a[14:15], v13 offset:4608
    v_mfma_f32_16x16x32_bf16 a[228:231], a[4:7], a[68:71], a[228:231]
    s_sub_u32 s48, s66, 4194304
    v_exp_f32 v185, v185
    v_mfma_f32_16x16x32_bf16 a[232:235], a[0:3], a[56:59], a[232:235]
    s_min_u32 s66, s66, s48
    ds_read_b128 a[40:43], v1 offset:55296
    v_fma_f32 v184, v184, s62, s62
    v_mfma_f32_16x16x32_bf16 a[232:235], a[4:7], a[72:75], a[232:235]
    buffer_load_dwordx4 v23, s[16:19], s53 offen offset:1024 lds
    v_fma_f32 v185, v185, s62, s62
    v_mfma_f32_16x16x32_bf16 a[236:239], a[0:3], a[60:63], a[236:239]
    v_exp_f32 v186, v186
    v_mfma_f32_16x16x32_bf16 a[236:239], a[4:7], a[76:79], a[236:239]
    s_waitcnt vmcnt(6) lgkmcnt(1)
    v_exp_f32 v187, v187
    v_mfma_f32_16x16x32_bf16 a[240:243], a[8:11], a[48:51], a[240:243]
    ds_read_b64_tr_b16 a[0:1], v10 offset:8192
    ds_read_b64_tr_b16 a[2:3], v10 offset:8704
    v_mfma_f32_16x16x32_bf16 a[240:243], a[12:15], a[64:67], a[240:243]
    buffer_load_dwordx4 v24, s[16:19], s53 offen offset:2048 lds
    v_fma_f32 v186, v186, s62, s62
    v_mfma_f32_16x16x32_bf16 a[244:247], a[8:11], a[52:55], a[244:247]
    ds_read_b64_tr_b16 a[4:5], v10 offset:12288
    ds_read_b64_tr_b16 a[6:7], v10 offset:12800
    v_mfma_f32_16x16x32_bf16 a[244:247], a[12:15], a[68:71], a[244:247]
    v_rcp_f32 v184, v184
    v_mfma_f32_16x16x32_bf16 a[248:251], a[8:11], a[56:59], a[248:251]
    ds_read_b128 a[44:47], v1 offset:56320
    v_fma_f32 v187, v187, s62, s62
    v_mfma_f32_16x16x32_bf16 a[248:251], a[12:15], a[72:75], a[248:251]
    buffer_load_dwordx4 v25, s[16:19], s53 offen offset:3072 lds
    v_mul_f32 v184, v184, v248
    v_mfma_f32_16x16x32_bf16 a[252:255], a[8:11], a[60:63], a[252:255]
    v_rcp_f32 v185, v185
    v_mfma_f32_16x16x32_bf16 a[252:255], a[12:15], a[76:79], a[252:255]
    s_waitcnt lgkmcnt(0)
    v_rcp_f32 v186, v186
    v_mfma_f32_16x16x32_bf16 a[128:131], a[0:3], a[16:19], a[128:131]
    s_add_u32 m0, s45, 0
    ds_read_b64_tr_b16 a[8:9], v11 offset:8192
    ds_read_b64_tr_b16 a[10:11], v11 offset:8704
    v_mfma_f32_16x16x32_bf16 a[128:131], a[4:7], a[32:35], a[128:131]
    buffer_load_dwordx4 v22, s[16:19], s66 offen offset:0 lds
    v_mul_f32 v185, v185, v249
    v_mfma_f32_16x16x32_bf16 a[132:135], a[0:3], a[20:23], a[132:135]
    s_add_u32 s67, s67, 524288
    ds_read_b64_tr_b16 a[12:13], v11 offset:12288
    ds_read_b64_tr_b16 a[14:15], v11 offset:12800
    v_mfma_f32_16x16x32_bf16 a[132:135], a[4:7], a[36:39], a[132:135]
    s_sub_u32 s48, s67, 4194304
    v_rcp_f32 v187, v187
    v_mfma_f32_16x16x32_bf16 a[136:139], a[0:3], a[24:27], a[136:139]
    s_min_u32 s67, s67, s48
    ds_read_b128 a[48:51], v1 offset:57344
    v_mul_f32 v186, v186, v250
    v_mfma_f32_16x16x32_bf16 a[136:139], a[4:7], a[40:43], a[136:139]
    buffer_load_dwordx4 v23, s[16:19], s66 offen offset:1024 lds
    v_mul_f32 v187, v187, v251
    v_mfma_f32_16x16x32_bf16 a[140:143], a[0:3], a[28:31], a[140:143]
    s_add_u32 s50, s66, 128
    v_cvt_pk_bf16_f32 v90, v184, v185
    v_cvt_pk_bf16_f32 v91, v186, v187
    v_mfma_f32_16x16x32_bf16 a[140:143], a[4:7], a[44:47], a[140:143]
    s_waitcnt lgkmcnt(1)
    v_mfma_f32_16x16x32_bf16 a[144:147], a[8:11], a[16:19], a[144:147]
    ds_read_b64_tr_b16 a[0:1], v12 offset:8192
    ds_read_b64_tr_b16 a[2:3], v12 offset:8704
    v_mfma_f32_16x16x32_bf16 a[144:147], a[12:15], a[32:35], a[144:147]
    buffer_load_dwordx4 v24, s[16:19], s66 offen offset:2048 lds
    v_mul_f32 v172, s44, v172
    v_mfma_f32_16x16x32_bf16 a[148:151], a[8:11], a[20:23], a[148:151]
    ds_read_b64_tr_b16 a[4:5], v12 offset:12288
    ds_read_b64_tr_b16 a[6:7], v12 offset:12800
    v_mfma_f32_16x16x32_bf16 a[148:151], a[12:15], a[36:39], a[148:151]
    v_exp_f32 v172, v172
    v_mfma_f32_16x16x32_bf16 a[152:155], a[8:11], a[24:27], a[152:155]
    ds_read_b128 a[52:55], v1 offset:58368
    v_mul_f32 v173, s44, v173
    v_mfma_f32_16x16x32_bf16 a[152:155], a[12:15], a[40:43], a[152:155]
    buffer_load_dwordx4 v25, s[16:19], s66 offen offset:3072 lds
    v_mul_f32 v174, s44, v174
    v_mfma_f32_16x16x32_bf16 a[156:159], a[8:11], a[28:31], a[156:159]
    v_exp_f32 v173, v173
    v_mfma_f32_16x16x32_bf16 a[156:159], a[12:15], a[44:47], a[156:159]
    s_waitcnt lgkmcnt(1)
    v_exp_f32 v174, v174
    v_mfma_f32_16x16x32_bf16 a[160:163], a[0:3], a[16:19], a[160:163]
    s_add_u32 m0, s45, 4096
    ds_read_b64_tr_b16 a[8:9], v13 offset:8192
    ds_read_b64_tr_b16 a[10:11], v13 offset:8704
    v_mfma_f32_16x16x32_bf16 a[160:163], a[4:7], a[32:35], a[160:163]
    buffer_load_dwordx4 v22, s[16:19], s67 offen offset:0 lds
    v_mul_f32 v175, s44, v175
    v_mfma_f32_16x16x32_bf16 a[164:167], a[0:3], a[20:23], a[164:167]
    s_add_u32 s53, s67, 128
    ds_read_b64_tr_b16 a[12:13], v13 offset:12288
    ds_read_b64_tr_b16 a[14:15], v13 offset:12800
    v_mfma_f32_16x16x32_bf16 a[164:167], a[4:7], a[36:39], a[164:167]
    v_exp_f32 v175, v175
    v_mfma_f32_16x16x32_bf16 a[168:171], a[0:3], a[24:27], a[168:171]
    ds_read_b128 a[56:59], v1 offset:59392
    v_fma_f32 v172, v172, s62, s62
    v_mfma_f32_16x16x32_bf16 a[168:171], a[4:7], a[40:43], a[168:171]
    buffer_load_dwordx4 v23, s[16:19], s67 offen offset:1024 lds
    v_fma_f32 v173, v173, s62, s62
    v_mfma_f32_16x16x32_bf16 a[172:175], a[0:3], a[28:31], a[172:175]
    v_rcp_f32 v172, v172
    v_mfma_f32_16x16x32_bf16 a[172:175], a[4:7], a[44:47], a[172:175]
    s_waitcnt vmcnt(6) lgkmcnt(1)
    v_rcp_f32 v173, v173
    v_mfma_f32_16x16x32_bf16 a[176:179], a[8:11], a[16:19], a[176:179]
    ds_read_b64_tr_b16 a[0:1], v10 offset:16384
    ds_read_b64_tr_b16 a[2:3], v10 offset:16896
    v_mfma_f32_16x16x32_bf16 a[176:179], a[12:15], a[32:35], a[176:179]
    buffer_load_dwordx4 v24, s[16:19], s67 offen offset:2048 lds
    v_fma_f32 v174, v174, s62, s62
    v_mfma_f32_16x16x32_bf16 a[180:183], a[8:11], a[20:23], a[180:183]
    ds_read_b64_tr_b16 a[4:5], v10 offset:20480
    ds_read_b64_tr_b16 a[6:7], v10 offset:20992
    v_mfma_f32_16x16x32_bf16 a[180:183], a[12:15], a[36:39], a[180:183]
    v_rcp_f32 v174, v174
    v_mfma_f32_16x16x32_bf16 a[184:187], a[8:11], a[24:27], a[184:187]
    ds_read_b128 a[60:63], v1 offset:60416
    v_fma_f32 v175, v175, s62, s62
    v_mfma_f32_16x16x32_bf16 a[184:187], a[12:15], a[40:43], a[184:187]
    buffer_load_dwordx4 v25, s[16:19], s67 offen offset:3072 lds
    v_mul_f32 v172, v172, v236
    v_mfma_f32_16x16x32_bf16 a[188:191], a[8:11], a[28:31], a[188:191]
    v_rcp_f32 v175, v175
    v_mfma_f32_16x16x32_bf16 a[188:191], a[12:15], a[44:47], a[188:191]
    s_waitcnt lgkmcnt(1)
    v_mul_f32 v173, v173, v237
    v_mfma_f32_16x16x32_bf16 a[192:195], a[0:3], a[16:19], a[192:195]
    s_add_u32 m0, s45, 8192
    ds_read_b64_tr_b16 a[8:9], v11 offset:16384
    ds_read_b64_tr_b16 a[10:11], v11 offset:16896
    v_mfma_f32_16x16x32_bf16 a[192:195], a[4:7], a[32:35], a[192:195]
    buffer_load_dwordx4 v22, s[16:19], s50 offen offset:0 lds
    v_mul_f32 v174, v174, v238
    v_mfma_f32_16x16x32_bf16 a[196:199], a[0:3], a[20:23], a[196:199]
    ds_read_b64_tr_b16 a[12:13], v11 offset:20480
    ds_read_b64_tr_b16 a[14:15], v11 offset:20992
    v_mfma_f32_16x16x32_bf16 a[196:199], a[4:7], a[36:39], a[196:199]
    v_mul_f32 v175, v175, v239
    v_cvt_pk_bf16_f32 v92, v172, v173
    v_mfma_f32_16x16x32_bf16 a[200:203], a[0:3], a[24:27], a[200:203]
    ds_read_b128 a[64:67], v1 offset:61440
    v_cvt_pk_bf16_f32 v93, v174, v175
    v_mfma_f32_16x16x32_bf16 a[200:203], a[4:7], a[40:43], a[200:203]
    buffer_load_dwordx4 v23, s[16:19], s50 offen offset:1024 lds
    v_mul_f32 v188, s44, v188
    v_mfma_f32_16x16x32_bf16 a[204:207], a[0:3], a[28:31], a[204:207]
    v_exp_f32 v188, v188
    v_mfma_f32_16x16x32_bf16 a[204:207], a[4:7], a[44:47], a[204:207]
    s_waitcnt lgkmcnt(1)
    v_mul_f32 v189, s44, v189
    v_mul_f32 v190, s44, v190
    v_mfma_f32_16x16x32_bf16 a[208:211], a[8:11], a[16:19], a[208:211]
    ds_read_b64_tr_b16 a[0:1], v12 offset:16384
    ds_read_b64_tr_b16 a[2:3], v12 offset:16896
    v_mfma_f32_16x16x32_bf16 a[208:211], a[12:15], a[32:35], a[208:211]
    buffer_load_dwordx4 v24, s[16:19], s50 offen offset:2048 lds
    v_mul_f32 v191, s44, v191
    v_mfma_f32_16x16x32_bf16 a[212:215], a[8:11], a[20:23], a[212:215]
    ds_read_b64_tr_b16 a[4:5], v12 offset:20480
    ds_read_b64_tr_b16 a[6:7], v12 offset:20992
    v_mfma_f32_16x16x32_bf16 a[212:215], a[12:15], a[36:39], a[212:215]
    v_exp_f32 v189, v189
    v_mfma_f32_16x16x32_bf16 a[216:219], a[8:11], a[24:27], a[216:219]
    ds_read_b128 a[68:71], v1 offset:62464
    v_fma_f32 v188, v188, s62, s62
    v_mfma_f32_16x16x32_bf16 a[216:219], a[12:15], a[40:43], a[216:219]
    buffer_load_dwordx4 v25, s[16:19], s50 offen offset:3072 lds
    v_fma_f32 v189, v189, s62, s62
    v_mfma_f32_16x16x32_bf16 a[220:223], a[8:11], a[28:31], a[220:223]
    v_exp_f32 v190, v190
    v_mfma_f32_16x16x32_bf16 a[220:223], a[12:15], a[44:47], a[220:223]
    s_waitcnt lgkmcnt(1)
    v_exp_f32 v191, v191
    v_mfma_f32_16x16x32_bf16 a[224:227], a[0:3], a[16:19], a[224:227]
    s_add_u32 m0, s45, 12288
    ds_read_b64_tr_b16 a[8:9], v13 offset:16384
    ds_read_b64_tr_b16 a[10:11], v13 offset:16896
    v_mfma_f32_16x16x32_bf16 a[224:227], a[4:7], a[32:35], a[224:227]
    buffer_load_dwordx4 v22, s[16:19], s53 offen offset:0 lds
    v_fma_f32 v190, v190, s62, s62
    v_mfma_f32_16x16x32_bf16 a[228:231], a[0:3], a[20:23], a[228:231]
    ds_read_b64_tr_b16 a[12:13], v13 offset:20480
    ds_read_b64_tr_b16 a[14:15], v13 offset:20992
    v_mfma_f32_16x16x32_bf16 a[228:231], a[4:7], a[36:39], a[228:231]
    v_rcp_f32 v188, v188
    v_mfma_f32_16x16x32_bf16 a[232:235], a[0:3], a[24:27], a[232:235]
    ds_read_b128 a[72:75], v1 offset:63488
    v_fma_f32 v191, v191, s62, s62
    v_mfma_f32_16x16x32_bf16 a[232:235], a[4:7], a[40:43], a[232:235]
    buffer_load_dwordx4 v23, s[16:19], s53 offen offset:1024 lds
    v_mul_f32 v188, v188, v252
    v_mfma_f32_16x16x32_bf16 a[236:239], a[0:3], a[28:31], a[236:239]
    v_rcp_f32 v189, v189
    v_mfma_f32_16x16x32_bf16 a[236:239], a[4:7], a[44:47], a[236:239]
    s_waitcnt vmcnt(6) lgkmcnt(1)
    v_rcp_f32 v190, v190
    v_mfma_f32_16x16x32_bf16 a[240:243], a[8:11], a[16:19], a[240:243]
    ds_read_b64_tr_b16 a[0:1], v10 offset:0
    ds_read_b64_tr_b16 a[2:3], v10 offset:512
    v_mfma_f32_16x16x32_bf16 a[240:243], a[12:15], a[32:35], a[240:243]
    buffer_load_dwordx4 v24, s[16:19], s53 offen offset:2048 lds
    v_mul_f32 v189, v189, v253
    v_mfma_f32_16x16x32_bf16 a[244:247], a[8:11], a[20:23], a[244:247]
    ds_read_b64_tr_b16 a[4:5], v10 offset:4096
    ds_read_b64_tr_b16 a[6:7], v10 offset:4608
    v_mfma_f32_16x16x32_bf16 a[244:247], a[12:15], a[36:39], a[244:247]
    v_rcp_f32 v191, v191
    v_mfma_f32_16x16x32_bf16 a[248:251], a[8:11], a[24:27], a[248:251]
    ds_read_b128 a[76:79], v1 offset:64512
    v_mul_f32 v190, v190, v254
    v_mfma_f32_16x16x32_bf16 a[248:251], a[12:15], a[40:43], a[248:251]
    buffer_load_dwordx4 v25, s[16:19], s53 offen offset:3072 lds
    v_mul_f32 v191, v191, v255
    v_mfma_f32_16x16x32_bf16 a[252:255], a[8:11], a[28:31], a[252:255]
    v_cvt_pk_bf16_f32 v94, v188, v189
    v_cvt_pk_bf16_f32 v95, v190, v191
    v_mfma_f32_16x16x32_bf16 a[252:255], a[12:15], a[44:47], a[252:255]
    s_waitcnt lgkmcnt(0)
    v_mfma_f32_16x16x32_bf16 a[128:131], a[0:3], a[48:51], a[128:131]
    s_add_u32 m0, s45, 16384
    ds_read_b64_tr_b16 a[8:9], v11 offset:0
    ds_read_b64_tr_b16 a[10:11], v11 offset:512
    v_mfma_f32_16x16x32_bf16 a[128:131], a[4:7], a[64:67], a[128:131]
    buffer_load_dwordx4 v26, s[32:35], s68 offen offset:0 lds
    v_mfma_f32_16x16x32_bf16 a[132:135], a[0:3], a[52:55], a[132:135]
    s_add_u32 s50, s68, 128
    ds_read_b64_tr_b16 a[12:13], v11 offset:4096
    ds_read_b64_tr_b16 a[14:15], v11 offset:4608
    v_mfma_f32_16x16x32_bf16 a[132:135], a[4:7], a[68:71], a[132:135]
    v_mfma_f32_16x16x32_bf16 a[136:139], a[0:3], a[56:59], a[136:139]
    v_mfma_f32_16x16x32_bf16 a[136:139], a[4:7], a[72:75], a[136:139]
    buffer_load_dwordx4 v27, s[32:35], s68 offen offset:1024 lds
    v_mfma_f32_16x16x32_bf16 a[140:143], a[0:3], a[60:63], a[140:143]
    v_mfma_f32_16x16x32_bf16 a[140:143], a[4:7], a[76:79], a[140:143]
    s_waitcnt lgkmcnt(0)
    v_mfma_f32_16x16x32_bf16 a[144:147], a[8:11], a[48:51], a[144:147]
    ds_read_b64_tr_b16 a[0:1], v12 offset:0
    ds_read_b64_tr_b16 a[2:3], v12 offset:512
    v_mfma_f32_16x16x32_bf16 a[144:147], a[12:15], a[64:67], a[144:147]
    buffer_load_dwordx4 v28, s[32:35], s68 offen offset:2048 lds
    v_mfma_f32_16x16x32_bf16 a[148:151], a[8:11], a[52:55], a[148:151]
    ds_read_b64_tr_b16 a[4:5], v12 offset:4096
    ds_read_b64_tr_b16 a[6:7], v12 offset:4608
    v_mfma_f32_16x16x32_bf16 a[148:151], a[12:15], a[68:71], a[148:151]
    v_mfma_f32_16x16x32_bf16 a[152:155], a[8:11], a[56:59], a[152:155]
    v_mfma_f32_16x16x32_bf16 a[152:155], a[12:15], a[72:75], a[152:155]
    buffer_load_dwordx4 v29, s[32:35], s68 offen offset:3072 lds
    v_mfma_f32_16x16x32_bf16 a[156:159], a[8:11], a[60:63], a[156:159]
    v_mfma_f32_16x16x32_bf16 a[156:159], a[12:15], a[76:79], a[156:159]
    s_waitcnt lgkmcnt(0)
    v_mfma_f32_16x16x32_bf16 a[160:163], a[0:3], a[48:51], a[160:163]
    s_add_u32 m0, s45, 20480
    ds_read_b64_tr_b16 a[8:9], v13 offset:0
    ds_read_b64_tr_b16 a[10:11], v13 offset:512
    v_mfma_f32_16x16x32_bf16 a[160:163], a[4:7], a[64:67], a[160:163]
    buffer_load_dwordx4 v26, s[32:35], s50 offen offset:0 lds
    v_mfma_f32_16x16x32_bf16 a[164:167], a[0:3], a[52:55], a[164:167]
    ds_read_b64_tr_b16 a[12:13], v13 offset:4096
    ds_read_b64_tr_b16 a[14:15], v13 offset:4608
    v_mfma_f32_16x16x32_bf16 a[164:167], a[4:7], a[68:71], a[164:167]
    v_mfma_f32_16x16x32_bf16 a[168:171], a[0:3], a[56:59], a[168:171]
    v_mfma_f32_16x16x32_bf16 a[168:171], a[4:7], a[72:75], a[168:171]
    buffer_load_dwordx4 v27, s[32:35], s50 offen offset:1024 lds
    v_mfma_f32_16x16x32_bf16 a[172:175], a[0:3], a[60:63], a[172:175]
    ds_write_b128 v53, v[80:83] offset:0
    ds_write_b128 v53, v[84:87] offset:1024
    ds_write_b128 v53, v[88:91] offset:2048
    ds_write_b128 v53, v[92:95] offset:3072
    v_mfma_f32_16x16x32_bf16 a[172:175], a[4:7], a[76:79], a[172:175]
    s_waitcnt vmcnt(6) lgkmcnt(4)
    v_mfma_f32_16x16x32_bf16 a[176:179], a[8:11], a[48:51], a[176:179]
    ds_read_b64_tr_b16 a[0:1], v10 offset:8192
    ds_read_b64_tr_b16 a[2:3], v10 offset:8704
    v_mfma_f32_16x16x32_bf16 a[176:179], a[12:15], a[64:67], a[176:179]
    buffer_load_dwordx4 v28, s[32:35], s50 offen offset:2048 lds
    v_mfma_f32_16x16x32_bf16 a[180:183], a[8:11], a[52:55], a[180:183]
    ds_read_b64_tr_b16 a[4:5], v10 offset:12288
    ds_read_b64_tr_b16 a[6:7], v10 offset:12800
    v_mfma_f32_16x16x32_bf16 a[180:183], a[12:15], a[68:71], a[180:183]
    v_mfma_f32_16x16x32_bf16 a[184:187], a[8:11], a[56:59], a[184:187]
    v_mfma_f32_16x16x32_bf16 a[184:187], a[12:15], a[72:75], a[184:187]
    s_waitcnt lgkmcnt(4)
    buffer_load_dwordx4 v29, s[32:35], s50 offen offset:3072 lds
    v_mfma_f32_16x16x32_bf16 a[188:191], a[8:11], a[60:63], a[188:191]
    s_barrier
    v_mfma_f32_16x16x32_bf16 a[188:191], a[12:15], a[76:79], a[188:191]
    s_waitcnt lgkmcnt(0)
    v_mfma_f32_16x16x32_bf16 a[192:195], a[0:3], a[48:51], a[192:195]
    s_add_u32 m0, s45, 0
    ds_read_b64_tr_b16 a[8:9], v11 offset:8192
    ds_read_b64_tr_b16 a[10:11], v11 offset:8704
    v_mfma_f32_16x16x32_bf16 a[192:195], a[4:7], a[64:67], a[192:195]
    buffer_load_dwordx4 v26, s[32:35], s69 offen offset:0 lds
    v_mfma_f32_16x16x32_bf16 a[196:199], a[0:3], a[52:55], a[196:199]
    s_add_u32 s68, s68, 65536
    ds_read_b64_tr_b16 a[12:13], v11 offset:12288
    ds_read_b64_tr_b16 a[14:15], v11 offset:12800
    v_mfma_f32_16x16x32_bf16 a[196:199], a[4:7], a[68:71], a[196:199]
    s_sub_u32 s48, s68, 229376
    v_mfma_f32_16x16x32_bf16 a[200:203], a[0:3], a[56:59], a[200:203]
    s_min_u32 s68, s68, s48
    ds_read_b128 a[16:19], v1 offset:0
    v_mfma_f32_16x16x32_bf16 a[200:203], a[4:7], a[72:75], a[200:203]
    buffer_load_dwordx4 v27, s[32:35], s69 offen offset:1024 lds
    v_mfma_f32_16x16x32_bf16 a[204:207], a[0:3], a[60:63], a[204:207]
    s_add_u32 s53, s69, 128
    v_mfma_f32_16x16x32_bf16 a[204:207], a[4:7], a[76:79], a[204:207]
    s_waitcnt lgkmcnt(1)
    v_mfma_f32_16x16x32_bf16 a[208:211], a[8:11], a[48:51], a[208:211]
    ds_read_b64_tr_b16 a[0:1], v12 offset:8192
    ds_read_b64_tr_b16 a[2:3], v12 offset:8704
    v_mfma_f32_16x16x32_bf16 a[208:211], a[12:15], a[64:67], a[208:211]
    buffer_load_dwordx4 v28, s[32:35], s69 offen offset:2048 lds
    v_mfma_f32_16x16x32_bf16 a[212:215], a[8:11], a[52:55], a[212:215]
    ds_read_b64_tr_b16 a[4:5], v12 offset:12288
    ds_read_b64_tr_b16 a[6:7], v12 offset:12800
    v_mfma_f32_16x16x32_bf16 a[212:215], a[12:15], a[68:71], a[212:215]
    v_mfma_f32_16x16x32_bf16 a[216:219], a[8:11], a[56:59], a[216:219]
    ds_read_b128 a[20:23], v1 offset:1024
    v_mfma_f32_16x16x32_bf16 a[216:219], a[12:15], a[72:75], a[216:219]
    buffer_load_dwordx4 v29, s[32:35], s69 offen offset:3072 lds
    v_mfma_f32_16x16x32_bf16 a[220:223], a[8:11], a[60:63], a[220:223]
    v_mfma_f32_16x16x32_bf16 a[220:223], a[12:15], a[76:79], a[220:223]
    s_waitcnt lgkmcnt(1)
    v_mfma_f32_16x16x32_bf16 a[224:227], a[0:3], a[48:51], a[224:227]
    s_add_u32 m0, s45, 4096
    ds_read_b64_tr_b16 a[8:9], v13 offset:8192
    ds_read_b64_tr_b16 a[10:11], v13 offset:8704
    v_mfma_f32_16x16x32_bf16 a[224:227], a[4:7], a[64:67], a[224:227]
    buffer_load_dwordx4 v26, s[32:35], s53 offen offset:0 lds
    v_mfma_f32_16x16x32_bf16 a[228:231], a[0:3], a[52:55], a[228:231]
    ds_read_b64_tr_b16 a[12:13], v13 offset:12288
    ds_read_b64_tr_b16 a[14:15], v13 offset:12800
    v_mfma_f32_16x16x32_bf16 a[228:231], a[4:7], a[68:71], a[228:231]
    v_mfma_f32_16x16x32_bf16 a[232:235], a[0:3], a[56:59], a[232:235]
    ds_read_b128 a[24:27], v1 offset:2048
    v_mfma_f32_16x16x32_bf16 a[232:235], a[4:7], a[72:75], a[232:235]
    buffer_load_dwordx4 v27, s[32:35], s53 offen offset:1024 lds
    v_mfma_f32_16x16x32_bf16 a[236:239], a[0:3], a[60:63], a[236:239]
    v_mfma_f32_16x16x32_bf16 a[236:239], a[4:7], a[76:79], a[236:239]
    s_waitcnt vmcnt(10) lgkmcnt(1)
    v_mfma_f32_16x16x32_bf16 a[240:243], a[8:11], a[48:51], a[240:243]
    ds_read_b64_tr_b16 a[0:1], v14 offset:16384
    ds_read_b64_tr_b16 a[2:3], v14 offset:18432
    v_mfma_f32_16x16x32_bf16 a[240:243], a[12:15], a[64:67], a[240:243]
    buffer_load_dwordx4 v28, s[32:35], s53 offen offset:2048 lds
    v_mfma_f32_16x16x32_bf16 a[244:247], a[8:11], a[52:55], a[244:247]
    ds_read_b64_tr_b16 a[4:5], v15 offset:16384
    ds_read_b64_tr_b16 a[6:7], v15 offset:18432
    v_mfma_f32_16x16x32_bf16 a[244:247], a[12:15], a[68:71], a[244:247]
    v_mfma_f32_16x16x32_bf16 a[248:251], a[8:11], a[56:59], a[248:251]
    ds_read_b128 a[28:31], v1 offset:3072
    v_mfma_f32_16x16x32_bf16 a[248:251], a[12:15], a[72:75], a[248:251]
    buffer_load_dwordx4 v29, s[32:35], s53 offen offset:3072 lds
    v_mfma_f32_16x16x32_bf16 a[252:255], a[8:11], a[60:63], a[252:255]
    v_mfma_f32_16x16x32_bf16 a[252:255], a[12:15], a[76:79], a[252:255]
    s_waitcnt lgkmcnt(0)
    v_mfma_f32_16x16x32_bf16 v[128:131], a[0:3], a[16:19], 0
    s_add_u32 m0, s45, 8192
    ds_read_b64_tr_b16 a[8:9], v16 offset:16384
    ds_read_b64_tr_b16 a[10:11], v16 offset:18432
    v_mfma_f32_16x16x32_bf16 v[144:147], a[4:7], a[16:19], 0
    buffer_load_dwordx4 v26, s[32:35], s68 offen offset:0 lds
    v_mfma_f32_16x16x32_bf16 v[132:135], a[0:3], a[20:23], 0
    s_add_u32 s69, s69, 65536
    ds_read_b64_tr_b16 a[12:13], v17 offset:16384
    ds_read_b64_tr_b16 a[14:15], v17 offset:18432
    v_mfma_f32_16x16x32_bf16 v[148:151], a[4:7], a[20:23], 0
    s_sub_u32 s48, s69, 229376
    v_mfma_f32_16x16x32_bf16 v[136:139], a[0:3], a[24:27], 0
    s_min_u32 s69, s69, s48
    ds_read_b128 a[32:35], v1 offset:4096
    v_accvgpr_read_b32 v2, a128
    v_mfma_f32_16x16x32_bf16 v[152:155], a[4:7], a[24:27], 0
    buffer_load_dwordx4 v27, s[32:35], s68 offen offset:1024 lds
    v_accvgpr_read_b32 v3, a129
    v_mfma_f32_16x16x32_bf16 v[140:143], a[0:3], a[28:31], 0
    s_add_u32 s50, s68, 128
    v_accvgpr_read_b32 v4, a130
    v_accvgpr_read_b32 v5, a131
    v_mfma_f32_16x16x32_bf16 v[156:159], a[4:7], a[28:31], 0
    s_waitcnt vmcnt(10) lgkmcnt(1)
    v_accvgpr_read_b32 v6, a144
    v_mfma_f32_16x16x32_bf16 v[160:163], a[8:11], a[16:19], 0
    ds_read_b64_tr_b16 a[0:1], v14 offset:20480
    ds_read_b64_tr_b16 a[2:3], v14 offset:22528
    v_mfma_f32_16x16x32_bf16 v[176:179], a[12:15], a[16:19], 0
    buffer_load_dwordx4 v28, s[32:35], s68 offen offset:2048 lds
    v_accvgpr_read_b32 v7, a145
    v_mfma_f32_16x16x32_bf16 v[164:167], a[8:11], a[20:23], 0
    ds_read_b64_tr_b16 a[4:5], v15 offset:20480
    ds_read_b64_tr_b16 a[6:7], v15 offset:22528
    v_mfma_f32_16x16x32_bf16 v[180:183], a[12:15], a[20:23], 0
    v_accvgpr_read_b32 v8, a146
    v_accvgpr_read_b32 v9, a147
    v_mfma_f32_16x16x32_bf16 v[168:171], a[8:11], a[24:27], 0
    ds_read_b128 a[36:39], v1 offset:5120
    v_cvt_pk_bf16_f32 v64, v2, v3
    v_mfma_f32_16x16x32_bf16 v[184:187], a[12:15], a[24:27], 0
    buffer_load_dwordx4 v29, s[32:35], s68 offen offset:3072 lds
    v_cvt_pk_bf16_f32 v66, v6, v7
    v_mfma_f32_16x16x32_bf16 v[172:175], a[8:11], a[28:31], 0
    v_cvt_pk_bf16_f32 v65, v4, v5
    v_cvt_pk_bf16_f32 v67, v8, v9
    v_mfma_f32_16x16x32_bf16 v[188:191], a[12:15], a[28:31], 0
    s_waitcnt lgkmcnt(1)
    v_accvgpr_read_b32 v2, a160
    v_mfma_f32_16x16x32_bf16 v[192:195], a[0:3], a[16:19], 0
    s_add_u32 m0, s45, 12288
    ds_read_b64_tr_b16 a[8:9], v16 offset:20480
    ds_read_b64_tr_b16 a[10:11], v16 offset:22528
    v_mfma_f32_16x16x32_bf16 v[208:211], a[4:7], a[16:19], 0
    buffer_load_dwordx4 v26, s[32:35], s50 offen offset:0 lds
    v_accvgpr_read_b32 v3, a161
    v_mfma_f32_16x16x32_bf16 v[196:199], a[0:3], a[20:23], 0
    ds_read_b64_tr_b16 a[12:13], v17 offset:20480
    ds_read_b64_tr_b16 a[14:15], v17 offset:22528
    v_mfma_f32_16x16x32_bf16 v[212:215], a[4:7], a[20:23], 0
    v_accvgpr_read_b32 v4, a162
    v_accvgpr_read_b32 v5, a163
    v_mfma_f32_16x16x32_bf16 v[200:203], a[0:3], a[24:27], 0
    ds_read_b128 a[40:43], v1 offset:6144
    v_accvgpr_read_b32 v6, a176
    v_mfma_f32_16x16x32_bf16 v[216:219], a[4:7], a[24:27], 0
    buffer_load_dwordx4 v27, s[32:35], s50 offen offset:1024 lds
    v_accvgpr_read_b32 v7, a177
    v_mfma_f32_16x16x32_bf16 v[204:207], a[0:3], a[28:31], 0
    v_accvgpr_read_b32 v8, a178
    v_accvgpr_read_b32 v9, a179
    v_mfma_f32_16x16x32_bf16 v[220:223], a[4:7], a[28:31], 0
    s_waitcnt vmcnt(10) lgkmcnt(1)
    v_permlane16_swap_b32 v64, v66
    v_mfma_f32_16x16x32_bf16 v[224:227], a[8:11], a[16:19], 0
    ds_read_b64_tr_b16 a[0:1], v14 offset:0
    ds_read_b64_tr_b16 a[2:3], v14 offset:2048
    v_mfma_f32_16x16x32_bf16 v[240:243], a[12:15], a[16:19], 0
    buffer_load_dwordx4 v28, s[32:35], s50 offen offset:2048 lds
    v_permlane16_swap_b32 v65, v67
    v_mfma_f32_16x16x32_bf16 v[228:231], a[8:11], a[20:23], 0
    ds_read_b64_tr_b16 a[4:5], v15 offset:0
    ds_read_b64_tr_b16 a[6:7], v15 offset:2048
    v_mfma_f32_16x16x32_bf16 v[244:247], a[12:15], a[20:23], 0
    v_cvt_pk_bf16_f32 v68, v2, v3
    v_cvt_pk_bf16_f32 v70, v6, v7
    v_mfma_f32_16x16x32_bf16 v[232:235], a[8:11], a[24:27], 0
    ds_read_b128 a[44:47], v1 offset:7168
    v_cvt_pk_bf16_f32 v69, v4, v5
    v_mfma_f32_16x16x32_bf16 v[248:251], a[12:15], a[24:27], 0
    buffer_load_dwordx4 v29, s[32:35], s50 offen offset:3072 lds
    v_cvt_pk_bf16_f32 v71, v8, v9
    v_mfma_f32_16x16x32_bf16 v[236:239], a[8:11], a[28:31], 0
    v_accvgpr_read_b32 v2, a192
    v_accvgpr_read_b32 v3, a193
    v_mfma_f32_16x16x32_bf16 v[252:255], a[12:15], a[28:31], 0
    s_waitcnt lgkmcnt(0)
    v_accvgpr_read_b32 v4, a194
    v_mfma_f32_16x16x32_bf16 v[128:131], a[0:3], a[32:35], v[128:131]
    s_add_u32 m0, s45, 16384
    ds_read_b64_tr_b16 a[8:9], v16 offset:0
    ds_read_b64_tr_b16 a[10:11], v16 offset:2048
    v_mfma_f32_16x16x32_bf16 v[144:147], a[4:7], a[32:35], v[144:147]
    buffer_load_dwordx4 v26, s[32:35], s69 offen offset:0 lds
    v_accvgpr_read_b32 v5, a195
    v_mfma_f32_16x16x32_bf16 v[132:135], a[0:3], a[36:39], v[132:135]
    s_add_u32 s68, s68, 65536
    ds_read_b64_tr_b16 a[12:13], v17 offset:0
    ds_read_b64_tr_b16 a[14:15], v17 offset:2048
    v_mfma_f32_16x16x32_bf16 v[148:151], a[4:7], a[36:39], v[148:151]
    s_sub_u32 s48, s68, 229376
    v_accvgpr_read_b32 v6, a208
    v_accvgpr_read_b32 v7, a209
    v_mfma_f32_16x16x32_bf16 v[136:139], a[0:3], a[40:43], v[136:139]
    s_min_u32 s68, s68, s48
    ds_read_b128 a[48:51], v1 offset:8192
    v_accvgpr_read_b32 v8, a210
    v_mfma_f32_16x16x32_bf16 v[152:155], a[4:7], a[40:43], v[152:155]
    buffer_load_dwordx4 v27, s[32:35], s69 offen offset:1024 lds
    v_accvgpr_read_b32 v9, a211
    v_mfma_f32_16x16x32_bf16 v[140:143], a[0:3], a[44:47], v[140:143]
    s_add_u32 s53, s69, 128
    v_permlane16_swap_b32 v68, v70
    v_permlane16_swap_b32 v69, v71
    v_mfma_f32_16x16x32_bf16 v[156:159], a[4:7], a[44:47], v[156:159]
    s_waitcnt vmcnt(10) lgkmcnt(1)
    v_cvt_pk_bf16_f32 v72, v2, v3
    v_mfma_f32_16x16x32_bf16 v[160:163], a[8:11], a[32:35], v[160:163]
    ds_read_b64_tr_b16 a[0:1], v14 offset:4096
    ds_read_b64_tr_b16 a[2:3], v14 offset:6144
    v_mfma_f32_16x16x32_bf16 v[176:179], a[12:15], a[32:35], v[176:179]
    buffer_load_dwordx4 v28, s[32:35], s69 offen offset:2048 lds
    v_cvt_pk_bf16_f32 v74, v6, v7
    v_mfma_f32_16x16x32_bf16 v[164:167], a[8:11], a[36:39], v[164:167]
    ds_read_b64_tr_b16 a[4:5], v15 offset:4096
    ds_read_b64_tr_b16 a[6:7], v15 offset:6144
    v_mfma_f32_16x16x32_bf16 v[180:183], a[12:15], a[36:39], v[180:183]
    v_cvt_pk_bf16_f32 v73, v4, v5
    v_cvt_pk_bf16_f32 v75, v8, v9
    v_mfma_f32_16x16x32_bf16 v[168:171], a[8:11], a[40:43], v[168:171]
    ds_read_b128 a[52:55], v1 offset:9216
    v_accvgpr_read_b32 v2, a224
    v_mfma_f32_16x16x32_bf16 v[184:187], a[12:15], a[40:43], v[184:187]
    buffer_load_dwordx4 v29, s[32:35], s69 offen offset:3072 lds
    v_accvgpr_read_b32 v3, a225
    v_mfma_f32_16x16x32_bf16 v[172:175], a[8:11], a[44:47], v[172:175]
    v_accvgpr_read_b32 v4, a226
    v_accvgpr_read_b32 v5, a227
    v_mfma_f32_16x16x32_bf16 v[188:191], a[12:15], a[44:47], v[188:191]
    s_waitcnt lgkmcnt(1)
    v_accvgpr_read_b32 v6, a240
    v_mfma_f32_16x16x32_bf16 v[192:195], a[0:3], a[32:35], v[192:195]
    s_add_u32 m0, s45, 20480
    ds_read_b64_tr_b16 a[8:9], v16 offset:4096
    ds_read_b64_tr_b16 a[10:11], v16 offset:6144
    v_mfma_f32_16x16x32_bf16 v[208:211], a[4:7], a[32:35], v[208:211]
    buffer_load_dwordx4 v26, s[32:35], s53 offen offset:0 lds
    v_accvgpr_read_b32 v7, a241
    v_mfma_f32_16x16x32_bf16 v[196:199], a[0:3], a[36:39], v[196:199]
    ds_read_b64_tr_b16 a[12:13], v17 offset:4096
    ds_read_b64_tr_b16 a[14:15], v17 offset:6144
    v_mfma_f32_16x16x32_bf16 v[212:215], a[4:7], a[36:39], v[212:215]
    v_accvgpr_read_b32 v8, a242
    v_accvgpr_read_b32 v9, a243
    v_mfma_f32_16x16x32_bf16 v[200:203], a[0:3], a[40:43], v[200:203]
    ds_read_b128 a[56:59], v1 offset:10240
    v_permlane16_swap_b32 v72, v74
    v_mfma_f32_16x16x32_bf16 v[216:219], a[4:7], a[40:43], v[216:219]
    buffer_load_dwordx4 v27, s[32:35], s53 offen offset:1024 lds
    v_permlane16_swap_b32 v73, v75
    v_mfma_f32_16x16x32_bf16 v[204:207], a[0:3], a[44:47], v[204:207]
    v_cvt_pk_bf16_f32 v76, v2, v3
    v_cvt_pk_bf16_f32 v78, v6, v7
    v_mfma_f32_16x16x32_bf16 v[220:223], a[4:7], a[44:47], v[220:223]
    s_waitcnt vmcnt(10) lgkmcnt(1)
    v_cvt_pk_bf16_f32 v77, v4, v5
    v_mfma_f32_16x16x32_bf16 v[224:227], a[8:11], a[32:35], v[224:227]
    ds_read_b64_tr_b16 a[0:1], v14 offset:8192
    ds_read_b64_tr_b16 a[2:3], v14 offset:10240
    v_mfma_f32_16x16x32_bf16 v[240:243], a[12:15], a[32:35], v[240:243]
    buffer_load_dwordx4 v28, s[32:35], s53 offen offset:2048 lds
    v_cvt_pk_bf16_f32 v79, v8, v9
    v_mfma_f32_16x16x32_bf16 v[228:231], a[8:11], a[36:39], v[228:231]
    ds_read_b64_tr_b16 a[4:5], v15 offset:8192
    ds_read_b64_tr_b16 a[6:7], v15 offset:10240
    v_mfma_f32_16x16x32_bf16 v[244:247], a[12:15], a[36:39], v[244:247]
    v_accvgpr_read_b32 v2, a132
    v_accvgpr_read_b32 v3, a133
    v_mfma_f32_16x16x32_bf16 v[232:235], a[8:11], a[40:43], v[232:235]
    ds_read_b128 a[60:63], v1 offset:11264
    v_accvgpr_read_b32 v4, a134
    v_mfma_f32_16x16x32_bf16 v[248:251], a[12:15], a[40:43], v[248:251]
    buffer_load_dwordx4 v29, s[32:35], s53 offen offset:3072 lds
    v_accvgpr_read_b32 v5, a135
    v_mfma_f32_16x16x32_bf16 v[236:239], a[8:11], a[44:47], v[236:239]
    v_accvgpr_read_b32 v6, a148
    v_accvgpr_read_b32 v7, a149
    v_mfma_f32_16x16x32_bf16 v[252:255], a[12:15], a[44:47], v[252:255]
    s_waitcnt lgkmcnt(0)
    v_accvgpr_read_b32 v8, a150
    v_accvgpr_read_b32 v9, a151
    v_mfma_f32_16x16x32_bf16 v[128:131], a[0:3], a[48:51], v[128:131]
    s_add_u32 m0, s45, 0
    ds_read_b64_tr_b16 a[8:9], v16 offset:8192
    ds_read_b64_tr_b16 a[10:11], v16 offset:10240
    v_mfma_f32_16x16x32_bf16 v[144:147], a[4:7], a[48:51], v[144:147]
    buffer_load_dwordx4 v26, s[32:35], s68 offen offset:0 lds
    v_permlane16_swap_b32 v76, v78
    v_mfma_f32_16x16x32_bf16 v[132:135], a[0:3], a[52:55], v[132:135]
    s_add_u32 s69, s69, 65536
    ds_read_b64_tr_b16 a[12:13], v17 offset:8192
    ds_read_b64_tr_b16 a[14:15], v17 offset:10240
    v_mfma_f32_16x16x32_bf16 v[148:151], a[4:7], a[52:55], v[148:151]
    s_sub_u32 s48, s69, 229376
    v_permlane16_swap_b32 v77, v79
    v_cvt_pk_bf16_f32 v80, v2, v3
    v_mfma_f32_16x16x32_bf16 v[136:139], a[0:3], a[56:59], v[136:139]
    s_min_u32 s69, s69, s48
    ds_read_b128 a[64:67], v1 offset:12288
    v_cvt_pk_bf16_f32 v82, v6, v7
    v_mfma_f32_16x16x32_bf16 v[152:155], a[4:7], a[56:59], v[152:155]
    buffer_load_dwordx4 v27, s[32:35], s68 offen offset:1024 lds
    v_cvt_pk_bf16_f32 v81, v4, v5
    v_mfma_f32_16x16x32_bf16 v[140:143], a[0:3], a[60:63], v[140:143]
    s_add_u32 s50, s68, 128
    v_cvt_pk_bf16_f32 v83, v8, v9
    v_accvgpr_read_b32 v2, a164
    v_mfma_f32_16x16x32_bf16 v[156:159], a[4:7], a[60:63], v[156:159]
    s_waitcnt vmcnt(10) lgkmcnt(1)
    v_accvgpr_read_b32 v3, a165
    v_mfma_f32_16x16x32_bf16 v[160:163], a[8:11], a[48:51], v[160:163]
    ds_read_b64_tr_b16 a[0:1], v14 offset:12288
    ds_read_b64_tr_b16 a[2:3], v14 offset:14336
    v_mfma_f32_16x16x32_bf16 v[176:179], a[12:15], a[48:51], v[176:179]
    buffer_load_dwordx4 v28, s[32:35], s68 offen offset:2048 lds
    v_accvgpr_read_b32 v4, a166
    v_mfma_f32_16x16x32_bf16 v[164:167], a[8:11], a[52:55], v[164:167]
    ds_read_b64_tr_b16 a[4:5], v15 offset:12288
    ds_read_b64_tr_b16 a[6:7], v15 offset:14336
    v_mfma_f32_16x16x32_bf16 v[180:183], a[12:15], a[52:55], v[180:183]
    v_accvgpr_read_b32 v5, a167
    v_accvgpr_read_b32 v6, a180
    v_mfma_f32_16x16x32_bf16 v[168:171], a[8:11], a[56:59], v[168:171]
    ds_read_b128 a[68:71], v1 offset:13312
    v_accvgpr_read_b32 v7, a181
    v_mfma_f32_16x16x32_bf16 v[184:187], a[12:15], a[56:59], v[184:187]
    buffer_load_dwordx4 v29, s[32:35], s68 offen offset:3072 lds
    v_accvgpr_read_b32 v8, a182
    v_mfma_f32_16x16x32_bf16 v[172:175], a[8:11], a[60:63], v[172:175]
    v_accvgpr_read_b32 v9, a183
    v_permlane16_swap_b32 v80, v82
    v_mfma_f32_16x16x32_bf16 v[188:191], a[12:15], a[60:63], v[188:191]
    s_waitcnt lgkmcnt(1)
    v_permlane16_swap_b32 v81, v83
    v_mfma_f32_16x16x32_bf16 v[192:195], a[0:3], a[48:51], v[192:195]
    s_add_u32 m0, s45, 4096
    ds_read_b64_tr_b16 a[8:9], v16 offset:12288
    ds_read_b64_tr_b16 a[10:11], v16 offset:14336
    v_mfma_f32_16x16x32_bf16 v[208:211], a[4:7], a[48:51], v[208:211]
    buffer_load_dwordx4 v26, s[32:35], s50 offen offset:0 lds
    v_cvt_pk_bf16_f32 v84, v2, v3
    v_mfma_f32_16x16x32_bf16 v[196:199], a[0:3], a[52:55], v[196:199]
    ds_read_b64_tr_b16 a[12:13], v17 offset:12288
    ds_read_b64_tr_b16 a[14:15], v17 offset:14336
    v_mfma_f32_16x16x32_bf16 v[212:215], a[4:7], a[52:55], v[212:215]
    v_cvt_pk_bf16_f32 v86, v6, v7
    v_cvt_pk_bf16_f32 v85, v4, v5
    v_mfma_f32_16x16x32_bf16 v[200:203], a[0:3], a[56:59], v[200:203]
    ds_read_b128 a[72:75], v1 offset:14336
    v_cvt_pk_bf16_f32 v87, v8, v9
    v_mfma_f32_16x16x32_bf16 v[216:219], a[4:7], a[56:59], v[216:219]
    buffer_load_dwordx4 v27, s[32:35], s50 offen offset:1024 lds
    v_accvgpr_read_b32 v2, a196
    v_mfma_f32_16x16x32_bf16 v[204:207], a[0:3], a[60:63], v[204:207]
    v_accvgpr_read_b32 v3, a197
    v_accvgpr_read_b32 v4, a198
    v_mfma_f32_16x16x32_bf16 v[220:223], a[4:7], a[60:63], v[220:223]
    s_waitcnt vmcnt(10) lgkmcnt(1)
    v_accvgpr_read_b32 v5, a199
    v_mfma_f32_16x16x32_bf16 v[224:227], a[8:11], a[48:51], v[224:227]
    ds_read_b64_tr_b16 a[0:1], v14 offset:16384
    ds_read_b64_tr_b16 a[2:3], v14 offset:18432
    v_mfma_f32_16x16x32_bf16 v[240:243], a[12:15], a[48:51], v[240:243]
    buffer_load_dwordx4 v28, s[32:35], s50 offen offset:2048 lds
    v_accvgpr_read_b32 v6, a212
    v_mfma_f32_16x16x32_bf16 v[228:231], a[8:11], a[52:55], v[228:231]
    ds_read_b64_tr_b16 a[4:5], v15 offset:16384
    ds_read_b64_tr_b16 a[6:7], v15 offset:18432
    v_mfma_f32_16x16x32_bf16 v[244:247], a[12:15], a[52:55], v[244:247]
    v_accvgpr_read_b32 v7, a213
    v_accvgpr_read_b32 v8, a214
    v_mfma_f32_16x16x32_bf16 v[232:235], a[8:11], a[56:59], v[232:235]
    ds_read_b128 a[76:79], v1 offset:15360
    v_accvgpr_read_b32 v9, a215
    v_mfma_f32_16x16x32_bf16 v[248:251], a[12:15], a[56:59], v[248:251]
    buffer_load_dwordx4 v29, s[32:35], s50 offen offset:3072 lds
    v_permlane16_swap_b32 v84, v86
    v_mfma_f32_16x16x32_bf16 v[236:239], a[8:11], a[60:63], v[236:239]
    v_permlane16_swap_b32 v85, v87
    v_cvt_pk_bf16_f32 v88, v2, v3
    v_mfma_f32_16x16x32_bf16 v[252:255], a[12:15], a[60:63], v[252:255]
    s_waitcnt lgkmcnt(0)
    v_cvt_pk_bf16_f32 v90, v6, v7
    v_mfma_f32_16x16x32_bf16 v[128:131], a[0:3], a[64:67], v[128:131]
    s_add_u32 m0, s45, 8192
    ds_read_b64_tr_b16 a[8:9], v16 offset:16384
    ds_read_b64_tr_b16 a[10:11], v16 offset:18432
    v_mfma_f32_16x16x32_bf16 v[144:147], a[4:7], a[64:67], v[144:147]
    buffer_load_dwordx4 v26, s[32:35], s69 offen offset:0 lds
    v_cvt_pk_bf16_f32 v89, v4, v5
    v_mfma_f32_16x16x32_bf16 v[132:135], a[0:3], a[68:71], v[132:135]
    s_add_u32 s68, s68, 65536
    ds_read_b64_tr_b16 a[12:13], v17 offset:16384
    ds_read_b64_tr_b16 a[14:15], v17 offset:18432
    v_mfma_f32_16x16x32_bf16 v[148:151], a[4:7], a[68:71], v[148:151]
    s_sub_u32 s48, s68, 229376
    v_cvt_pk_bf16_f32 v91, v8, v9
    v_accvgpr_read_b32 v2, a228
    v_mfma_f32_16x16x32_bf16 v[136:139], a[0:3], a[72:75], v[136:139]
    s_min_u32 s68, s68, s48
    ds_read_b128 a[16:19], v1 offset:16384
    v_accvgpr_read_b32 v3, a229
    v_mfma_f32_16x16x32_bf16 v[152:155], a[4:7], a[72:75], v[152:155]
    buffer_load_dwordx4 v27, s[32:35], s69 offen offset:1024 lds
    v_accvgpr_read_b32 v4, a230
    v_mfma_f32_16x16x32_bf16 v[140:143], a[0:3], a[76:79], v[140:143]
    s_add_u32 s53, s69, 128
    v_accvgpr_read_b32 v5, a231
    v_accvgpr_read_b32 v6, a244
    v_mfma_f32_16x16x32_bf16 v[156:159], a[4:7], a[76:79], v[156:159]
    s_waitcnt vmcnt(10) lgkmcnt(1)
    v_accvgpr_read_b32 v7, a245
    v_mfma_f32_16x16x32_bf16 v[160:163], a[8:11], a[64:67], v[160:163]
    ds_read_b64_tr_b16 a[0:1], v14 offset:20480
    ds_read_b64_tr_b16 a[2:3], v14 offset:22528
    v_mfma_f32_16x16x32_bf16 v[176:179], a[12:15], a[64:67], v[176:179]
    buffer_load_dwordx4 v28, s[32:35], s69 offen offset:2048 lds
    v_accvgpr_read_b32 v8, a246
    v_mfma_f32_16x16x32_bf16 v[164:167], a[8:11], a[68:71], v[164:167]
    ds_read_b64_tr_b16 a[4:5], v15 offset:20480
    ds_read_b64_tr_b16 a[6:7], v15 offset:22528
    v_mfma_f32_16x16x32_bf16 v[180:183], a[12:15], a[68:71], v[180:183]
    v_accvgpr_read_b32 v9, a247
    v_permlane16_swap_b32 v88, v90
    v_mfma_f32_16x16x32_bf16 v[168:171], a[8:11], a[72:75], v[168:171]
    ds_read_b128 a[20:23], v1 offset:17408
    v_permlane16_swap_b32 v89, v91
    v_mfma_f32_16x16x32_bf16 v[184:187], a[12:15], a[72:75], v[184:187]
    buffer_load_dwordx4 v29, s[32:35], s69 offen offset:3072 lds
    v_cvt_pk_bf16_f32 v92, v2, v3
    v_mfma_f32_16x16x32_bf16 v[172:175], a[8:11], a[76:79], v[172:175]
    v_cvt_pk_bf16_f32 v94, v6, v7
    v_cvt_pk_bf16_f32 v93, v4, v5
    v_mfma_f32_16x16x32_bf16 v[188:191], a[12:15], a[76:79], v[188:191]
    s_waitcnt lgkmcnt(1)
    v_cvt_pk_bf16_f32 v95, v8, v9
    v_mfma_f32_16x16x32_bf16 v[192:195], a[0:3], a[64:67], v[192:195]
    s_add_u32 m0, s45, 12288
    ds_read_b64_tr_b16 a[8:9], v16 offset:20480
    ds_read_b64_tr_b16 a[10:11], v16 offset:22528
    v_mfma_f32_16x16x32_bf16 v[208:211], a[4:7], a[64:67], v[208:211]
    buffer_load_dwordx4 v26, s[32:35], s53 offen offset:0 lds
    v_accvgpr_read_b32 v2, a136
    v_mfma_f32_16x16x32_bf16 v[196:199], a[0:3], a[68:71], v[196:199]
    ds_read_b64_tr_b16 a[12:13], v17 offset:20480
    ds_read_b64_tr_b16 a[14:15], v17 offset:22528
    v_mfma_f32_16x16x32_bf16 v[212:215], a[4:7], a[68:71], v[212:215]
    v_accvgpr_read_b32 v3, a137
    v_accvgpr_read_b32 v4, a138
    v_mfma_f32_16x16x32_bf16 v[200:203], a[0:3], a[72:75], v[200:203]
    ds_read_b128 a[24:27], v1 offset:18432
    v_accvgpr_read_b32 v5, a139
    v_mfma_f32_16x16x32_bf16 v[216:219], a[4:7], a[72:75], v[216:219]
    buffer_load_dwordx4 v27, s[32:35], s53 offen offset:1024 lds
    v_accvgpr_read_b32 v6, a152
    v_mfma_f32_16x16x32_bf16 v[204:207], a[0:3], a[76:79], v[204:207]
    v_accvgpr_read_b32 v7, a153
    v_accvgpr_read_b32 v8, a154
    v_mfma_f32_16x16x32_bf16 v[220:223], a[4:7], a[76:79], v[220:223]
    s_waitcnt vmcnt(10) lgkmcnt(1)
    v_accvgpr_read_b32 v9, a155
    v_permlane16_swap_b32 v92, v94
    v_mfma_f32_16x16x32_bf16 v[224:227], a[8:11], a[64:67], v[224:227]
    ds_read_b64_tr_b16 a[0:1], v14 offset:0
    ds_read_b64_tr_b16 a[2:3], v14 offset:2048
    v_mfma_f32_16x16x32_bf16 v[240:243], a[12:15], a[64:67], v[240:243]
    buffer_load_dwordx4 v28, s[32:35], s53 offen offset:2048 lds
    v_permlane16_swap_b32 v93, v95
    v_mfma_f32_16x16x32_bf16 v[228:231], a[8:11], a[68:71], v[228:231]
    ds_read_b64_tr_b16 a[4:5], v15 offset:0
    ds_read_b64_tr_b16 a[6:7], v15 offset:2048
    v_mfma_f32_16x16x32_bf16 v[244:247], a[12:15], a[68:71], v[244:247]
    v_cvt_pk_bf16_f32 v96, v2, v3
    v_cvt_pk_bf16_f32 v98, v6, v7
    v_mfma_f32_16x16x32_bf16 v[232:235], a[8:11], a[72:75], v[232:235]
    ds_read_b128 a[28:31], v1 offset:19456
    v_cvt_pk_bf16_f32 v97, v4, v5
    v_mfma_f32_16x16x32_bf16 v[248:251], a[12:15], a[72:75], v[248:251]
    buffer_load_dwordx4 v29, s[32:35], s53 offen offset:3072 lds
    v_cvt_pk_bf16_f32 v99, v8, v9
    v_mfma_f32_16x16x32_bf16 v[236:239], a[8:11], a[76:79], v[236:239]
    v_accvgpr_read_b32 v2, a168
    v_accvgpr_read_b32 v3, a169
    v_mfma_f32_16x16x32_bf16 v[252:255], a[12:15], a[76:79], v[252:255]
    s_waitcnt lgkmcnt(0)
    v_accvgpr_read_b32 v4, a170
    v_mfma_f32_16x16x32_bf16 v[128:131], a[0:3], a[16:19], v[128:131]
    s_add_u32 m0, s45, 16384
    ds_read_b64_tr_b16 a[8:9], v16 offset:0
    ds_read_b64_tr_b16 a[10:11], v16 offset:2048
    v_mfma_f32_16x16x32_bf16 v[144:147], a[4:7], a[16:19], v[144:147]
    buffer_load_dwordx4 v26, s[32:35], s68 offen offset:0 lds
    v_accvgpr_read_b32 v5, a171
    v_mfma_f32_16x16x32_bf16 v[132:135], a[0:3], a[20:23], v[132:135]
    s_add_u32 s50, s68, 128
    ds_read_b64_tr_b16 a[12:13], v17 offset:0
    ds_read_b64_tr_b16 a[14:15], v17 offset:2048
    v_mfma_f32_16x16x32_bf16 v[148:151], a[4:7], a[20:23], v[148:151]
    v_accvgpr_read_b32 v6, a184
    v_accvgpr_read_b32 v7, a185
    v_mfma_f32_16x16x32_bf16 v[136:139], a[0:3], a[24:27], v[136:139]
    ds_read_b128 a[32:35], v1 offset:20480
    v_accvgpr_read_b32 v8, a186
    v_mfma_f32_16x16x32_bf16 v[152:155], a[4:7], a[24:27], v[152:155]
    buffer_load_dwordx4 v27, s[32:35], s68 offen offset:1024 lds
    v_accvgpr_read_b32 v9, a187
    v_mfma_f32_16x16x32_bf16 v[140:143], a[0:3], a[28:31], v[140:143]
    v_permlane16_swap_b32 v96, v98
    v_permlane16_swap_b32 v97, v99
    v_mfma_f32_16x16x32_bf16 v[156:159], a[4:7], a[28:31], v[156:159]
    s_waitcnt vmcnt(10) lgkmcnt(1)
    v_cvt_pk_bf16_f32 v100, v2, v3
    v_mfma_f32_16x16x32_bf16 v[160:163], a[8:11], a[16:19], v[160:163]
    ds_read_b64_tr_b16 a[0:1], v14 offset:4096
    ds_read_b64_tr_b16 a[2:3], v14 offset:6144
    v_mfma_f32_16x16x32_bf16 v[176:179], a[12:15], a[16:19], v[176:179]
    buffer_load_dwordx4 v28, s[32:35], s68 offen offset:2048 lds
    v_cvt_pk_bf16_f32 v102, v6, v7
    v_mfma_f32_16x16x32_bf16 v[164:167], a[8:11], a[20:23], v[164:167]
    ds_read_b64_tr_b16 a[4:5], v15 offset:4096
    ds_read_b64_tr_b16 a[6:7], v15 offset:6144
    v_mfma_f32_16x16x32_bf16 v[180:183], a[12:15], a[20:23], v[180:183]
    v_cvt_pk_bf16_f32 v101, v4, v5
    v_cvt_pk_bf16_f32 v103, v8, v9
    v_mfma_f32_16x16x32_bf16 v[168:171], a[8:11], a[24:27], v[168:171]
    ds_read_b128 a[36:39], v1 offset:21504
    v_accvgpr_read_b32 v2, a200
    v_mfma_f32_16x16x32_bf16 v[184:187], a[12:15], a[24:27], v[184:187]
    buffer_load_dwordx4 v29, s[32:35], s68 offen offset:3072 lds
    v_accvgpr_read_b32 v3, a201
    v_mfma_f32_16x16x32_bf16 v[172:175], a[8:11], a[28:31], v[172:175]
    v_accvgpr_read_b32 v4, a202
    v_accvgpr_read_b32 v5, a203
    v_mfma_f32_16x16x32_bf16 v[188:191], a[12:15], a[28:31], v[188:191]
    s_waitcnt lgkmcnt(1)
    v_accvgpr_read_b32 v6, a216
    v_mfma_f32_16x16x32_bf16 v[192:195], a[0:3], a[16:19], v[192:195]
    s_add_u32 m0, s45, 20480
    ds_read_b64_tr_b16 a[8:9], v16 offset:4096
    ds_read_b64_tr_b16 a[10:11], v16 offset:6144
    v_mfma_f32_16x16x32_bf16 v[208:211], a[4:7], a[16:19], v[208:211]
    buffer_load_dwordx4 v26, s[32:35], s50 offen offset:0 lds
    v_accvgpr_read_b32 v7, a217
    v_mfma_f32_16x16x32_bf16 v[196:199], a[0:3], a[20:23], v[196:199]
    ds_read_b64_tr_b16 a[12:13], v17 offset:4096
    ds_read_b64_tr_b16 a[14:15], v17 offset:6144
    v_mfma_f32_16x16x32_bf16 v[212:215], a[4:7], a[20:23], v[212:215]
    v_accvgpr_read_b32 v8, a218
    v_accvgpr_read_b32 v9, a219
    v_mfma_f32_16x16x32_bf16 v[200:203], a[0:3], a[24:27], v[200:203]
    ds_read_b128 a[40:43], v1 offset:22528
    v_permlane16_swap_b32 v100, v102
    v_mfma_f32_16x16x32_bf16 v[216:219], a[4:7], a[24:27], v[216:219]
    buffer_load_dwordx4 v27, s[32:35], s50 offen offset:1024 lds
    v_permlane16_swap_b32 v101, v103
    v_mfma_f32_16x16x32_bf16 v[204:207], a[0:3], a[28:31], v[204:207]
    v_cvt_pk_bf16_f32 v104, v2, v3
    v_cvt_pk_bf16_f32 v106, v6, v7
    v_mfma_f32_16x16x32_bf16 v[220:223], a[4:7], a[28:31], v[220:223]
    s_waitcnt vmcnt(10) lgkmcnt(1)
    v_cvt_pk_bf16_f32 v105, v4, v5
    v_mfma_f32_16x16x32_bf16 v[224:227], a[8:11], a[16:19], v[224:227]
    ds_read_b64_tr_b16 a[0:1], v14 offset:8192
    ds_read_b64_tr_b16 a[2:3], v14 offset:10240
    v_mfma_f32_16x16x32_bf16 v[240:243], a[12:15], a[16:19], v[240:243]
    buffer_load_dwordx4 v28, s[32:35], s50 offen offset:2048 lds
    v_cvt_pk_bf16_f32 v107, v8, v9
    v_mfma_f32_16x16x32_bf16 v[228:231], a[8:11], a[20:23], v[228:231]
    ds_read_b64_tr_b16 a[4:5], v15 offset:8192
    ds_read_b64_tr_b16 a[6:7], v15 offset:10240
    v_mfma_f32_16x16x32_bf16 v[244:247], a[12:15], a[20:23], v[244:247]
    v_accvgpr_read_b32 v2, a232
    v_accvgpr_read_b32 v3, a233
    v_mfma_f32_16x16x32_bf16 v[232:235], a[8:11], a[24:27], v[232:235]
    ds_read_b128 a[44:47], v1 offset:23552
    v_accvgpr_read_b32 v4, a234
    v_mfma_f32_16x16x32_bf16 v[248:251], a[12:15], a[24:27], v[248:251]
    buffer_load_dwordx4 v29, s[32:35], s50 offen offset:3072 lds
    v_accvgpr_read_b32 v5, a235
    v_mfma_f32_16x16x32_bf16 v[236:239], a[8:11], a[28:31], v[236:239]
    v_accvgpr_read_b32 v6, a248
    v_accvgpr_read_b32 v7, a249
    v_mfma_f32_16x16x32_bf16 v[252:255], a[12:15], a[28:31], v[252:255]
    s_waitcnt lgkmcnt(0)
    v_accvgpr_read_b32 v8, a250
    v_mfma_f32_16x16x32_bf16 v[128:131], a[0:3], a[32:35], v[128:131]
    s_mov_b32 m0, s95
    ds_read_b64_tr_b16 a[8:9], v16 offset:8192
    ds_read_b64_tr_b16 a[10:11], v16 offset:10240
    v_mfma_f32_16x16x32_bf16 v[144:147], a[4:7], a[32:35], v[144:147]
    buffer_load_dwordx4 v30, s[88:91], s94 offen offset:0 lds
    v_accvgpr_read_b32 v9, a251
    v_mfma_f32_16x16x32_bf16 v[132:135], a[0:3], a[36:39], v[132:135]
    ds_read_b64_tr_b16 a[12:13], v17 offset:8192
    ds_read_b64_tr_b16 a[14:15], v17 offset:10240
    v_mfma_f32_16x16x32_bf16 v[148:151], a[4:7], a[36:39], v[148:151]
    v_permlane16_swap_b32 v104, v106
    v_permlane16_swap_b32 v105, v107
    v_mfma_f32_16x16x32_bf16 v[136:139], a[0:3], a[40:43], v[136:139]
    ds_read_b128 a[48:51], v1 offset:24576
    v_cvt_pk_bf16_f32 v108, v2, v3
    v_mfma_f32_16x16x32_bf16 v[152:155], a[4:7], a[40:43], v[152:155]
    buffer_load_dwordx4 v31, s[88:91], s94 offen offset:1024 lds
    v_cvt_pk_bf16_f32 v110, v6, v7
    v_mfma_f32_16x16x32_bf16 v[140:143], a[0:3], a[44:47], v[140:143]
    v_cvt_pk_bf16_f32 v109, v4, v5
    v_cvt_pk_bf16_f32 v111, v8, v9
    v_mfma_f32_16x16x32_bf16 v[156:159], a[4:7], a[44:47], v[156:159]
    s_waitcnt vmcnt(10) lgkmcnt(1)
    v_accvgpr_read_b32 v2, a140
    v_mfma_f32_16x16x32_bf16 v[160:163], a[8:11], a[32:35], v[160:163]
    ds_read_b64_tr_b16 a[0:1], v14 offset:12288
    ds_read_b64_tr_b16 a[2:3], v14 offset:14336
    v_mfma_f32_16x16x32_bf16 v[176:179], a[12:15], a[32:35], v[176:179]
    buffer_load_dwordx4 v32, s[88:91], s94 offen offset:2048 lds
    v_accvgpr_read_b32 v3, a141
    v_mfma_f32_16x16x32_bf16 v[164:167], a[8:11], a[36:39], v[164:167]
    ds_read_b64_tr_b16 a[4:5], v15 offset:12288
    ds_read_b64_tr_b16 a[6:7], v15 offset:14336
    v_mfma_f32_16x16x32_bf16 v[180:183], a[12:15], a[36:39], v[180:183]
    v_accvgpr_read_b32 v4, a142
    v_accvgpr_read_b32 v5, a143
    v_mfma_f32_16x16x32_bf16 v[168:171], a[8:11], a[40:43], v[168:171]
    ds_read_b128 a[52:55], v1 offset:25600
    v_accvgpr_read_b32 v6, a156
    v_mfma_f32_16x16x32_bf16 v[184:187], a[12:15], a[40:43], v[184:187]
    buffer_load_dwordx4 v33, s[88:91], s94 offen offset:3072 lds
    v_accvgpr_read_b32 v7, a157
    v_mfma_f32_16x16x32_bf16 v[172:175], a[8:11], a[44:47], v[172:175]
    v_accvgpr_read_b32 v8, a158
    v_accvgpr_read_b32 v9, a159
    v_mfma_f32_16x16x32_bf16 v[188:191], a[12:15], a[44:47], v[188:191]
    s_waitcnt lgkmcnt(1)
    v_permlane16_swap_b32 v108, v110
    v_permlane16_swap_b32 v109, v111
    v_mfma_f32_16x16x32_bf16 v[192:195], a[0:3], a[32:35], v[192:195]
    s_sub_u32 m0, s56, 24576
    ds_read_b64_tr_b16 a[8:9], v16 offset:12288
    ds_read_b64_tr_b16 a[10:11], v16 offset:14336
    v_mfma_f32_16x16x32_bf16 v[208:211], a[4:7], a[32:35], v[208:211]
    buffer_load_dwordx4 v46, s[8:11], s54 offen offset:0 lds
    v_cvt_pk_bf16_f32 v112, v2, v3
    v_mfma_f32_16x16x32_bf16 v[196:199], a[0:3], a[36:39], v[196:199]
    ds_read_b64_tr_b16 a[12:13], v17 offset:12288
    ds_read_b64_tr_b16 a[14:15], v17 offset:14336
    v_mfma_f32_16x16x32_bf16 v[212:215], a[4:7], a[36:39], v[212:215]
    v_cvt_pk_bf16_f32 v114, v6, v7
    v_cvt_pk_bf16_f32 v113, v4, v5
    v_mfma_f32_16x16x32_bf16 v[200:203], a[0:3], a[40:43], v[200:203]
    ds_read_b128 a[56:59], v1 offset:26624
    v_cvt_pk_bf16_f32 v115, v8, v9
    v_mfma_f32_16x16x32_bf16 v[216:219], a[4:7], a[40:43], v[216:219]
    buffer_load_dwordx4 v47, s[8:11], s54 offen offset:1024 lds
    v_accvgpr_read_b32 v2, a172
    v_mfma_f32_16x16x32_bf16 v[204:207], a[0:3], a[44:47], v[204:207]
    v_accvgpr_read_b32 v3, a173
    v_accvgpr_read_b32 v4, a174
    v_mfma_f32_16x16x32_bf16 v[220:223], a[4:7], a[44:47], v[220:223]
    s_waitcnt vmcnt(10) lgkmcnt(1)
    v_accvgpr_read_b32 v5, a175
    v_mfma_f32_16x16x32_bf16 v[224:227], a[8:11], a[32:35], v[224:227]
    ds_read_b64_tr_b16 a[0:1], v14 offset:16384
    ds_read_b64_tr_b16 a[2:3], v14 offset:18432
    v_mfma_f32_16x16x32_bf16 v[240:243], a[12:15], a[32:35], v[240:243]
    buffer_load_dwordx4 v48, s[8:11], s54 offen offset:2048 lds
    v_accvgpr_read_b32 v6, a188
    v_mfma_f32_16x16x32_bf16 v[228:231], a[8:11], a[36:39], v[228:231]
    ds_read_b64_tr_b16 a[4:5], v15 offset:16384
    ds_read_b64_tr_b16 a[6:7], v15 offset:18432
    v_mfma_f32_16x16x32_bf16 v[244:247], a[12:15], a[36:39], v[244:247]
    v_accvgpr_read_b32 v7, a189
    v_accvgpr_read_b32 v8, a190
    v_mfma_f32_16x16x32_bf16 v[232:235], a[8:11], a[40:43], v[232:235]
    ds_read_b128 a[60:63], v1 offset:27648
    v_accvgpr_read_b32 v9, a191
    v_mfma_f32_16x16x32_bf16 v[248:251], a[12:15], a[40:43], v[248:251]
    buffer_load_dwordx4 v49, s[8:11], s54 offen offset:3072 lds
    v_permlane16_swap_b32 v112, v114
    v_mfma_f32_16x16x32_bf16 v[236:239], a[8:11], a[44:47], v[236:239]
    s_add_u32 s54, s54, 16384
    v_permlane16_swap_b32 v113, v115
    v_cvt_pk_bf16_f32 v116, v2, v3
    v_mfma_f32_16x16x32_bf16 v[252:255], a[12:15], a[44:47], v[252:255]
    s_waitcnt lgkmcnt(0)
    v_cvt_pk_bf16_f32 v118, v6, v7
    v_mfma_f32_16x16x32_bf16 v[128:131], a[0:3], a[48:51], v[128:131]
    s_and_b32 s54, s54, 524287
    ds_read_b64_tr_b16 a[8:9], v16 offset:16384
    ds_read_b64_tr_b16 a[10:11], v16 offset:18432
    v_mfma_f32_16x16x32_bf16 v[144:147], a[4:7], a[48:51], v[144:147]
    v_cvt_pk_bf16_f32 v117, v4, v5
    v_cvt_pk_bf16_f32 v119, v8, v9
    v_mfma_f32_16x16x32_bf16 v[132:135], a[0:3], a[52:55], v[132:135]
    ds_read_b64_tr_b16 a[12:13], v17 offset:16384
    ds_read_b64_tr_b16 a[14:15], v17 offset:18432
    v_mfma_f32_16x16x32_bf16 v[148:151], a[4:7], a[52:55], v[148:151]
    v_accvgpr_read_b32 v2, a204
    v_accvgpr_read_b32 v3, a205
    v_mfma_f32_16x16x32_bf16 v[136:139], a[0:3], a[56:59], v[136:139]
    v_accvgpr_read_b32 v4, a206
    v_accvgpr_read_b32 v5, a207
    v_mfma_f32_16x16x32_bf16 v[152:155], a[4:7], a[56:59], v[152:155]
    v_accvgpr_read_b32 v6, a220
    v_accvgpr_read_b32 v7, a221
    v_mfma_f32_16x16x32_bf16 v[140:143], a[0:3], a[60:63], v[140:143]
    v_mfma_f32_16x16x32_bf16 v[156:159], a[4:7], a[60:63], v[156:159]
    s_waitcnt vmcnt(8) lgkmcnt(0)
    v_mfma_f32_16x16x32_bf16 v[160:163], a[8:11], a[48:51], v[160:163]
    ds_read_b64_tr_b16 a[0:1], v14 offset:20480
    ds_read_b64_tr_b16 a[2:3], v14 offset:22528
    v_mfma_f32_16x16x32_bf16 v[176:179], a[12:15], a[48:51], v[176:179]
    v_accvgpr_read_b32 v8, a222
    v_accvgpr_read_b32 v9, a223
    v_mfma_f32_16x16x32_bf16 v[164:167], a[8:11], a[52:55], v[164:167]
    ds_read_b64_tr_b16 a[4:5], v15 offset:20480
    ds_read_b64_tr_b16 a[6:7], v15 offset:22528
    v_mfma_f32_16x16x32_bf16 v[180:183], a[12:15], a[52:55], v[180:183]
    v_permlane16_swap_b32 v116, v118
    v_permlane16_swap_b32 v117, v119
    v_mfma_f32_16x16x32_bf16 v[168:171], a[8:11], a[56:59], v[168:171]
    v_cvt_pk_bf16_f32 v120, v2, v3
    v_cvt_pk_bf16_f32 v122, v6, v7
    v_mfma_f32_16x16x32_bf16 v[184:187], a[12:15], a[56:59], v[184:187]
    v_cvt_pk_bf16_f32 v121, v4, v5
    v_cvt_pk_bf16_f32 v123, v8, v9
    v_mfma_f32_16x16x32_bf16 v[172:175], a[8:11], a[60:63], v[172:175]
    v_mfma_f32_16x16x32_bf16 v[188:191], a[12:15], a[60:63], v[188:191]
    s_waitcnt lgkmcnt(0)
    v_mfma_f32_16x16x32_bf16 v[192:195], a[0:3], a[48:51], v[192:195]
    ds_read_b64_tr_b16 a[8:9], v16 offset:20480
    ds_read_b64_tr_b16 a[10:11], v16 offset:22528
    v_mfma_f32_16x16x32_bf16 v[208:211], a[4:7], a[48:51], v[208:211]
    v_accvgpr_read_b32 v2, a236
    v_accvgpr_read_b32 v3, a237
    v_mfma_f32_16x16x32_bf16 v[196:199], a[0:3], a[52:55], v[196:199]
    ds_read_b64_tr_b16 a[12:13], v17 offset:20480
    ds_read_b64_tr_b16 a[14:15], v17 offset:22528
    v_mfma_f32_16x16x32_bf16 v[212:215], a[4:7], a[52:55], v[212:215]
    v_accvgpr_read_b32 v4, a238
    v_accvgpr_read_b32 v5, a239
    v_mfma_f32_16x16x32_bf16 v[200:203], a[0:3], a[56:59], v[200:203]
    v_accvgpr_read_b32 v6, a252
    v_accvgpr_read_b32 v7, a253
    v_mfma_f32_16x16x32_bf16 v[216:219], a[4:7], a[56:59], v[216:219]
    v_accvgpr_read_b32 v8, a254
    v_accvgpr_read_b32 v9, a255
    v_mfma_f32_16x16x32_bf16 v[204:207], a[0:3], a[60:63], v[204:207]
    v_mfma_f32_16x16x32_bf16 v[220:223], a[4:7], a[60:63], v[220:223]
    s_waitcnt lgkmcnt(0)
    v_mfma_f32_16x16x32_bf16 v[224:227], a[8:11], a[48:51], v[224:227]
    v_mfma_f32_16x16x32_bf16 v[240:243], a[12:15], a[48:51], v[240:243]
    v_permlane16_swap_b32 v120, v122
    v_permlane16_swap_b32 v121, v123
    v_mfma_f32_16x16x32_bf16 v[228:231], a[8:11], a[52:55], v[228:231]
    v_mfma_f32_16x16x32_bf16 v[244:247], a[12:15], a[52:55], v[244:247]
    v_cvt_pk_bf16_f32 v124, v2, v3
    v_cvt_pk_bf16_f32 v126, v6, v7
    v_mfma_f32_16x16x32_bf16 v[232:235], a[8:11], a[56:59], v[232:235]
    v_cvt_pk_bf16_f32 v125, v4, v5
    v_cvt_pk_bf16_f32 v127, v8, v9
    v_mfma_f32_16x16x32_bf16 v[248:251], a[12:15], a[56:59], v[248:251]
    v_permlane16_swap_b32 v124, v126
    v_permlane16_swap_b32 v125, v127
    v_mfma_f32_16x16x32_bf16 v[236:239], a[8:11], a[60:63], v[236:239]
    v_mfma_f32_16x16x32_bf16 v[252:255], a[12:15], a[60:63], v[252:255]
    s_waitcnt vmcnt(0)
    s_barrier
    ds_read_b128 a[0:3], v34 offset:0
    ds_read_b128 a[4:7], v35 offset:0
    ds_read_b128 a[8:11], v36 offset:0
    ds_read_b128 a[12:15], v37 offset:0
    ds_read_b128 a[80:83], v34 offset:4096
    ds_read_b128 a[84:87], v35 offset:4096
    ds_read_b128 a[88:91], v36 offset:4096
    ds_read_b128 a[92:95], v37 offset:4096
    s_mul_i32 s51, s42, 2048
    v_add_u32 v18, s51, v1
    v_cvt_pk_bf16_f32 v128, v128, v129
    v_cvt_pk_bf16_f32 v129, v130, v131
    v_cvt_pk_bf16_f32 v130, v144, v145
    v_cvt_pk_bf16_f32 v131, v146, v147
    ds_write_b128 v18, v[128:131] offset:0
    v_cvt_pk_bf16_f32 v132, v132, v133
    v_cvt_pk_bf16_f32 v133, v134, v135
    v_cvt_pk_bf16_f32 v134, v148, v149
    v_cvt_pk_bf16_f32 v135, v150, v151
    ds_write_b128 v18, v[132:135] offset:1024
    v_cvt_pk_bf16_f32 v136, v136, v137
    v_cvt_pk_bf16_f32 v137, v138, v139
    v_cvt_pk_bf16_f32 v138, v152, v153
    v_cvt_pk_bf16_f32 v139, v154, v155
    ds_write_b128 v18, v[136:139] offset:8192
    v_cvt_pk_bf16_f32 v140, v140, v141
    v_cvt_pk_bf16_f32 v141, v142, v143
    v_cvt_pk_bf16_f32 v142, v156, v157
    v_cvt_pk_bf16_f32 v143, v158, v159
    ds_write_b128 v18, v[140:143] offset:9216
    s_waitcnt lgkmcnt(11)
    v_mfma_f32_16x16x32_bf16 v[128:131], a[0:3], v[64:67], 0
    s_add_u32 m0, s56, 16384
    s_nop 0
    buffer_load_dwordx4 v46, s[8:11], s54 offen offset:0 lds
    v_mfma_f32_16x16x32_bf16 v[132:135], a[0:3], v[80:83], 0
    v_cvt_pk_bf16_f32 v160, v160, v161
    v_cvt_pk_bf16_f32 v161, v162, v163
    v_cvt_pk_bf16_f32 v162, v176, v177
    v_mfma_f32_16x16x32_bf16 v[136:139], a[0:3], v[96:99], 0
    v_cvt_pk_bf16_f32 v163, v178, v179
    ds_write_b128 v18, v[160:163] offset:16384
    v_mfma_f32_16x16x32_bf16 v[140:143], a[0:3], v[112:115], 0
    v_cvt_pk_bf16_f32 v164, v164, v165
    v_cvt_pk_bf16_f32 v165, v166, v167
    v_cvt_pk_bf16_f32 v166, v180, v181
    s_waitcnt lgkmcnt(11)
    v_mfma_f32_16x16x32_bf16 v[128:131], a[4:7], v[68:71], v[128:131]
    buffer_load_dwordx4 v47, s[8:11], s54 offen offset:1024 lds
    v_mfma_f32_16x16x32_bf16 v[132:135], a[4:7], v[84:87], v[132:135]
    v_cvt_pk_bf16_f32 v167, v182, v183
    ds_write_b128 v18, v[164:167] offset:17408
    v_mfma_f32_16x16x32_bf16 v[136:139], a[4:7], v[100:103], v[136:139]
    buffer_load_dwordx4 v48, s[8:11], s54 offen offset:2048 lds
    v_mfma_f32_16x16x32_bf16 v[140:143], a[4:7], v[116:119], v[140:143]
    v_cvt_pk_bf16_f32 v168, v168, v169
    v_cvt_pk_bf16_f32 v169, v170, v171
    v_cvt_pk_bf16_f32 v170, v184, v185
    s_waitcnt lgkmcnt(11)
    v_mfma_f32_16x16x32_bf16 v[128:131], a[8:11], v[72:75], v[128:131]
    buffer_load_dwordx4 v49, s[8:11], s54 offen offset:3072 lds
    s_add_u32 s54, s54, 16384
    s_and_b32 s54, s54, 524287
    v_mfma_f32_16x16x32_bf16 v[132:135], a[8:11], v[88:91], v[132:135]
    v_cvt_pk_bf16_f32 v171, v186, v187
    ds_write_b128 v18, v[168:171] offset:24576
    v_mfma_f32_16x16x32_bf16 v[136:139], a[8:11], v[104:107], v[136:139]
    v_cvt_pk_bf16_f32 v172, v172, v173
    v_cvt_pk_bf16_f32 v173, v174, v175
    v_cvt_pk_bf16_f32 v174, v188, v189
    v_mfma_f32_16x16x32_bf16 v[140:143], a[8:11], v[120:123], v[140:143]
    v_cvt_pk_bf16_f32 v175, v190, v191
    ds_write_b128 v18, v[172:175] offset:25600
    s_waitcnt lgkmcnt(12)
    v_mfma_f32_16x16x32_bf16 v[128:131], a[12:15], v[76:79], v[128:131]
    s_add_u32 m0, s57, 0
    s_nop 0
    buffer_load_dwordx4 v50, s[12:15], s55 offen offset:0 lds
    v_mfma_f32_16x16x32_bf16 v[132:135], a[12:15], v[92:95], v[132:135]
    v_cvt_pk_bf16_f32 v192, v192, v193
    v_cvt_pk_bf16_f32 v193, v194, v195
    v_cvt_pk_bf16_f32 v194, v208, v209
    v_mfma_f32_16x16x32_bf16 v[136:139], a[12:15], v[108:111], v[136:139]
    buffer_load_dwordx4 v51, s[12:15], s55 offen offset:1024 lds
    v_mfma_f32_16x16x32_bf16 v[140:143], a[12:15], v[124:127], v[140:143]
    v_cvt_pk_bf16_f32 v195, v210, v211
    v_accvgpr_write_b32 a16, v192
    v_accvgpr_write_b32 a17, v193
    s_waitcnt lgkmcnt(11)
    v_mfma_f32_16x16x32_bf16 v[144:147], a[80:83], v[64:67], 0
    buffer_load_dwordx4 v50, s[12:15], s55 offen offset:2048 lds
    v_mfma_f32_16x16x32_bf16 v[148:151], a[80:83], v[80:83], 0
    v_accvgpr_write_b32 a18, v194
    v_accvgpr_write_b32 a19, v195
    v_cvt_pk_bf16_f32 v196, v196, v197
    v_mfma_f32_16x16x32_bf16 v[152:155], a[80:83], v[96:99], 0
    v_cvt_pk_bf16_f32 v197, v198, v199
    v_cvt_pk_bf16_f32 v198, v212, v213
    v_cvt_pk_bf16_f32 v199, v214, v215
    v_mfma_f32_16x16x32_bf16 v[156:159], a[80:83], v[112:115], 0
    v_accvgpr_write_b32 a20, v196
    v_accvgpr_write_b32 a21, v197
    v_accvgpr_write_b32 a22, v198
    s_waitcnt lgkmcnt(10)
    v_mfma_f32_16x16x32_bf16 v[144:147], a[84:87], v[68:71], v[144:147]
    buffer_load_dwordx4 v51, s[12:15], s55 offen offset:3072 lds
    s_add_u32 s55, s55, 16384
    s_and_b32 s55, s55, 524287
    v_mfma_f32_16x16x32_bf16 v[148:151], a[84:87], v[84:87], v[148:151]
    v_accvgpr_write_b32 a23, v199
    v_cvt_pk_bf16_f32 v200, v200, v201
    v_cvt_pk_bf16_f32 v201, v202, v203
    v_mfma_f32_16x16x32_bf16 v[152:155], a[84:87], v[100:103], v[152:155]
    s_add_u32 m0, s57, 16384
    s_nop 0
    buffer_load_dwordx4 v50, s[12:15], s55 offen offset:0 lds
    v_mfma_f32_16x16x32_bf16 v[156:159], a[84:87], v[116:119], v[156:159]
    v_cvt_pk_bf16_f32 v202, v216, v217
    v_cvt_pk_bf16_f32 v203, v218, v219
    v_accvgpr_write_b32 a24, v200
    s_waitcnt lgkmcnt(9)
    v_mfma_f32_16x16x32_bf16 v[144:147], a[88:91], v[72:75], v[144:147]
    buffer_load_dwordx4 v51, s[12:15], s55 offen offset:1024 lds
    v_mfma_f32_16x16x32_bf16 v[148:151], a[88:91], v[88:91], v[148:151]
    v_accvgpr_write_b32 a25, v201
    v_accvgpr_write_b32 a26, v202
    v_accvgpr_write_b32 a27, v203
    v_mfma_f32_16x16x32_bf16 v[152:155], a[88:91], v[104:107], v[152:155]
    v_cvt_pk_bf16_f32 v204, v204, v205
    v_cvt_pk_bf16_f32 v205, v206, v207
    v_cvt_pk_bf16_f32 v206, v220, v221
    v_mfma_f32_16x16x32_bf16 v[156:159], a[88:91], v[120:123], v[156:159]
    v_cvt_pk_bf16_f32 v207, v222, v223
    v_accvgpr_write_b32 a28, v204
    v_accvgpr_write_b32 a29, v205
    s_waitcnt lgkmcnt(8)
    v_mfma_f32_16x16x32_bf16 v[144:147], a[92:95], v[76:79], v[144:147]
    buffer_load_dwordx4 v50, s[12:15], s55 offen offset:2048 lds
    v_mfma_f32_16x16x32_bf16 v[148:151], a[92:95], v[92:95], v[148:151]
    v_accvgpr_write_b32 a30, v206
    v_accvgpr_write_b32 a31, v207
    v_cvt_pk_bf16_f32 v224, v224, v225
    v_mfma_f32_16x16x32_bf16 v[152:155], a[92:95], v[108:111], v[152:155]
    buffer_load_dwordx4 v51, s[12:15], s55 offen offset:3072 lds
    s_add_u32 s55, s55, 16384
    s_and_b32 s55, s55, 524287
    v_mfma_f32_16x16x32_bf16 v[156:159], a[92:95], v[124:127], v[156:159]
    v_cvt_pk_bf16_f32 v225, v226, v227
    v_cvt_pk_bf16_f32 v226, v240, v241
    v_cvt_pk_bf16_f32 v227, v242, v243
    v_accvgpr_write_b32 a32, v224
    v_accvgpr_write_b32 a33, v225
    v_accvgpr_write_b32 a34, v226
    v_accvgpr_write_b32 a35, v227
    v_cvt_pk_bf16_f32 v228, v228, v229
    v_cvt_pk_bf16_f32 v229, v230, v231
    v_cvt_pk_bf16_f32 v230, v244, v245
    v_cvt_pk_bf16_f32 v231, v246, v247
    v_accvgpr_write_b32 a36, v228
    v_accvgpr_write_b32 a37, v229
    v_accvgpr_write_b32 a38, v230
    v_accvgpr_write_b32 a39, v231
    v_cvt_pk_bf16_f32 v232, v232, v233
    v_cvt_pk_bf16_f32 v233, v234, v235
    v_cvt_pk_bf16_f32 v234, v248, v249
    v_cvt_pk_bf16_f32 v235, v250, v251
    v_accvgpr_write_b32 a40, v232
    v_accvgpr_write_b32 a41, v233
    v_accvgpr_write_b32 a42, v234
    v_accvgpr_write_b32 a43, v235
    v_cvt_pk_bf16_f32 v236, v236, v237
    v_cvt_pk_bf16_f32 v237, v238, v239
    v_cvt_pk_bf16_f32 v238, v252, v253
    v_cvt_pk_bf16_f32 v239, v254, v255
    v_accvgpr_write_b32 a44, v236
    v_accvgpr_write_b32 a45, v237
    v_accvgpr_write_b32 a46, v238
    v_accvgpr_write_b32 a47, v239
    s_sub_u32 s51, s92, s45
    s_sub_u32 s52, s93, s45
    v_add_u32 v10, s52, v14
    v_add_u32 v14, s51, v14
    v_add_u32 v11, s52, v15
    v_add_u32 v15, s51, v15
    v_add_u32 v12, s52, v16
    v_add_u32 v16, s51, v16
    v_add_u32 v13, s52, v17
    v_add_u32 v17, s51, v17
    v_accvgpr_write_b32 a100, v10
    v_accvgpr_write_b32 a101, v11
    v_accvgpr_write_b32 a102, v12
    v_accvgpr_write_b32 a103, v13
    v_accvgpr_write_b32 a104, v14
    v_accvgpr_write_b32 a105, v15
    v_accvgpr_write_b32 a106, v16
    v_accvgpr_write_b32 a107, v17
    v_and_b32 v19, 1, v0
    v_mul_u32_u24 v19, 0xaaaa, v19
    v_add_u32 v19, 0x4444, v19
L_max:
    ds_read_b128 a[0:3], v34 offset:8192
    ds_read_b128 a[4:7], v35 offset:8192
    ds_read_b128 v[192:195], v1 offset:57344
    ds_read_b128 v[196:199], v1 offset:58368
    ds_read_b128 v[200:203], v1 offset:59392
    ds_read_b128 v[204:207], v1 offset:60416
    ds_read_b128 v[208:211], v1 offset:61440
    ds_read_b128 v[212:215], v1 offset:62464
    ds_read_b128 v[216:219], v1 offset:63488
    ds_read_b128 v[220:223], v1 offset:64512
    v_max3_f32 v2, v128, v129, v60
    v_max3_f32 v2, v130, v131, v2
    v_max3_f32 v2, v144, v145, v2
    v_max3_f32 v2, v146, v147, v2
    v_max3_f32 v3, v132, v133, v61
    v_max3_f32 v3, v134, v135, v3
    v_max3_f32 v3, v148, v149, v3
    v_max3_f32 v3, v150, v151, v3
    v_max3_f32 v4, v136, v137, v62
    v_max3_f32 v4, v138, v139, v4
    v_max3_f32 v4, v152, v153, v4
    v_max3_f32 v4, v154, v155, v4
    v_max3_f32 v5, v140, v141, v63
    v_max3_f32 v5, v142, v143, v5
    v_max3_f32 v5, v156, v157, v5
    v_max3_f32 v5, v158, v159, v5
    s_waitcnt lgkmcnt(0)
    v_max3_f32 v192, abs(v192), abs(v193), abs(v194)
    v_max_f32_e64 v192, v192, abs(v195)
    v_max3_f32 v196, abs(v196), abs(v197), abs(v198)
    v_max_f32_e64 v196, v196, abs(v199)
    v_max3_f32 v200, abs(v200), abs(v201), abs(v202)
    v_max_f32_e64 v200, v200, abs(v203)
    v_max3_f32 v204, abs(v204), abs(v205), abs(v206)
    v_max_f32_e64 v204, v204, abs(v207)
    v_max3_f32 v208, abs(v208), abs(v209), abs(v210)
    v_max_f32_e64 v208, v208, abs(v211)
    v_max3_f32 v212, abs(v212), abs(v213), abs(v214)
    v_max_f32_e64 v212, v212, abs(v215)
    v_max3_f32 v216, abs(v216), abs(v217), abs(v218)
    v_max_f32_e64 v216, v216, abs(v219)
    v_max3_f32 v220, abs(v220), abs(v221), abs(v222)
    v_max_f32_e64 v220, v220, abs(v223)
    v_min3_f32 v224, v192, v196, v200
    v_min3_f32 v225, v204, v208, v212
    v_min3_f32 v224, v224, v216, v220
    v_min_f32 v224, v224, v225
    v_mov_b32 v225, v224
    v_mov_b32 v6, v2
    v_mov_b32 v7, v3
    v_mov_b32 v8, v4
    v_mov_b32 v9, v5
    v_permlane32_swap_b32 v224, v225
    v_permlane32_swap_b32 v2, v6
    v_permlane32_swap_b32 v3, v7
    v_permlane32_swap_b32 v4, v8
    v_permlane32_swap_b32 v5, v9
    v_min_f32 v224, v224, v225
    v_max_f32 v2, v2, v6
    v_max_f32 v3, v3, v7
    v_max_f32 v4, v4, v8
    v_max_f32 v5, v5, v9
    v_mov_b32 v225, v224
    v_mov_b32 v6, v2
    v_mov_b32 v7, v3
    v_mov_b32 v8, v4
    v_mov_b32 v9, v5
    v_permlane16_swap_b32 v224, v225
    v_permlane16_swap_b32 v2, v6
    v_permlane16_swap_b32 v3, v7
    v_permlane16_swap_b32 v4, v8
    v_permlane16_swap_b32 v5, v9
    v_min_f32 v224, v224, v225
    v_max_f32 v2, v2, v6
    v_max_f32 v3, v3, v7
    v_max_f32 v4, v4, v8
    v_max_f32 v5, v5, v9
    v_min_f32_dpp v224, v224, v224 row_ror:8 row_mask:0xf bank_mask:0xf
    v_sub_f32 v10, 0xc2000000, v2
    v_sub_f32 v11, 0xc2000000, v2
    v_sub_f32 v12, 0xc2000000, v2
    v_sub_f32 v13, 0xc2000000, v2
    v_min_f32_dpp v224, v224, v224 row_ror:4 row_mask:0xf bank_mask:0xf
    v_sub_f32 v14, 0xc2000000, v3
    v_sub_f32 v15, 0xc2000000, v3
    v_sub_f32 v16, 0xc2000000, v3
    v_sub_f32 v17, 0xc2000000, v3
    v_min_f32_dpp v224, v224, v224 row_ror:2 row_mask:0xf bank_mask:0xf
    v_sub_f32 v30, 0xc2000000, v4
    v_sub_f32 v31, 0xc2000000, v4
    v_sub_f32 v32, 0xc2000000, v4
    v_sub_f32 v33, 0xc2000000, v4
    v_min_f32_dpp v224, v224, v224 row_ror:1 row_mask:0xf bank_mask:0xf
    v_sub_f32 v60, 0xc2000000, v5
    v_sub_f32 v61, 0xc2000000, v5
    v_sub_f32 v62, 0xc2000000, v5
    v_sub_f32 v63, 0xc2000000, v5
    v_add_f32 v128, v128, v10
    v_add_f32 v144, v144, v10
    v_add_f32 v129, v129, v10
    v_add_f32 v145, v145, v10
    v_add_f32 v130, v130, v10
    v_add_f32 v146, v146, v10
    v_add_f32 v131, v131, v10
    v_add_f32 v147, v147, v10
    v_add_f32 v132, v132, v14
    v_add_f32 v148, v148, v14
    v_add_f32 v133, v133, v14
    v_add_f32 v149, v149, v14
    v_add_f32 v134, v134, v14
    v_add_f32 v150, v150, v14
    v_add_f32 v135, v135, v14
    v_add_f32 v151, v151, v14
    v_add_f32 v136, v136, v30
    v_add_f32 v152, v152, v30
    v_add_f32 v137, v137, v30
    v_add_f32 v153, v153, v30
    v_add_f32 v138, v138, v30
    v_add_f32 v154, v154, v30
    v_add_f32 v139, v139, v30
    v_add_f32 v155, v155, v30
    v_add_f32 v140, v140, v60
    v_add_f32 v156, v156, v60
    v_add_f32 v141, v141, v60
    v_add_f32 v157, v157, v60
    v_add_f32 v142, v142, v60
    v_add_f32 v158, v158, v60
    v_add_f32 v143, v143, v60
    v_add_f32 v159, v159, v60
    v_and_b32 v224, 0xffff0000, v224
    v_mul_f32 v224, 0x34800000, v224
    v_accvgpr_write_b32 a92, v224
    v_accvgpr_write_b32 a93, v224
    v_accvgpr_write_b32 a94, v224
    v_accvgpr_write_b32 a95, v224
    s_mov_b32 s58, 0
    v_mfma_f32_16x16x32_bf16 v[160:163], a[0:3], v[64:67], v[10:13]
    ds_read_b128 a[8:11], v36 offset:8192
    ds_read_b128 a[12:15], v37 offset:8192
    v_exp_f32 v128, v128
    v_mfma_f32_16x16x32_bf16 v[160:163], a[4:7], v[68:71], v[160:163]
    v_exp_f32 v129, v129
    v_mfma_f32_16x16x32_bf16 v[164:167], a[0:3], v[80:83], v[14:17]
    v_exp_f32 v130, v130
    v_mfma_f32_16x16x32_bf16 v[164:167], a[4:7], v[84:87], v[164:167]
    v_exp_f32 v131, v131
    v_cvt_pk_bf16_f32 v196, v128, v129
    v_mfma_f32_16x16x32_bf16 v[168:171], a[0:3], v[96:99], v[30:33]
    v_exp_f32 v144, v144
    v_mfma_f32_16x16x32_bf16 v[168:171], a[4:7], v[100:103], v[168:171]
    v_exp_f32 v145, v145
    v_cvt_pk_bf16_f32 v197, v130, v131
    v_mfma_f32_16x16x32_bf16 v[172:175], a[0:3], v[112:115], v[60:63]
    v_exp_f32 v146, v146
    v_mov_b32 v204, 0
    v_mov_b32 v205, 0
    v_mov_b32 v206, 0
    v_mov_b32 v207, 0
    v_mfma_f32_16x16x32_bf16 v[172:175], a[4:7], v[116:119], v[172:175]
    s_waitcnt lgkmcnt(0)
    v_exp_f32 v147, v147
    v_cvt_pk_bf16_f32 v198, v144, v145
    v_mfma_f32_16x16x32_bf16 v[160:163], a[8:11], v[72:75], v[160:163]
    ds_read_b128 a[0:3], v34 offset:12288
    ds_read_b128 a[4:7], v35 offset:12288
    v_exp_f32 v132, v132
    v_mfma_f32_16x16x32_bf16 v[160:163], a[12:15], v[76:79], v[160:163]
    v_exp_f32 v133, v133
    v_cvt_pk_bf16_f32 v199, v146, v147
    v_mfma_f32_16x16x32_bf16 v[164:167], a[8:11], v[88:91], v[164:167]
    v_exp_f32 v134, v134
    v_mfma_f32_16x16x32_bf16 v[164:167], a[12:15], v[92:95], v[164:167]
    v_exp_f32 v135, v135
    v_cvt_pk_bf16_f32 v212, v132, v133
    v_mfma_f32_16x16x32_bf16 v[168:171], a[8:11], v[104:107], v[168:171]
    v_exp_f32 v148, v148
    v_mfma_f32_16x16x32_bf16 v[168:171], a[12:15], v[108:111], v[168:171]
    v_exp_f32 v149, v149
    v_cvt_pk_bf16_f32 v213, v134, v135
    v_mfma_f32_16x16x32_bf16 v[172:175], a[8:11], v[120:123], v[172:175]
    v_exp_f32 v150, v150
    v_mov_b32 v220, 0
    v_mov_b32 v221, 0
    v_mov_b32 v222, 0
    v_mov_b32 v223, 0
    v_mfma_f32_16x16x32_bf16 v[172:175], a[12:15], v[124:127], v[172:175]
    s_waitcnt lgkmcnt(0)
    v_exp_f32 v151, v151
    v_cvt_pk_bf16_f32 v214, v148, v149
    v_mfma_f32_16x16x32_bf16 v[176:179], a[0:3], v[64:67], v[10:13]
    ds_read_b128 a[8:11], v36 offset:12288
    ds_read_b128 a[12:15], v37 offset:12288
    v_exp_f32 v136, v136
    v_mfma_f32_16x16x32_bf16 v[176:179], a[4:7], v[68:71], v[176:179]
    v_exp_f32 v137, v137
    v_cvt_pk_bf16_f32 v215, v150, v151
    v_mfma_f32_16x16x32_bf16 v[180:183], a[0:3], v[80:83], v[14:17]
    v_exp_f32 v138, v138
    v_mfma_f32_16x16x32_bf16 v[180:183], a[4:7], v[84:87], v[180:183]
    v_exp_f32 v139, v139
    v_cvt_pk_bf16_f32 v228, v136, v137
    v_mfma_f32_16x16x32_bf16 v[184:187], a[0:3], v[96:99], v[30:33]
    v_exp_f32 v152, v152
    v_mfma_f32_16x16x32_bf16 v[184:187], a[4:7], v[100:103], v[184:187]
    v_exp_f32 v153, v153
    v_cvt_pk_bf16_f32 v229, v138, v139
    v_mfma_f32_16x16x32_bf16 v[188:191], a[0:3], v[112:115], v[60:63]
    v_exp_f32 v154, v154
    v_mov_b32 v236, 0
    v_mov_b32 v237, 0
    v_mov_b32 v238, 0
    v_mov_b32 v239, 0
    v_mfma_f32_16x16x32_bf16 v[188:191], a[4:7], v[116:119], v[188:191]
    s_waitcnt lgkmcnt(0)
    v_exp_f32 v155, v155
    v_cvt_pk_bf16_f32 v230, v152, v153
    v_mfma_f32_16x16x32_bf16 v[176:179], a[8:11], v[72:75], v[176:179]
    ds_read_b128 a[0:3], v34 offset:16384
    ds_read_b128 a[4:7], v35 offset:16384
    v_exp_f32 v140, v140
    v_mfma_f32_16x16x32_bf16 v[176:179], a[12:15], v[76:79], v[176:179]
    v_exp_f32 v141, v141
    v_cvt_pk_bf16_f32 v231, v154, v155
    v_mfma_f32_16x16x32_bf16 v[180:183], a[8:11], v[88:91], v[180:183]
    v_exp_f32 v142, v142
    v_mfma_f32_16x16x32_bf16 v[180:183], a[12:15], v[92:95], v[180:183]
    v_exp_f32 v143, v143
    v_cvt_pk_bf16_f32 v244, v140, v141
    v_mfma_f32_16x16x32_bf16 v[184:187], a[8:11], v[104:107], v[184:187]
    v_exp_f32 v156, v156
    v_mfma_f32_16x16x32_bf16 v[184:187], a[12:15], v[108:111], v[184:187]
    v_exp_f32 v157, v157
    v_cvt_pk_bf16_f32 v245, v142, v143
    v_mfma_f32_16x16x32_bf16 v[188:191], a[8:11], v[120:123], v[188:191]
    v_exp_f32 v158, v158
    v_mov_b32 v252, 0
    v_mov_b32 v253, 0
    v_mov_b32 v254, 0
    v_mov_b32 v255, 0
    v_mfma_f32_16x16x32_bf16 v[188:191], a[12:15], v[124:127], v[188:191]
    s_waitcnt lgkmcnt(0)
    v_exp_f32 v159, v159
    v_cvt_pk_bf16_f32 v246, v156, v157
    v_mfma_f32_16x16x32_bf16 v[128:131], a[0:3], v[64:67], v[10:13]
    s_add_u32 m0, s56, 32768
    ds_read_b128 a[8:11], v36 offset:16384
    ds_read_b128 a[12:15], v37 offset:16384
    v_mfma_f32_16x16x32_bf16 v[128:131], a[4:7], v[68:71], v[128:131]
    buffer_load_dwordx4 v46, s[8:11], s54 offen offset:0 lds
    v_mfma_f32_16x16x32_bf16 v[132:135], a[0:3], v[80:83], v[14:17]
    v_exp_f32 v160, v160
    v_mfma_f32_16x16x32_bf16 v[132:135], a[4:7], v[84:87], v[132:135]
    v_exp_f32 v161, v161
    v_mfma_f32_16x16x32_bf16 v[136:139], a[0:3], v[96:99], v[30:33]
    v_cvt_pk_bf16_f32 v247, v158, v159
    v_cvt_pk_bf16_f32 v200, v160, v161
    v_mfma_f32_16x16x32_bf16 v[136:139], a[4:7], v[100:103], v[136:139]
    buffer_load_dwordx4 v47, s[8:11], s54 offen offset:1024 lds
    v_mfma_f32_16x16x32_bf16 v[140:143], a[0:3], v[112:115], v[60:63]
    v_exp_f32 v162, v162
    v_mfma_f32_16x16x32_bf16 v[140:143], a[4:7], v[116:119], v[140:143]
    s_waitcnt lgkmcnt(0)
    v_exp_f32 v163, v163
    v_mfma_f32_16x16x32_bf16 v[128:131], a[8:11], v[72:75], v[128:131]
    ds_read_b128 a[0:3], v34 offset:20480
    ds_read_b128 a[4:7], v35 offset:20480
    v_mfma_f32_16x16x32_bf16 v[128:131], a[12:15], v[76:79], v[128:131]
    buffer_load_dwordx4 v48, s[8:11], s54 offen offset:2048 lds
    v_mfma_f32_16x16x32_bf16 v[132:135], a[8:11], v[88:91], v[132:135]
    v_exp_f32 v176, v176
    v_mfma_f32_16x16x32_bf16 v[132:135], a[12:15], v[92:95], v[132:135]
    v_exp_f32 v177, v177
    v_mfma_f32_16x16x32_bf16 v[136:139], a[8:11], v[104:107], v[136:139]
    v_cvt_pk_bf16_f32 v201, v162, v163
    v_cvt_pk_bf16_f32 v202, v176, v177
    v_mfma_f32_16x16x32_bf16 v[136:139], a[12:15], v[108:111], v[136:139]
    buffer_load_dwordx4 v49, s[8:11], s54 offen offset:3072 lds
    v_mfma_f32_16x16x32_bf16 v[140:143], a[8:11], v[120:123], v[140:143]
    s_add_u32 s54, s54, 16384
    v_exp_f32 v178, v178
    v_mfma_f32_16x16x32_bf16 v[140:143], a[12:15], v[124:127], v[140:143]
    s_waitcnt lgkmcnt(0)
    v_exp_f32 v179, v179
    v_mfma_f32_16x16x32_bf16 v[144:147], a[0:3], v[64:67], v[10:13]
    s_and_b32 s54, s54, 524287
    s_add_u32 m0, s57, 32768
    ds_read_b128 a[8:11], v36 offset:20480
    ds_read_b128 a[12:15], v37 offset:20480
    v_mfma_f32_16x16x32_bf16 v[144:147], a[4:7], v[68:71], v[144:147]
    buffer_load_dwordx4 v50, s[12:15], s55 offen offset:0 lds
    v_mfma_f32_16x16x32_bf16 v[148:151], a[0:3], v[80:83], v[14:17]
    v_exp_f32 v164, v164
    v_mfma_f32_16x16x32_bf16 v[148:151], a[4:7], v[84:87], v[148:151]
    v_exp_f32 v165, v165
    v_mfma_f32_16x16x32_bf16 v[152:155], a[0:3], v[96:99], v[30:33]
    v_cvt_pk_bf16_f32 v203, v178, v179
    v_cvt_pk_bf16_f32 v216, v164, v165
    v_mfma_f32_16x16x32_bf16 v[152:155], a[4:7], v[100:103], v[152:155]
    buffer_load_dwordx4 v51, s[12:15], s55 offen offset:1024 lds
    v_mfma_f32_16x16x32_bf16 v[156:159], a[0:3], v[112:115], v[60:63]
    v_exp_f32 v166, v166
    v_mfma_f32_16x16x32_bf16 v[156:159], a[4:7], v[116:119], v[156:159]
    s_waitcnt lgkmcnt(0)
    v_exp_f32 v167, v167
    v_mfma_f32_16x16x32_bf16 v[144:147], a[8:11], v[72:75], v[144:147]
    ds_read_b64_tr_b16 a[0:1], v42 offset:0
    ds_read_b64_tr_b16 a[2:3], v42 offset:4096
    v_mfma_f32_16x16x32_bf16 v[144:147], a[12:15], v[76:79], v[144:147]
    v_exp_f32 v180, v180
    v_mfma_f32_16x16x32_bf16 v[148:151], a[8:11], v[88:91], v[148:151]
    ds_read_b64_tr_b16 a[4:5], v42 offset:0
    ds_read_b64_tr_b16 a[6:7], v42 offset:4096
    v_mfma_f32_16x16x32_bf16 v[148:151], a[12:15], v[92:95], v[148:151]
    v_exp_f32 v181, v181
    v_mfma_f32_16x16x32_bf16 v[152:155], a[8:11], v[104:107], v[152:155]
    v_cvt_pk_bf16_f32 v217, v166, v167
    v_cvt_pk_bf16_f32 v218, v180, v181
    v_mfma_f32_16x16x32_bf16 v[152:155], a[12:15], v[108:111], v[152:155]
    buffer_load_dwordx4 v50, s[12:15], s55 offen offset:2048 lds
    v_mfma_f32_16x16x32_bf16 v[156:159], a[8:11], v[120:123], v[156:159]
    v_exp_f32 v182, v182
    v_mfma_f32_16x16x32_bf16 v[156:159], a[12:15], v[124:127], v[156:159]
    s_waitcnt lgkmcnt(0)
    v_exp_f32 v183, v183
    v_mfma_f32_16x16x32_bf16 a[128:131], a[0:3], v[204:207], a[92:95]
    ds_read_b64_tr_b16 a[8:9], v43 offset:0
    ds_read_b64_tr_b16 a[10:11], v43 offset:4096
    v_mfma_f32_16x16x32_bf16 a[192:195], a[4:7], v[196:199], a[92:95]
    v_exp_f32 v168, v168
    v_mfma_f32_16x16x32_bf16 a[132:135], a[0:3], v[220:223], a[92:95]
    ds_read_b64_tr_b16 a[12:13], v43 offset:0
    ds_read_b64_tr_b16 a[14:15], v43 offset:4096
    v_mfma_f32_16x16x32_bf16 a[196:199], a[4:7], v[212:215], a[92:95]
    v_exp_f32 v169, v169
    v_mfma_f32_16x16x32_bf16 a[136:139], a[0:3], v[236:239], a[92:95]
    v_cvt_pk_bf16_f32 v219, v182, v183
    v_cvt_pk_bf16_f32 v232, v168, v169
    v_mfma_f32_16x16x32_bf16 a[200:203], a[4:7], v[228:231], a[92:95]
    buffer_load_dwordx4 v51, s[12:15], s55 offen offset:3072 lds
    v_mfma_f32_16x16x32_bf16 a[140:143], a[0:3], v[252:255], a[92:95]
    s_add_u32 s55, s55, 16384
    v_exp_f32 v170, v170
    v_add_u32 v34, 32768, v34
    v_add_u32 v35, 32768, v35
    v_add_u32 v42, 57344, v42
    v_mfma_f32_16x16x32_bf16 a[204:207], a[4:7], v[244:247], a[92:95]
    s_waitcnt lgkmcnt(0)
    v_exp_f32 v171, v171
    v_mfma_f32_16x16x32_bf16 a[144:147], a[8:11], v[204:207], a[92:95]
    ds_read_b64_tr_b16 a[0:1], v44 offset:0
    ds_read_b64_tr_b16 a[2:3], v44 offset:4096
    v_mfma_f32_16x16x32_bf16 a[208:211], a[12:15], v[196:199], a[92:95]
    v_exp_f32 v184, v184
    v_mfma_f32_16x16x32_bf16 a[148:151], a[8:11], v[220:223], a[92:95]
    s_and_b32 s55, s55, 524287
    ds_read_b64_tr_b16 a[4:5], v44 offset:0
    ds_read_b64_tr_b16 a[6:7], v44 offset:4096
    v_mfma_f32_16x16x32_bf16 a[212:215], a[12:15], v[212:215], a[92:95]
    v_exp_f32 v185, v185
    v_mfma_f32_16x16x32_bf16 a[152:155], a[8:11], v[236:239], a[92:95]
    s_mov_b32 s51, 0
    v_cvt_pk_bf16_f32 v233, v170, v171
    v_cvt_pk_bf16_f32 v234, v184, v185
    v_mfma_f32_16x16x32_bf16 a[216:219], a[12:15], v[228:231], a[92:95]
    buffer_load_dword a96, v58, s[20:23], s51 offen
    v_mfma_f32_16x16x32_bf16 a[156:159], a[8:11], v[252:255], a[92:95]
    v_exp_f32 v186, v186
    v_add_u32 v36, 32768, v36
    v_add_u32 v37, 32768, v37
    v_add_u32 v43, 57344, v43
    v_mfma_f32_16x16x32_bf16 a[220:223], a[12:15], v[244:247], a[92:95]
    s_waitcnt lgkmcnt(0)
    v_exp_f32 v187, v187
    v_mfma_f32_16x16x32_bf16 a[160:163], a[0:3], v[204:207], a[92:95]
    ds_read_b64_tr_b16 a[8:9], v45 offset:0
    ds_read_b64_tr_b16 a[10:11], v45 offset:4096
    v_mfma_f32_16x16x32_bf16 a[224:227], a[4:7], v[196:199], a[92:95]
    v_exp_f32 v172, v172
    v_mfma_f32_16x16x32_bf16 a[164:167], a[0:3], v[220:223], a[92:95]
    ds_read_b64_tr_b16 a[12:13], v45 offset:0
    ds_read_b64_tr_b16 a[14:15], v45 offset:4096
    v_mfma_f32_16x16x32_bf16 a[228:231], a[4:7], v[212:215], a[92:95]
    v_exp_f32 v173, v173
    v_mfma_f32_16x16x32_bf16 a[168:171], a[0:3], v[236:239], a[92:95]
    v_cvt_pk_bf16_f32 v235, v186, v187
    v_cvt_pk_bf16_f32 v248, v172, v173
    v_mfma_f32_16x16x32_bf16 a[232:235], a[4:7], v[228:231], a[92:95]
    v_add_u32 v44, 57344, v44
    v_mfma_f32_16x16x32_bf16 a[172:175], a[0:3], v[252:255], a[92:95]
    v_exp_f32 v174, v174
    v_mfma_f32_16x16x32_bf16 a[236:239], a[4:7], v[244:247], a[92:95]
    s_waitcnt vmcnt(9) lgkmcnt(0)
    v_exp_f32 v175, v175
    v_mfma_f32_16x16x32_bf16 a[176:179], a[8:11], v[204:207], a[92:95]
    s_barrier
    v_mfma_f32_16x16x32_bf16 a[240:243], a[12:15], v[196:199], a[92:95]
    v_exp_f32 v188, v188
    v_mfma_f32_16x16x32_bf16 a[180:183], a[8:11], v[220:223], a[92:95]
    ds_read_b128 a[0:3], v34 offset:16384
    ds_read_b128 a[4:7], v35 offset:16384
    v_mfma_f32_16x16x32_bf16 a[244:247], a[12:15], v[212:215], a[92:95]
    v_exp_f32 v189, v189
    v_mfma_f32_16x16x32_bf16 a[184:187], a[8:11], v[236:239], a[92:95]
    v_cvt_pk_bf16_f32 v249, v174, v175
    v_cvt_pk_bf16_f32 v250, v188, v189
    v_mfma_f32_16x16x32_bf16 a[248:251], a[12:15], v[228:231], a[92:95]
    v_add_u32 v45, 57344, v45
    v_mfma_f32_16x16x32_bf16 a[188:191], a[8:11], v[252:255], a[92:95]
    v_exp_f32 v190, v190
    v_mfma_f32_16x16x32_bf16 a[252:255], a[12:15], v[244:247], a[92:95]
    v_exp_f32 v191, v191
    v_smfmac_f32_16x16x64_bf16 a[108:111], a[112:115], v[196:203], v19
    v_cvt_pk_bf16_f32 v251, v190, v191
    v_smfmac_f32_16x16x64_bf16 a[108:111], a[116:119], v[212:219], v19
    v_smfmac_f32_16x16x64_bf16 a[108:111], a[120:123], v[228:235], v19
    v_smfmac_f32_16x16x64_bf16 a[108:111], a[124:127], v[244:251], v19
    s_waitcnt lgkmcnt(0)
    s_or_b32 s51, s40, s42
    s_cmp_eq_u32 s51, 0
    s_cbranch_scc0 L_notok
    s_lshl_b32 s51, s41, 3
    v_mov_b32 v2, s74
    v_mov_b32 v3, 0
    v_mov_b32 v4, s51
    s_mov_b64 exec, 1
    global_atomic_cmpswap v4, v[2:3], s[84:85] offset:4 sc1
    s_mov_b64 exec, -1
L_notok:
    ds_write_b128 v18, a[16:19] offset:32768
    ds_write_b128 v18, a[20:23] offset:33792
    ds_write_b128 v18, a[24:27] offset:40960
    ds_write_b128 v18, a[28:31] offset:41984
    ds_write_b128 v18, a[32:35] offset:49152
    ds_write_b128 v18, a[36:39] offset:50176
    ds_write_b128 v18, a[40:43] offset:57344
    ds_write_b128 v18, a[44:47] offset:58368
    s_mov_b32 s24, s36
    s_mov_b32 s25, s37
    s_mov_b32 s27, 0x20000
    s_mov_b32 s64, 0
    s_cmp_eq_u32 s59, 0
    s_cselect_b32 s26, 16384, 0
    s_waitcnt lgkmcnt(0)
    .p2align 6
L_loop:
    v_mfma_f32_16x16x32_bf16 v[160:163], a[0:3], v[64:67], v[10:13]
    s_add_u32 m0, s56, 0
    ds_read_b128 a[8:11], v36 offset:16384
    ds_read_b128 a[12:15], v37 offset:16384
    v_mfma_f32_16x16x32_bf16 v[160:163], a[4:7], v[68:71], v[160:163]
    buffer_load_dwordx4 v46, s[8:11], s54 offen offset:0 lds
    v_mfma_f32_16x16x32_bf16 v[164:167], a[0:3], v[80:83], v[14:17]
    v_exp_f32 v128, v128
    v_mfma_f32_16x16x32_bf16 v[164:167], a[4:7], v[84:87], v[164:167]
    v_exp_f32 v129, v129
    v_mfma_f32_16x16x32_bf16 v[168:171], a[0:3], v[96:99], v[30:33]
    v_cvt_pk_bf16_f32 v192, v128, v129
    v_mfma_f32_16x16x32_bf16 v[168:171], a[4:7], v[100:103], v[168:171]
    buffer_load_dwordx4 v47, s[8:11], s54 offen offset:1024 lds
    v_mfma_f32_16x16x32_bf16 v[172:175], a[0:3], v[112:115], v[60:63]
    v_exp_f32 v130, v130
    v_mfma_f32_16x16x32_bf16 v[172:175], a[4:7], v[116:119], v[172:175]
    s_waitcnt lgkmcnt(0)
    v_exp_f32 v131, v131
    v_mfma_f32_16x16x32_bf16 v[160:163], a[8:11], v[72:75], v[160:163]
    ds_read_b128 a[0:3], v34 offset:20480
    ds_read_b128 a[4:7], v35 offset:20480
    v_mfma_f32_16x16x32_bf16 v[160:163], a[12:15], v[76:79], v[160:163]
    buffer_load_dwordx4 v48, s[8:11], s54 offen offset:2048 lds
    v_mfma_f32_16x16x32_bf16 v[164:167], a[8:11], v[88:91], v[164:167]
    v_exp_f32 v144, v144
    v_mfma_f32_16x16x32_bf16 v[164:167], a[12:15], v[92:95], v[164:167]
    v_exp_f32 v145, v145
    v_mfma_f32_16x16x32_bf16 v[168:171], a[8:11], v[104:107], v[168:171]
    v_cvt_pk_bf16_f32 v193, v130, v131
    v_cvt_pk_bf16_f32 v194, v144, v145
    v_mfma_f32_16x16x32_bf16 v[168:171], a[12:15], v[108:111], v[168:171]
    buffer_load_dwordx4 v49, s[8:11], s54 offen offset:3072 lds
    v_mfma_f32_16x16x32_bf16 v[172:175], a[8:11], v[120:123], v[172:175]
    s_add_u32 s54, s54, 16384
    v_exp_f32 v146, v146
    v_mfma_f32_16x16x32_bf16 v[172:175], a[12:15], v[124:127], v[172:175]
    s_waitcnt lgkmcnt(0)
    v_exp_f32 v147, v147
    v_mfma_f32_16x16x32_bf16 v[176:179], a[0:3], v[64:67], v[10:13]
    ds_read_b128 a[8:11], v36 offset:20480
    ds_read_b128 a[12:15], v37 offset:20480
    v_mfma_f32_16x16x32_bf16 v[176:179], a[4:7], v[68:71], v[176:179]
    ds_read_b128 v[20:23], v18 offset:0
    v_mfma_f32_16x16x32_bf16 v[180:183], a[0:3], v[80:83], v[14:17]
    s_and_b32 s54, s54, 524287
    v_exp_f32 v132, v132
    v_mfma_f32_16x16x32_bf16 v[180:183], a[4:7], v[84:87], v[180:183]
    v_exp_f32 v133, v133
    v_mfma_f32_16x16x32_bf16 v[184:187], a[0:3], v[96:99], v[30:33]
    v_cvt_pk_bf16_f32 v195, v146, v147
    v_cvt_pk_bf16_f32 v208, v132, v133
    v_mfma_f32_16x16x32_bf16 v[184:187], a[4:7], v[100:103], v[184:187]
    v_mfma_f32_16x16x32_bf16 v[188:191], a[0:3], v[112:115], v[60:63]
    v_exp_f32 v134, v134
    v_mfma_f32_16x16x32_bf16 v[188:191], a[4:7], v[116:119], v[188:191]
    s_waitcnt lgkmcnt(1)
    v_exp_f32 v135, v135
    v_mfma_f32_16x16x32_bf16 v[176:179], a[8:11], v[72:75], v[176:179]
    ds_read_b64_tr_b16 a[0:1], v38 offset:8192
    ds_read_b64_tr_b16 a[2:3], v38 offset:12288
    v_mfma_f32_16x16x32_bf16 v[176:179], a[12:15], v[76:79], v[176:179]
    v_exp_f32 v148, v148
    v_mfma_f32_16x16x32_bf16 v[180:183], a[8:11], v[88:91], v[180:183]
    ds_read_b64_tr_b16 a[4:5], v38 offset:16384
    ds_read_b64_tr_b16 a[6:7], v38 offset:20480
    v_mfma_f32_16x16x32_bf16 v[180:183], a[12:15], v[92:95], v[180:183]
    v_exp_f32 v149, v149
    v_mfma_f32_16x16x32_bf16 v[184:187], a[8:11], v[104:107], v[184:187]
    v_cvt_pk_bf16_f32 v209, v134, v135
    v_cvt_pk_bf16_f32 v210, v148, v149
    v_mfma_f32_16x16x32_bf16 v[184:187], a[12:15], v[108:111], v[184:187]
    v_mfma_f32_16x16x32_bf16 v[188:191], a[8:11], v[120:123], v[188:191]
    v_exp_f32 v150, v150
    v_mfma_f32_16x16x32_bf16 v[188:191], a[12:15], v[124:127], v[188:191]
    s_waitcnt lgkmcnt(0)
    v_exp_f32 v151, v151
    v_mfma_f32_16x16x32_bf16 a[128:131], a[0:3], v[196:199], a[128:131]
    ds_read_b64_tr_b16 a[8:9], v39 offset:8192
    ds_read_b64_tr_b16 a[10:11], v39 offset:12288
    v_mfma_f32_16x16x32_bf16 a[128:131], a[4:7], v[200:203], a[128:131]
    v_exp_f32 v136, v136
    v_mfma_f32_16x16x32_bf16 a[132:135], a[0:3], v[212:215], a[132:135]
    ds_read_b64_tr_b16 a[12:13], v39 offset:16384
    ds_read_b64_tr_b16 a[14:15], v39 offset:20480
    v_mfma_f32_16x16x32_bf16 a[132:135], a[4:7], v[216:219], a[132:135]
    v_exp_f32 v137, v137
    v_mfma_f32_16x16x32_bf16 a[136:139], a[0:3], v[228:231], a[136:139]
    v_cvt_pk_bf16_f32 v211, v150, v151
    v_cvt_pk_bf16_f32 v224, v136, v137
    v_mfma_f32_16x16x32_bf16 a[136:139], a[4:7], v[232:235], a[136:139]
    v_mfma_f32_16x16x32_bf16 a[140:143], a[0:3], v[244:247], a[140:143]
    v_exp_f32 v138, v138
    v_mfma_f32_16x16x32_bf16 a[140:143], a[4:7], v[248:251], a[140:143]
    s_waitcnt lgkmcnt(0)
    v_exp_f32 v139, v139
    v_mfma_f32_16x16x32_bf16 a[144:147], a[8:11], v[196:199], a[144:147]
    ds_read_b64_tr_b16 a[0:1], v40 offset:8192
    ds_read_b64_tr_b16 a[2:3], v40 offset:12288
    v_mfma_f32_16x16x32_bf16 a[144:147], a[12:15], v[200:203], a[144:147]
    v_exp_f32 v152, v152
    v_mfma_f32_16x16x32_bf16 a[148:151], a[8:11], v[212:215], a[148:151]
    ds_read_b64_tr_b16 a[4:5], v40 offset:16384
    ds_read_b64_tr_b16 a[6:7], v40 offset:20480
    v_mfma_f32_16x16x32_bf16 a[148:151], a[12:15], v[216:219], a[148:151]
    v_exp_f32 v153, v153
    v_mfma_f32_16x16x32_bf16 a[152:155], a[8:11], v[228:231], a[152:155]
    v_cvt_pk_bf16_f32 v225, v138, v139
    v_cvt_pk_bf16_f32 v226, v152, v153
    v_mfma_f32_16x16x32_bf16 a[152:155], a[12:15], v[232:235], a[152:155]
    v_mfma_f32_16x16x32_bf16 a[156:159], a[8:11], v[244:247], a[156:159]
    v_exp_f32 v154, v154
    v_mfma_f32_16x16x32_bf16 a[156:159], a[12:15], v[248:251], a[156:159]
    s_waitcnt lgkmcnt(0)
    v_exp_f32 v155, v155
    v_mfma_f32_16x16x32_bf16 a[160:163], a[0:3], v[196:199], a[160:163]
    ds_read_b64_tr_b16 a[8:9], v41 offset:8192
    ds_read_b64_tr_b16 a[10:11], v41 offset:12288
    v_mfma_f32_16x16x32_bf16 a[160:163], a[4:7], v[200:203], a[160:163]
    v_exp_f32 v140, v140
    v_mfma_f32_16x16x32_bf16 a[164:167], a[0:3], v[212:215], a[164:167]
    ds_read_b64_tr_b16 a[12:13], v41 offset:16384
    ds_read_b64_tr_b16 a[14:15], v41 offset:20480
    v_mfma_f32_16x16x32_bf16 a[164:167], a[4:7], v[216:219], a[164:167]
    v_exp_f32 v141, v141
    v_mfma_f32_16x16x32_bf16 a[168:171], a[0:3], v[228:231], a[168:171]
    v_cvt_pk_bf16_f32 v227, v154, v155
    v_cvt_pk_bf16_f32 v240, v140, v141
    v_mfma_f32_16x16x32_bf16 a[168:171], a[4:7], v[232:235], a[168:171]
    v_mfma_f32_16x16x32_bf16 a[172:175], a[0:3], v[244:247], a[172:175]
    v_exp_f32 v142, v142
    v_mfma_f32_16x16x32_bf16 a[172:175], a[4:7], v[248:251], a[172:175]
    s_waitcnt lgkmcnt(0)
    v_exp_f32 v143, v143
    v_mfma_f32_16x16x32_bf16 a[176:179], a[8:11], v[196:199], a[176:179]
    ds_read_b128 a[0:3], v34 offset:24576
    ds_read_b128 a[4:7], v35 offset:24576
    v_mfma_f32_16x16x32_bf16 a[176:179], a[12:15], v[200:203], a[176:179]
    s_barrier
    v_mfma_f32_16x16x32_bf16 a[180:183], a[8:11], v[212:215], a[180:183]
    v_exp_f32 v156, v156
    v_mfma_f32_16x16x32_bf16 a[180:183], a[12:15], v[216:219], a[180:183]
    v_exp_f32 v157, v157
    v_mfma_f32_16x16x32_bf16 a[184:187], a[8:11], v[228:231], a[184:187]
    v_cvt_pk_bf16_f32 v241, v142, v143
    v_cvt_pk_bf16_f32 v242, v156, v157
    v_mfma_f32_16x16x32_bf16 a[184:187], a[12:15], v[232:235], a[184:187]
    v_mfma_f32_16x16x32_bf16 a[188:191], a[8:11], v[244:247], a[188:191]
    v_exp_f32 v158, v158
    v_mfma_f32_16x16x32_bf16 a[188:191], a[12:15], v[248:251], a[188:191]
    s_waitcnt lgkmcnt(0)
    v_exp_f32 v159, v159
    v_mfma_f32_16x16x32_bf16 v[128:131], a[0:3], v[64:67], v[10:13]
    s_add_u32 m0, s57, 0
    ds_read_b128 a[8:11], v36 offset:24576
    ds_read_b128 a[12:15], v37 offset:24576
    v_mfma_f32_16x16x32_bf16 v[128:131], a[4:7], v[68:71], v[128:131]
    buffer_load_dwordx4 v50, s[12:15], s55 offen offset:0 lds
    v_mfma_f32_16x16x32_bf16 v[132:135], a[0:3], v[80:83], v[14:17]
    v_exp_f32 v160, v160
    v_mfma_f32_16x16x32_bf16 v[132:135], a[4:7], v[84:87], v[132:135]
    v_exp_f32 v161, v161
    v_mfma_f32_16x16x32_bf16 v[136:139], a[0:3], v[96:99], v[30:33]
    v_cvt_pk_bf16_f32 v243, v158, v159
    v_cvt_pk_bf16_f32 v196, v160, v161
    v_mfma_f32_16x16x32_bf16 v[136:139], a[4:7], v[100:103], v[136:139]
    buffer_load_dwordx4 v51, s[12:15], s55 offen offset:1024 lds
    v_mfma_f32_16x16x32_bf16 v[140:143], a[0:3], v[112:115], v[60:63]
    v_exp_f32 v162, v162
    v_mfma_f32_16x16x32_bf16 v[140:143], a[4:7], v[116:119], v[140:143]
    s_waitcnt lgkmcnt(0)
    v_exp_f32 v163, v163
    v_mfma_f32_16x16x32_bf16 v[128:131], a[8:11], v[72:75], v[128:131]
    ds_read_b128 a[0:3], v34 offset:28672
    ds_read_b128 a[4:7], v35 offset:28672
    v_mfma_f32_16x16x32_bf16 v[128:131], a[12:15], v[76:79], v[128:131]
    buffer_load_dwordx4 v50, s[12:15], s55 offen offset:2048 lds
    v_mfma_f32_16x16x32_bf16 v[132:135], a[8:11], v[88:91], v[132:135]
    v_exp_f32 v176, v176
    v_mfma_f32_16x16x32_bf16 v[132:135], a[12:15], v[92:95], v[132:135]
    v_exp_f32 v177, v177
    v_mfma_f32_16x16x32_bf16 v[136:139], a[8:11], v[104:107], v[136:139]
    v_cvt_pk_bf16_f32 v197, v162, v163
    v_cvt_pk_bf16_f32 v198, v176, v177
    v_mfma_f32_16x16x32_bf16 v[136:139], a[12:15], v[108:111], v[136:139]
    buffer_load_dwordx4 v51, s[12:15], s55 offen offset:3072 lds
    v_mfma_f32_16x16x32_bf16 v[140:143], a[8:11], v[120:123], v[140:143]
    s_add_u32 s55, s55, 16384
    v_exp_f32 v178, v178
    v_mfma_f32_16x16x32_bf16 v[140:143], a[12:15], v[124:127], v[140:143]
    s_waitcnt lgkmcnt(0)
    v_exp_f32 v179, v179
    v_mfma_f32_16x16x32_bf16 v[144:147], a[0:3], v[64:67], v[10:13]
    ds_read_b128 a[8:11], v36 offset:28672
    ds_read_b128 a[12:15], v37 offset:28672
    v_mfma_f32_16x16x32_bf16 v[144:147], a[4:7], v[68:71], v[144:147]
    v_mfma_f32_16x16x32_bf16 v[148:151], a[0:3], v[80:83], v[14:17]
    s_and_b32 s55, s55, 524287
    v_exp_f32 v164, v164
    v_mfma_f32_16x16x32_bf16 v[148:151], a[4:7], v[84:87], v[148:151]
    v_exp_f32 v165, v165
    v_mfma_f32_16x16x32_bf16 v[152:155], a[0:3], v[96:99], v[30:33]
    v_cvt_pk_bf16_f32 v199, v178, v179
    v_cvt_pk_bf16_f32 v212, v164, v165
    v_mfma_f32_16x16x32_bf16 v[152:155], a[4:7], v[100:103], v[152:155]
    v_mfma_f32_16x16x32_bf16 v[156:159], a[0:3], v[112:115], v[60:63]
    v_exp_f32 v166, v166
    v_mfma_f32_16x16x32_bf16 v[156:159], a[4:7], v[116:119], v[156:159]
    s_waitcnt lgkmcnt(0)
    v_exp_f32 v167, v167
    v_mfma_f32_16x16x32_bf16 v[144:147], a[8:11], v[72:75], v[144:147]
    ds_read_b64_tr_b16 a[0:1], v42 offset:16384
    ds_read_b64_tr_b16 a[2:3], v42 offset:20480
    v_mfma_f32_16x16x32_bf16 v[144:147], a[12:15], v[76:79], v[144:147]
    v_exp_f32 v180, v180
    v_mfma_f32_16x16x32_bf16 v[148:151], a[8:11], v[88:91], v[148:151]
    ds_read_b64_tr_b16 a[4:5], v42 offset:24576
    ds_read_b64_tr_b16 a[6:7], v42 offset:28672
    v_mfma_f32_16x16x32_bf16 v[148:151], a[12:15], v[92:95], v[148:151]
    v_exp_f32 v181, v181
    v_mfma_f32_16x16x32_bf16 v[152:155], a[8:11], v[104:107], v[152:155]
    v_cvt_pk_bf16_f32 v213, v166, v167
    v_cvt_pk_bf16_f32 v214, v180, v181
    v_mfma_f32_16x16x32_bf16 v[152:155], a[12:15], v[108:111], v[152:155]
    v_mfma_f32_16x16x32_bf16 v[156:159], a[8:11], v[120:123], v[156:159]
    v_exp_f32 v182, v182
    v_mfma_f32_16x16x32_bf16 v[156:159], a[12:15], v[124:127], v[156:159]
    s_waitcnt lgkmcnt(0)
    v_exp_f32 v183, v183
    v_mfma_f32_16x16x32_bf16 a[192:195], a[0:3], v[200:203], a[192:195]
    ds_read_b64_tr_b16 a[8:9], v43 offset:16384
    ds_read_b64_tr_b16 a[10:11], v43 offset:20480
    v_mfma_f32_16x16x32_bf16 a[192:195], a[4:7], v[192:195], a[192:195]
    v_exp_f32 v168, v168
    v_mfma_f32_16x16x32_bf16 a[196:199], a[0:3], v[216:219], a[196:199]
    ds_read_b64_tr_b16 a[12:13], v43 offset:24576
    ds_read_b64_tr_b16 a[14:15], v43 offset:28672
    v_mfma_f32_16x16x32_bf16 a[196:199], a[4:7], v[208:211], a[196:199]
    v_exp_f32 v169, v169
    v_mfma_f32_16x16x32_bf16 a[200:203], a[0:3], v[232:235], a[200:203]
    v_cvt_pk_bf16_f32 v215, v182, v183
    v_cvt_pk_bf16_f32 v228, v168, v169
    v_mfma_f32_16x16x32_bf16 a[200:203], a[4:7], v[224:227], a[200:203]
    v_mfma_f32_16x16x32_bf16 a[204:207], a[0:3], v[248:251], a[204:207]
    v_exp_f32 v170, v170
    v_mfma_f32_16x16x32_bf16 a[204:207], a[4:7], v[240:243], a[204:207]
    s_waitcnt lgkmcnt(0)
    v_exp_f32 v171, v171
    v_mfma_f32_16x16x32_bf16 a[208:211], a[8:11], v[200:203], a[208:211]
    ds_read_b64_tr_b16 a[0:1], v44 offset:16384
    ds_read_b64_tr_b16 a[2:3], v44 offset:20480
    v_mfma_f32_16x16x32_bf16 a[208:211], a[12:15], v[192:195], a[208:211]
    v_exp_f32 v184, v184
    v_mfma_f32_16x16x32_bf16 a[212:215], a[8:11], v[216:219], a[212:215]
    ds_read_b64_tr_b16 a[4:5], v44 offset:24576
    ds_read_b64_tr_b16 a[6:7], v44 offset:28672
    v_mfma_f32_16x16x32_bf16 a[212:215], a[12:15], v[208:211], a[212:215]
    v_exp_f32 v185, v185
    v_mfma_f32_16x16x32_bf16 a[216:219], a[8:11], v[232:235], a[216:219]
    v_cvt_pk_bf16_f32 v229, v170, v171
    v_cvt_pk_bf16_f32 v230, v184, v185
    v_mfma_f32_16x16x32_bf16 a[216:219], a[12:15], v[224:227], a[216:219]
    v_mfma_f32_16x16x32_bf16 a[220:223], a[8:11], v[248:251], a[220:223]
    v_exp_f32 v186, v186
    v_mfma_f32_16x16x32_bf16 a[220:223], a[12:15], v[240:243], a[220:223]
    s_waitcnt lgkmcnt(0)
    v_exp_f32 v187, v187
    v_mfma_f32_16x16x32_bf16 a[224:227], a[0:3], v[200:203], a[224:227]
    ds_read_b64_tr_b16 a[8:9], v45 offset:16384
    ds_read_b64_tr_b16 a[10:11], v45 offset:20480
    v_mfma_f32_16x16x32_bf16 a[224:227], a[4:7], v[192:195], a[224:227]
    v_exp_f32 v172, v172
    v_mfma_f32_16x16x32_bf16 a[228:231], a[0:3], v[216:219], a[228:231]
    ds_read_b64_tr_b16 a[12:13], v45 offset:24576
    ds_read_b64_tr_b16 a[14:15], v45 offset:28672
    v_mfma_f32_16x16x32_bf16 a[228:231], a[4:7], v[208:211], a[228:231]
    v_exp_f32 v173, v173
    v_mfma_f32_16x16x32_bf16 a[232:235], a[0:3], v[232:235], a[232:235]
    v_cvt_pk_bf16_f32 v231, v186, v187
    v_cvt_pk_bf16_f32 v244, v172, v173
    v_mfma_f32_16x16x32_bf16 a[232:235], a[4:7], v[224:227], a[232:235]
    buffer_store_dwordx4 v[20:23], v1, s[24:27], s64 offen offset:0 sc1
    v_mfma_f32_16x16x32_bf16 a[236:239], a[0:3], v[248:251], a[236:239]
    v_exp_f32 v174, v174
    v_mfma_f32_16x16x32_bf16 a[236:239], a[4:7], v[240:243], a[236:239]
    s_waitcnt vmcnt(9) lgkmcnt(0)
    v_exp_f32 v175, v175
    v_mfma_f32_16x16x32_bf16 a[240:243], a[8:11], v[200:203], a[240:243]
    s_barrier
    v_mfma_f32_16x16x32_bf16 a[240:243], a[12:15], v[192:195], a[240:243]
    v_exp_f32 v188, v188
    v_mfma_f32_16x16x32_bf16 a[244:247], a[8:11], v[216:219], a[244:247]
    ds_read_b128 a[0:3], v34 offset:32768
    ds_read_b128 a[4:7], v35 offset:32768
    v_mfma_f32_16x16x32_bf16 a[244:247], a[12:15], v[208:211], a[244:247]
    v_exp_f32 v189, v189
    v_mfma_f32_16x16x32_bf16 a[248:251], a[8:11], v[232:235], a[248:251]
    v_cvt_pk_bf16_f32 v245, v174, v175
    v_cvt_pk_bf16_f32 v246, v188, v189
    v_mfma_f32_16x16x32_bf16 a[248:251], a[12:15], v[224:227], a[248:251]
    v_mfma_f32_16x16x32_bf16 a[252:255], a[8:11], v[248:251], a[252:255]
    v_exp_f32 v190, v190
    v_mfma_f32_16x16x32_bf16 a[252:255], a[12:15], v[240:243], a[252:255]
    v_exp_f32 v191, v191
    v_smfmac_f32_16x16x64_bf16 a[108:111], a[112:115], v[192:199], v19
    v_cvt_pk_bf16_f32 v247, v190, v191
    v_smfmac_f32_16x16x64_bf16 a[108:111], a[116:119], v[208:215], v19
    v_smfmac_f32_16x16x64_bf16 a[108:111], a[120:123], v[224:231], v19
    v_smfmac_f32_16x16x64_bf16 a[108:111], a[124:127], v[240:247], v19
    s_waitcnt lgkmcnt(0)
    v_mfma_f32_16x16x32_bf16 v[160:163], a[0:3], v[64:67], v[10:13]
    s_add_u32 m0, s56, 16384
    ds_read_b128 a[8:11], v36 offset:32768
    ds_read_b128 a[12:15], v37 offset:32768
    v_mfma_f32_16x16x32_bf16 v[160:163], a[4:7], v[68:71], v[160:163]
    buffer_load_dwordx4 v46, s[8:11], s54 offen offset:0 lds
    v_mfma_f32_16x16x32_bf16 v[164:167], a[0:3], v[80:83], v[14:17]
    v_exp_f32 v128, v128
    v_mfma_f32_16x16x32_bf16 v[164:167], a[4:7], v[84:87], v[164:167]
    v_exp_f32 v129, v129
    v_mfma_f32_16x16x32_bf16 v[168:171], a[0:3], v[96:99], v[30:33]
    v_cvt_pk_bf16_f32 v200, v128, v129
    v_mfma_f32_16x16x32_bf16 v[168:171], a[4:7], v[100:103], v[168:171]
    buffer_load_dwordx4 v47, s[8:11], s54 offen offset:1024 lds
    v_mfma_f32_16x16x32_bf16 v[172:175], a[0:3], v[112:115], v[60:63]
    v_exp_f32 v130, v130
    v_mfma_f32_16x16x32_bf16 v[172:175], a[4:7], v[116:119], v[172:175]
    s_waitcnt lgkmcnt(0)
    v_exp_f32 v131, v131
    v_mfma_f32_16x16x32_bf16 v[160:163], a[8:11], v[72:75], v[160:163]
    ds_read_b128 a[0:3], v34 offset:36864
    ds_read_b128 a[4:7], v35 offset:36864
    v_mfma_f32_16x16x32_bf16 v[160:163], a[12:15], v[76:79], v[160:163]
    buffer_load_dwordx4 v48, s[8:11], s54 offen offset:2048 lds
    v_mfma_f32_16x16x32_bf16 v[164:167], a[8:11], v[88:91], v[164:167]
    v_exp_f32 v144, v144
    v_mfma_f32_16x16x32_bf16 v[164:167], a[12:15], v[92:95], v[164:167]
    v_exp_f32 v145, v145
    v_mfma_f32_16x16x32_bf16 v[168:171], a[8:11], v[104:107], v[168:171]
    v_cvt_pk_bf16_f32 v201, v130, v131
    v_cvt_pk_bf16_f32 v202, v144, v145
    v_mfma_f32_16x16x32_bf16 v[168:171], a[12:15], v[108:111], v[168:171]
    buffer_load_dwordx4 v49, s[8:11], s54 offen offset:3072 lds
    v_mfma_f32_16x16x32_bf16 v[172:175], a[8:11], v[120:123], v[172:175]
    s_add_u32 s54, s54, 16384
    v_exp_f32 v146, v146
    v_mfma_f32_16x16x32_bf16 v[172:175], a[12:15], v[124:127], v[172:175]
    s_waitcnt lgkmcnt(0)
    v_exp_f32 v147, v147
    v_mfma_f32_16x16x32_bf16 v[176:179], a[0:3], v[64:67], v[10:13]
    ds_read_b128 a[8:11], v36 offset:36864
    ds_read_b128 a[12:15], v37 offset:36864
    v_mfma_f32_16x16x32_bf16 v[176:179], a[4:7], v[68:71], v[176:179]
    ds_read_b128 v[20:23], v18 offset:1024
    v_mfma_f32_16x16x32_bf16 v[180:183], a[0:3], v[80:83], v[14:17]
    s_and_b32 s54, s54, 524287
    v_exp_f32 v132, v132
    v_mfma_f32_16x16x32_bf16 v[180:183], a[4:7], v[84:87], v[180:183]
    v_exp_f32 v133, v133
    v_mfma_f32_16x16x32_bf16 v[184:187], a[0:3], v[96:99], v[30:33]
    v_cvt_pk_bf16_f32 v203, v146, v147
    v_cvt_pk_bf16_f32 v216, v132, v133
    v_mfma_f32_16x16x32_bf16 v[184:187], a[4:7], v[100:103], v[184:187]
    v_mfma_f32_16x16x32_bf16 v[188:191], a[0:3], v[112:115], v[60:63]
    v_exp_f32 v134, v134
    v_mfma_f32_16x16x32_bf16 v[188:191], a[4:7], v[116:119], v[188:191]
    s_waitcnt lgkmcnt(1)
    v_exp_f32 v135, v135
    v_mfma_f32_16x16x32_bf16 v[176:179], a[8:11], v[72:75], v[176:179]
    ds_read_b64_tr_b16 a[0:1], v38 offset:24576
    ds_read_b64_tr_b16 a[2:3], v38 offset:28672
    v_mfma_f32_16x16x32_bf16 v[176:179], a[12:15], v[76:79], v[176:179]
    v_exp_f32 v148, v148
    v_mfma_f32_16x16x32_bf16 v[180:183], a[8:11], v[88:91], v[180:183]
    ds_read_b64_tr_b16 a[4:5], v38 offset:32768
    ds_read_b64_tr_b16 a[6:7], v38 offset:36864
    v_mfma_f32_16x16x32_bf16 v[180:183], a[12:15], v[92:95], v[180:183]
    v_exp_f32 v149, v149
    v_mfma_f32_16x16x32_bf16 v[184:187], a[8:11], v[104:107], v[184:187]
    v_cvt_pk_bf16_f32 v217, v134, v135
    v_cvt_pk_bf16_f32 v218, v148, v149
    v_mfma_f32_16x16x32_bf16 v[184:187], a[12:15], v[108:111], v[184:187]
    v_mfma_f32_16x16x32_bf16 v[188:191], a[8:11], v[120:123], v[188:191]
    v_exp_f32 v150, v150
    v_mfma_f32_16x16x32_bf16 v[188:191], a[12:15], v[124:127], v[188:191]
    s_waitcnt lgkmcnt(0)
    v_exp_f32 v151, v151
    v_mfma_f32_16x16x32_bf16 a[128:131], a[0:3], v[192:195], a[128:131]
    ds_read_b64_tr_b16 a[8:9], v39 offset:24576
    ds_read_b64_tr_b16 a[10:11], v39 offset:28672
    v_mfma_f32_16x16x32_bf16 a[128:131], a[4:7], v[196:199], a[128:131]
    v_exp_f32 v136, v136
    v_mfma_f32_16x16x32_bf16 a[132:135], a[0:3], v[208:211], a[132:135]
    ds_read_b64_tr_b16 a[12:13], v39 offset:32768
    ds_read_b64_tr_b16 a[14:15], v39 offset:36864
    v_mfma_f32_16x16x32_bf16 a[132:135], a[4:7], v[212:215], a[132:135]
    v_exp_f32 v137, v137
    v_mfma_f32_16x16x32_bf16 a[136:139], a[0:3], v[224:227], a[136:139]
    v_cvt_pk_bf16_f32 v219, v150, v151
    v_cvt_pk_bf16_f32 v232, v136, v137
    v_mfma_f32_16x16x32_bf16 a[136:139], a[4:7], v[228:231], a[136:139]
    v_mfma_f32_16x16x32_bf16 a[140:143], a[0:3], v[240:243], a[140:143]
    v_exp_f32 v138, v138
    v_mfma_f32_16x16x32_bf16 a[140:143], a[4:7], v[244:247], a[140:143]
    s_waitcnt lgkmcnt(0)
    v_exp_f32 v139, v139
    v_mfma_f32_16x16x32_bf16 a[144:147], a[8:11], v[192:195], a[144:147]
    ds_read_b64_tr_b16 a[0:1], v40 offset:24576
    ds_read_b64_tr_b16 a[2:3], v40 offset:28672
    v_mfma_f32_16x16x32_bf16 a[144:147], a[12:15], v[196:199], a[144:147]
    v_exp_f32 v152, v152
    v_mfma_f32_16x16x32_bf16 a[148:151], a[8:11], v[208:211], a[148:151]
    ds_read_b64_tr_b16 a[4:5], v40 offset:32768
    ds_read_b64_tr_b16 a[6:7], v40 offset:36864
    v_mfma_f32_16x16x32_bf16 a[148:151], a[12:15], v[212:215], a[148:151]
    v_exp_f32 v153, v153
    v_mfma_f32_16x16x32_bf16 a[152:155], a[8:11], v[224:227], a[152:155]
    v_cvt_pk_bf16_f32 v233, v138, v139
    v_cvt_pk_bf16_f32 v234, v152, v153
    v_mfma_f32_16x16x32_bf16 a[152:155], a[12:15], v[228:231], a[152:155]
    v_mfma_f32_16x16x32_bf16 a[156:159], a[8:11], v[240:243], a[156:159]
    v_exp_f32 v154, v154
    v_mfma_f32_16x16x32_bf16 a[156:159], a[12:15], v[244:247], a[156:159]
    s_waitcnt lgkmcnt(0)
    v_exp_f32 v155, v155
    v_mfma_f32_16x16x32_bf16 a[160:163], a[0:3], v[192:195], a[160:163]
    ds_read_b64_tr_b16 a[8:9], v41 offset:24576
    ds_read_b64_tr_b16 a[10:11], v41 offset:28672
    v_mfma_f32_16x16x32_bf16 a[160:163], a[4:7], v[196:199], a[160:163]
    v_exp_f32 v140, v140
    v_mfma_f32_16x16x32_bf16 a[164:167], a[0:3], v[208:211], a[164:167]
    ds_read_b64_tr_b16 a[12:13], v41 offset:32768
    ds_read_b64_tr_b16 a[14:15], v41 offset:36864
    v_mfma_f32_16x16x32_bf16 a[164:167], a[4:7], v[212:215], a[164:167]
    v_exp_f32 v141, v141
    v_mfma_f32_16x16x32_bf16 a[168:171], a[0:3], v[224:227], a[168:171]
    v_cvt_pk_bf16_f32 v235, v154, v155
    v_cvt_pk_bf16_f32 v248, v140, v141
    v_mfma_f32_16x16x32_bf16 a[168:171], a[4:7], v[228:231], a[168:171]
    v_mfma_f32_16x16x32_bf16 a[172:175], a[0:3], v[240:243], a[172:175]
    v_exp_f32 v142, v142
    v_mfma_f32_16x16x32_bf16 a[172:175], a[4:7], v[244:247], a[172:175]
    s_waitcnt lgkmcnt(0)
    v_exp_f32 v143, v143
    v_mfma_f32_16x16x32_bf16 a[176:179], a[8:11], v[192:195], a[176:179]
    ds_read_b128 a[0:3], v34 offset:40960
    ds_read_b128 a[4:7], v35 offset:40960
    v_mfma_f32_16x16x32_bf16 a[176:179], a[12:15], v[196:199], a[176:179]
    s_barrier
    v_mfma_f32_16x16x32_bf16 a[180:183], a[8:11], v[208:211], a[180:183]
    v_exp_f32 v156, v156
    v_mfma_f32_16x16x32_bf16 a[180:183], a[12:15], v[212:215], a[180:183]
    v_exp_f32 v157, v157
    v_mfma_f32_16x16x32_bf16 a[184:187], a[8:11], v[224:227], a[184:187]
    v_cvt_pk_bf16_f32 v249, v142, v143
    v_cvt_pk_bf16_f32 v250, v156, v157
    v_mfma_f32_16x16x32_bf16 a[184:187], a[12:15], v[228:231], a[184:187]
    v_mfma_f32_16x16x32_bf16 a[188:191], a[8:11], v[240:243], a[188:191]
    v_exp_f32 v158, v158
    v_mfma_f32_16x16x32_bf16 a[188:191], a[12:15], v[244:247], a[188:191]
    s_waitcnt lgkmcnt(0)
    v_exp_f32 v159, v159
    v_mfma_f32_16x16x32_bf16 v[128:131], a[0:3], v[64:67], v[10:13]
    s_add_u32 m0, s57, 16384
    ds_read_b128 a[8:11], v36 offset:40960
    ds_read_b128 a[12:15], v37 offset:40960
    v_mfma_f32_16x16x32_bf16 v[128:131], a[4:7], v[68:71], v[128:131]
    buffer_load_dwordx4 v50, s[12:15], s55 offen offset:0 lds
    v_mfma_f32_16x16x32_bf16 v[132:135], a[0:3], v[80:83], v[14:17]
    v_exp_f32 v160, v160
    v_mfma_f32_16x16x32_bf16 v[132:135], a[4:7], v[84:87], v[132:135]
    v_exp_f32 v161, v161
    v_mfma_f32_16x16x32_bf16 v[136:139], a[0:3], v[96:99], v[30:33]
    v_cvt_pk_bf16_f32 v251, v158, v159
    v_cvt_pk_bf16_f32 v204, v160, v161
    v_mfma_f32_16x16x32_bf16 v[136:139], a[4:7], v[100:103], v[136:139]
    buffer_load_dwordx4 v51, s[12:15], s55 offen offset:1024 lds
    v_mfma_f32_16x16x32_bf16 v[140:143], a[0:3], v[112:115], v[60:63]
    v_exp_f32 v162, v162
    v_mfma_f32_16x16x32_bf16 v[140:143], a[4:7], v[116:119], v[140:143]
    s_waitcnt lgkmcnt(0)
    v_exp_f32 v163, v163
    v_mfma_f32_16x16x32_bf16 v[128:131], a[8:11], v[72:75], v[128:131]
    ds_read_b128 a[0:3], v34 offset:45056
    ds_read_b128 a[4:7], v35 offset:45056
    v_mfma_f32_16x16x32_bf16 v[128:131], a[12:15], v[76:79], v[128:131]
    buffer_load_dwordx4 v50, s[12:15], s55 offen offset:2048 lds
    v_mfma_f32_16x16x32_bf16 v[132:135], a[8:11], v[88:91], v[132:135]
    v_exp_f32 v176, v176
    v_mfma_f32_16x16x32_bf16 v[132:135], a[12:15], v[92:95], v[132:135]
    v_exp_f32 v177, v177
    v_mfma_f32_16x16x32_bf16 v[136:139], a[8:11], v[104:107], v[136:139]
    v_cvt_pk_bf16_f32 v205, v162, v163
    v_cvt_pk_bf16_f32 v206, v176, v177
    v_mfma_f32_16x16x32_bf16 v[136:139], a[12:15], v[108:111], v[136:139]
    buffer_load_dwordx4 v51, s[12:15], s55 offen offset:3072 lds
    v_mfma_f32_16x16x32_bf16 v[140:143], a[8:11], v[120:123], v[140:143]
    s_add_u32 s55, s55, 16384
    v_exp_f32 v178, v178
    v_mfma_f32_16x16x32_bf16 v[140:143], a[12:15], v[124:127], v[140:143]
    s_waitcnt lgkmcnt(0)
    v_exp_f32 v179, v179
    v_mfma_f32_16x16x32_bf16 v[144:147], a[0:3], v[64:67], v[10:13]
    ds_read_b128 a[8:11], v36 offset:45056
    ds_read_b128 a[12:15], v37 offset:45056
    v_mfma_f32_16x16x32_bf16 v[144:147], a[4:7], v[68:71], v[144:147]
    v_mfma_f32_16x16x32_bf16 v[148:151], a[0:3], v[80:83], v[14:17]
    s_and_b32 s55, s55, 524287
    v_exp_f32 v164, v164
    v_mfma_f32_16x16x32_bf16 v[148:151], a[4:7], v[84:87], v[148:151]
    v_exp_f32 v165, v165
    v_mfma_f32_16x16x32_bf16 v[152:155], a[0:3], v[96:99], v[30:33]
    v_cvt_pk_bf16_f32 v207, v178, v179
    v_cvt_pk_bf16_f32 v220, v164, v165
    v_mfma_f32_16x16x32_bf16 v[152:155], a[4:7], v[100:103], v[152:155]
    v_mfma_f32_16x16x32_bf16 v[156:159], a[0:3], v[112:115], v[60:63]
    v_exp_f32 v166, v166
    v_mfma_f32_16x16x32_bf16 v[156:159], a[4:7], v[116:119], v[156:159]
    s_waitcnt lgkmcnt(0)
    v_exp_f32 v167, v167
    v_mfma_f32_16x16x32_bf16 v[144:147], a[8:11], v[72:75], v[144:147]
    ds_read_b64_tr_b16 a[0:1], v42 offset:32768
    ds_read_b64_tr_b16 a[2:3], v42 offset:36864
    v_mfma_f32_16x16x32_bf16 v[144:147], a[12:15], v[76:79], v[144:147]
    v_exp_f32 v180, v180
    v_mfma_f32_16x16x32_bf16 v[148:151], a[8:11], v[88:91], v[148:151]
    ds_read_b64_tr_b16 a[4:5], v42 offset:40960
    ds_read_b64_tr_b16 a[6:7], v42 offset:45056
    v_mfma_f32_16x16x32_bf16 v[148:151], a[12:15], v[92:95], v[148:151]
    v_exp_f32 v181, v181
    v_mfma_f32_16x16x32_bf16 v[152:155], a[8:11], v[104:107], v[152:155]
    v_cvt_pk_bf16_f32 v221, v166, v167
    v_cvt_pk_bf16_f32 v222, v180, v181
    v_mfma_f32_16x16x32_bf16 v[152:155], a[12:15], v[108:111], v[152:155]
    v_mfma_f32_16x16x32_bf16 v[156:159], a[8:11], v[120:123], v[156:159]
    v_exp_f32 v182, v182
    v_mfma_f32_16x16x32_bf16 v[156:159], a[12:15], v[124:127], v[156:159]
    s_waitcnt lgkmcnt(0)
    v_exp_f32 v183, v183
    v_mfma_f32_16x16x32_bf16 a[192:195], a[0:3], v[196:199], a[192:195]
    ds_read_b64_tr_b16 a[8:9], v43 offset:32768
    ds_read_b64_tr_b16 a[10:11], v43 offset:36864
    v_mfma_f32_16x16x32_bf16 a[192:195], a[4:7], v[200:203], a[192:195]
    v_exp_f32 v168, v168
    v_mfma_f32_16x16x32_bf16 a[196:199], a[0:3], v[212:215], a[196:199]
    ds_read_b64_tr_b16 a[12:13], v43 offset:40960
    ds_read_b64_tr_b16 a[14:15], v43 offset:45056
    v_mfma_f32_16x16x32_bf16 a[196:199], a[4:7], v[216:219], a[196:199]
    v_exp_f32 v169, v169
    v_mfma_f32_16x16x32_bf16 a[200:203], a[0:3], v[228:231], a[200:203]
    v_cvt_pk_bf16_f32 v223, v182, v183
    v_cvt_pk_bf16_f32 v236, v168, v169
    v_mfma_f32_16x16x32_bf16 a[200:203], a[4:7], v[232:235], a[200:203]
    v_mfma_f32_16x16x32_bf16 a[204:207], a[0:3], v[244:247], a[204:207]
    v_exp_f32 v170, v170
    v_mfma_f32_16x16x32_bf16 a[204:207], a[4:7], v[248:251], a[204:207]
    s_waitcnt lgkmcnt(0)
    v_exp_f32 v171, v171
    v_mfma_f32_16x16x32_bf16 a[208:211], a[8:11], v[196:199], a[208:211]
    ds_read_b64_tr_b16 a[0:1], v44 offset:32768
    ds_read_b64_tr_b16 a[2:3], v44 offset:36864
    v_mfma_f32_16x16x32_bf16 a[208:211], a[12:15], v[200:203], a[208:211]
    v_exp_f32 v184, v184
    v_mfma_f32_16x16x32_bf16 a[212:215], a[8:11], v[212:215], a[212:215]
    ds_read_b64_tr_b16 a[4:5], v44 offset:40960
    ds_read_b64_tr_b16 a[6:7], v44 offset:45056
    v_mfma_f32_16x16x32_bf16 a[212:215], a[12:15], v[216:219], a[212:215]
    v_exp_f32 v185, v185
    v_mfma_f32_16x16x32_bf16 a[216:219], a[8:11], v[228:231], a[216:219]
    v_cvt_pk_bf16_f32 v237, v170, v171
    v_cvt_pk_bf16_f32 v238, v184, v185
    v_mfma_f32_16x16x32_bf16 a[216:219], a[12:15], v[232:235], a[216:219]
    v_mfma_f32_16x16x32_bf16 a[220:223], a[8:11], v[244:247], a[220:223]
    v_exp_f32 v186, v186
    v_mfma_f32_16x16x32_bf16 a[220:223], a[12:15], v[248:251], a[220:223]
    s_waitcnt lgkmcnt(0)
    v_exp_f32 v187, v187
    v_mfma_f32_16x16x32_bf16 a[224:227], a[0:3], v[196:199], a[224:227]
    ds_read_b64_tr_b16 a[8:9], v45 offset:32768
    ds_read_b64_tr_b16 a[10:11], v45 offset:36864
    v_mfma_f32_16x16x32_bf16 a[224:227], a[4:7], v[200:203], a[224:227]
    v_exp_f32 v172, v172
    v_mfma_f32_16x16x32_bf16 a[228:231], a[0:3], v[212:215], a[228:231]
    ds_read_b64_tr_b16 a[12:13], v45 offset:40960
    ds_read_b64_tr_b16 a[14:15], v45 offset:45056
    v_mfma_f32_16x16x32_bf16 a[228:231], a[4:7], v[216:219], a[228:231]
    v_exp_f32 v173, v173
    v_mfma_f32_16x16x32_bf16 a[232:235], a[0:3], v[228:231], a[232:235]
    v_cvt_pk_bf16_f32 v239, v186, v187
    v_cvt_pk_bf16_f32 v252, v172, v173
    v_mfma_f32_16x16x32_bf16 a[232:235], a[4:7], v[232:235], a[232:235]
    buffer_store_dwordx4 v[20:23], v1, s[24:27], s64 offen offset:1024 sc1
    v_mfma_f32_16x16x32_bf16 a[236:239], a[0:3], v[244:247], a[236:239]
    v_exp_f32 v174, v174
    v_mfma_f32_16x16x32_bf16 a[236:239], a[4:7], v[248:251], a[236:239]
    s_waitcnt vmcnt(10) lgkmcnt(0)
    v_exp_f32 v175, v175
    v_mfma_f32_16x16x32_bf16 a[240:243], a[8:11], v[196:199], a[240:243]
    s_barrier
    v_mfma_f32_16x16x32_bf16 a[240:243], a[12:15], v[200:203], a[240:243]
    v_exp_f32 v188, v188
    v_mfma_f32_16x16x32_bf16 a[244:247], a[8:11], v[212:215], a[244:247]
    ds_read_b128 a[0:3], v34 offset:0
    ds_read_b128 a[4:7], v35 offset:0
    v_mfma_f32_16x16x32_bf16 a[244:247], a[12:15], v[216:219], a[244:247]
    v_exp_f32 v189, v189
    v_mfma_f32_16x16x32_bf16 a[248:251], a[8:11], v[228:231], a[248:251]
    v_cvt_pk_bf16_f32 v253, v174, v175
    v_cvt_pk_bf16_f32 v254, v188, v189
    v_mfma_f32_16x16x32_bf16 a[248:251], a[12:15], v[232:235], a[248:251]
    s_add_u32 s64, s64, 2048
    v_mfma_f32_16x16x32_bf16 a[252:255], a[8:11], v[244:247], a[252:255]
    v_exp_f32 v190, v190
    v_mfma_f32_16x16x32_bf16 a[252:255], a[12:15], v[248:251], a[252:255]
    v_exp_f32 v191, v191
    v_smfmac_f32_16x16x64_bf16 a[108:111], a[112:115], v[200:207], v19
    v_cvt_pk_bf16_f32 v255, v190, v191
    v_smfmac_f32_16x16x64_bf16 a[108:111], a[116:119], v[216:223], v19
    v_smfmac_f32_16x16x64_bf16 a[108:111], a[120:123], v[232:239], v19
    v_smfmac_f32_16x16x64_bf16 a[108:111], a[124:127], v[248:255], v19
    s_waitcnt lgkmcnt(0)
    v_mfma_f32_16x16x32_bf16 v[160:163], a[0:3], v[64:67], v[10:13]
    s_add_u32 m0, s56, 32768
    ds_read_b128 a[8:11], v36 offset:0
    ds_read_b128 a[12:15], v37 offset:0
    v_mfma_f32_16x16x32_bf16 v[160:163], a[4:7], v[68:71], v[160:163]
    buffer_load_dwordx4 v46, s[8:11], s54 offen offset:0 lds
    v_mfma_f32_16x16x32_bf16 v[164:167], a[0:3], v[80:83], v[14:17]
    v_exp_f32 v128, v128
    v_mfma_f32_16x16x32_bf16 v[164:167], a[4:7], v[84:87], v[164:167]
    v_exp_f32 v129, v129
    v_mfma_f32_16x16x32_bf16 v[168:171], a[0:3], v[96:99], v[30:33]
    v_cvt_pk_bf16_f32 v196, v128, v129
    v_mfma_f32_16x16x32_bf16 v[168:171], a[4:7], v[100:103], v[168:171]
    buffer_load_dwordx4 v47, s[8:11], s54 offen offset:1024 lds
    v_mfma_f32_16x16x32_bf16 v[172:175], a[0:3], v[112:115], v[60:63]
    v_exp_f32 v130, v130
    v_mfma_f32_16x16x32_bf16 v[172:175], a[4:7], v[116:119], v[172:175]
    s_waitcnt lgkmcnt(0)
    v_exp_f32 v131, v131
    v_mfma_f32_16x16x32_bf16 v[160:163], a[8:11], v[72:75], v[160:163]
    ds_read_b128 a[0:3], v34 offset:4096
    ds_read_b128 a[4:7], v35 offset:4096
    v_mfma_f32_16x16x32_bf16 v[160:163], a[12:15], v[76:79], v[160:163]
    buffer_load_dwordx4 v48, s[8:11], s54 offen offset:2048 lds
    v_mfma_f32_16x16x32_bf16 v[164:167], a[8:11], v[88:91], v[164:167]
    v_exp_f32 v144, v144
    v_mfma_f32_16x16x32_bf16 v[164:167], a[12:15], v[92:95], v[164:167]
    v_exp_f32 v145, v145
    v_mfma_f32_16x16x32_bf16 v[168:171], a[8:11], v[104:107], v[168:171]
    v_cvt_pk_bf16_f32 v197, v130, v131
    v_cvt_pk_bf16_f32 v198, v144, v145
    v_mfma_f32_16x16x32_bf16 v[168:171], a[12:15], v[108:111], v[168:171]
    buffer_load_dwordx4 v49, s[8:11], s54 offen offset:3072 lds
    v_mfma_f32_16x16x32_bf16 v[172:175], a[8:11], v[120:123], v[172:175]
    s_add_u32 s54, s54, 16384
    v_exp_f32 v146, v146
    v_mfma_f32_16x16x32_bf16 v[172:175], a[12:15], v[124:127], v[172:175]
    s_waitcnt lgkmcnt(0)
    v_exp_f32 v147, v147
    v_mfma_f32_16x16x32_bf16 v[176:179], a[0:3], v[64:67], v[10:13]
    ds_read_b128 a[8:11], v36 offset:4096
    ds_read_b128 a[12:15], v37 offset:4096
    v_mfma_f32_16x16x32_bf16 v[176:179], a[4:7], v[68:71], v[176:179]
    v_add_u32 v18, 8192, v18
    v_mfma_f32_16x16x32_bf16 v[180:183], a[0:3], v[80:83], v[14:17]
    s_and_b32 s54, s54, 524287
    v_exp_f32 v132, v132
    v_mfma_f32_16x16x32_bf16 v[180:183], a[4:7], v[84:87], v[180:183]
    v_exp_f32 v133, v133
    v_mfma_f32_16x16x32_bf16 v[184:187], a[0:3], v[96:99], v[30:33]
    v_cvt_pk_bf16_f32 v199, v146, v147
    v_cvt_pk_bf16_f32 v212, v132, v133
    v_mfma_f32_16x16x32_bf16 v[184:187], a[4:7], v[100:103], v[184:187]
    v_mfma_f32_16x16x32_bf16 v[188:191], a[0:3], v[112:115], v[60:63]
    v_exp_f32 v134, v134
    v_mfma_f32_16x16x32_bf16 v[188:191], a[4:7], v[116:119], v[188:191]
    s_waitcnt lgkmcnt(0)
    v_exp_f32 v135, v135
    v_mfma_f32_16x16x32_bf16 v[176:179], a[8:11], v[72:75], v[176:179]
    ds_read_b64_tr_b16 a[0:1], v38 offset:40960
    ds_read_b64_tr_b16 a[2:3], v38 offset:45056
    v_mfma_f32_16x16x32_bf16 v[176:179], a[12:15], v[76:79], v[176:179]
    v_exp_f32 v148, v148
    v_mfma_f32_16x16x32_bf16 v[180:183], a[8:11], v[88:91], v[180:183]
    ds_read_b64_tr_b16 a[4:5], v38 offset:0
    ds_read_b64_tr_b16 a[6:7], v38 offset:4096
    v_mfma_f32_16x16x32_bf16 v[180:183], a[12:15], v[92:95], v[180:183]
    v_exp_f32 v149, v149
    v_mfma_f32_16x16x32_bf16 v[184:187], a[8:11], v[104:107], v[184:187]
    v_cvt_pk_bf16_f32 v213, v134, v135
    v_cvt_pk_bf16_f32 v214, v148, v149
    v_mfma_f32_16x16x32_bf16 v[184:187], a[12:15], v[108:111], v[184:187]
    v_mfma_f32_16x16x32_bf16 v[188:191], a[8:11], v[120:123], v[188:191]
    v_exp_f32 v150, v150
    v_mfma_f32_16x16x32_bf16 v[188:191], a[12:15], v[124:127], v[188:191]
    s_waitcnt lgkmcnt(0)
    v_exp_f32 v151, v151
    v_mfma_f32_16x16x32_bf16 a[128:131], a[0:3], v[200:203], a[128:131]
    ds_read_b64_tr_b16 a[8:9], v39 offset:40960
    ds_read_b64_tr_b16 a[10:11], v39 offset:45056
    v_mfma_f32_16x16x32_bf16 a[128:131], a[4:7], v[204:207], a[128:131]
    v_exp_f32 v136, v136
    v_mfma_f32_16x16x32_bf16 a[132:135], a[0:3], v[216:219], a[132:135]
    ds_read_b64_tr_b16 a[12:13], v39 offset:0
    ds_read_b64_tr_b16 a[14:15], v39 offset:4096
    v_mfma_f32_16x16x32_bf16 a[132:135], a[4:7], v[220:223], a[132:135]
    v_exp_f32 v137, v137
    v_mfma_f32_16x16x32_bf16 a[136:139], a[0:3], v[232:235], a[136:139]
    v_cvt_pk_bf16_f32 v215, v150, v151
    v_cvt_pk_bf16_f32 v228, v136, v137
    v_mfma_f32_16x16x32_bf16 a[136:139], a[4:7], v[236:239], a[136:139]
    v_mfma_f32_16x16x32_bf16 a[140:143], a[0:3], v[248:251], a[140:143]
    v_exp_f32 v138, v138
    v_mfma_f32_16x16x32_bf16 a[140:143], a[4:7], v[252:255], a[140:143]
    s_waitcnt lgkmcnt(0)
    v_exp_f32 v139, v139
    v_mfma_f32_16x16x32_bf16 a[144:147], a[8:11], v[200:203], a[144:147]
    ds_read_b64_tr_b16 a[0:1], v40 offset:40960
    ds_read_b64_tr_b16 a[2:3], v40 offset:45056
    v_mfma_f32_16x16x32_bf16 a[144:147], a[12:15], v[204:207], a[144:147]
    v_exp_f32 v152, v152
    v_mfma_f32_16x16x32_bf16 a[148:151], a[8:11], v[216:219], a[148:151]
    ds_read_b64_tr_b16 a[4:5], v40 offset:0
    ds_read_b64_tr_b16 a[6:7], v40 offset:4096
    v_mfma_f32_16x16x32_bf16 a[148:151], a[12:15], v[220:223], a[148:151]
    v_exp_f32 v153, v153
    v_mfma_f32_16x16x32_bf16 a[152:155], a[8:11], v[232:235], a[152:155]
    v_cvt_pk_bf16_f32 v229, v138, v139
    v_cvt_pk_bf16_f32 v230, v152, v153
    v_mfma_f32_16x16x32_bf16 a[152:155], a[12:15], v[236:239], a[152:155]
    v_mfma_f32_16x16x32_bf16 a[156:159], a[8:11], v[248:251], a[156:159]
    v_exp_f32 v154, v154
    v_mfma_f32_16x16x32_bf16 a[156:159], a[12:15], v[252:255], a[156:159]
    s_waitcnt lgkmcnt(0)
    v_exp_f32 v155, v155
    v_mfma_f32_16x16x32_bf16 a[160:163], a[0:3], v[200:203], a[160:163]
    ds_read_b64_tr_b16 a[8:9], v41 offset:40960
    ds_read_b64_tr_b16 a[10:11], v41 offset:45056
    v_mfma_f32_16x16x32_bf16 a[160:163], a[4:7], v[204:207], a[160:163]
    v_exp_f32 v140, v140
    v_mfma_f32_16x16x32_bf16 a[164:167], a[0:3], v[216:219], a[164:167]
    ds_read_b64_tr_b16 a[12:13], v41 offset:0
    ds_read_b64_tr_b16 a[14:15], v41 offset:4096
    v_mfma_f32_16x16x32_bf16 a[164:167], a[4:7], v[220:223], a[164:167]
    v_exp_f32 v141, v141
    v_mfma_f32_16x16x32_bf16 a[168:171], a[0:3], v[232:235], a[168:171]
    v_cvt_pk_bf16_f32 v231, v154, v155
    v_cvt_pk_bf16_f32 v244, v140, v141
    v_mfma_f32_16x16x32_bf16 a[168:171], a[4:7], v[236:239], a[168:171]
    v_mfma_f32_16x16x32_bf16 a[172:175], a[0:3], v[248:251], a[172:175]
    v_exp_f32 v142, v142
    v_mfma_f32_16x16x32_bf16 a[172:175], a[4:7], v[252:255], a[172:175]
    s_waitcnt lgkmcnt(0)
    v_exp_f32 v143, v143
    v_mfma_f32_16x16x32_bf16 a[176:179], a[8:11], v[200:203], a[176:179]
    ds_read_b128 a[0:3], v34 offset:8192
    ds_read_b128 a[4:7], v35 offset:8192
    v_mfma_f32_16x16x32_bf16 a[176:179], a[12:15], v[204:207], a[176:179]
    s_barrier
    v_mfma_f32_16x16x32_bf16 a[180:183], a[8:11], v[216:219], a[180:183]
    v_exp_f32 v156, v156
    v_mfma_f32_16x16x32_bf16 a[180:183], a[12:15], v[220:223], a[180:183]
    v_exp_f32 v157, v157
    v_mfma_f32_16x16x32_bf16 a[184:187], a[8:11], v[232:235], a[184:187]
    v_cvt_pk_bf16_f32 v245, v142, v143
    v_cvt_pk_bf16_f32 v246, v156, v157
    v_mfma_f32_16x16x32_bf16 a[184:187], a[12:15], v[236:239], a[184:187]
    v_mfma_f32_16x16x32_bf16 a[188:191], a[8:11], v[248:251], a[188:191]
    v_exp_f32 v158, v158
    v_mfma_f32_16x16x32_bf16 a[188:191], a[12:15], v[252:255], a[188:191]
    s_waitcnt lgkmcnt(0)
    v_exp_f32 v159, v159
    v_mfma_f32_16x16x32_bf16 v[128:131], a[0:3], v[64:67], v[10:13]
    s_add_u32 m0, s57, 32768
    ds_read_b128 a[8:11], v36 offset:8192
    ds_read_b128 a[12:15], v37 offset:8192
    v_mfma_f32_16x16x32_bf16 v[128:131], a[4:7], v[68:71], v[128:131]
    buffer_load_dwordx4 v50, s[12:15], s55 offen offset:0 lds
    v_mfma_f32_16x16x32_bf16 v[132:135], a[0:3], v[80:83], v[14:17]
    v_exp_f32 v160, v160
    v_mfma_f32_16x16x32_bf16 v[132:135], a[4:7], v[84:87], v[132:135]
    v_exp_f32 v161, v161
    v_mfma_f32_16x16x32_bf16 v[136:139], a[0:3], v[96:99], v[30:33]
    v_cvt_pk_bf16_f32 v247, v158, v159
    v_cvt_pk_bf16_f32 v200, v160, v161
    v_mfma_f32_16x16x32_bf16 v[136:139], a[4:7], v[100:103], v[136:139]
    buffer_load_dwordx4 v51, s[12:15], s55 offen offset:1024 lds
    v_mfma_f32_16x16x32_bf16 v[140:143], a[0:3], v[112:115], v[60:63]
    v_exp_f32 v162, v162
    v_mfma_f32_16x16x32_bf16 v[140:143], a[4:7], v[116:119], v[140:143]
    s_waitcnt lgkmcnt(0)
    v_exp_f32 v163, v163
    v_mfma_f32_16x16x32_bf16 v[128:131], a[8:11], v[72:75], v[128:131]
    ds_read_b128 a[0:3], v34 offset:12288
    ds_read_b128 a[4:7], v35 offset:12288
    v_mfma_f32_16x16x32_bf16 v[128:131], a[12:15], v[76:79], v[128:131]
    buffer_load_dwordx4 v50, s[12:15], s55 offen offset:2048 lds
    v_mfma_f32_16x16x32_bf16 v[132:135], a[8:11], v[88:91], v[132:135]
    v_exp_f32 v176, v176
    v_mfma_f32_16x16x32_bf16 v[132:135], a[12:15], v[92:95], v[132:135]
    v_exp_f32 v177, v177
    v_mfma_f32_16x16x32_bf16 v[136:139], a[8:11], v[104:107], v[136:139]
    v_cvt_pk_bf16_f32 v201, v162, v163
    v_cvt_pk_bf16_f32 v202, v176, v177
    v_mfma_f32_16x16x32_bf16 v[136:139], a[12:15], v[108:111], v[136:139]
    buffer_load_dwordx4 v51, s[12:15], s55 offen offset:3072 lds
    v_mfma_f32_16x16x32_bf16 v[140:143], a[8:11], v[120:123], v[140:143]
    s_add_u32 s55, s55, 16384
    v_exp_f32 v178, v178
    v_mfma_f32_16x16x32_bf16 v[140:143], a[12:15], v[124:127], v[140:143]
    s_waitcnt lgkmcnt(0)
    v_exp_f32 v179, v179
    v_mfma_f32_16x16x32_bf16 v[144:147], a[0:3], v[64:67], v[10:13]
    ds_read_b128 a[8:11], v36 offset:12288
    ds_read_b128 a[12:15], v37 offset:12288
    v_mfma_f32_16x16x32_bf16 v[144:147], a[4:7], v[68:71], v[144:147]
    v_mfma_f32_16x16x32_bf16 v[148:151], a[0:3], v[80:83], v[14:17]
    s_and_b32 s55, s55, 524287
    v_exp_f32 v164, v164
    v_mfma_f32_16x16x32_bf16 v[148:151], a[4:7], v[84:87], v[148:151]
    v_exp_f32 v165, v165
    v_mfma_f32_16x16x32_bf16 v[152:155], a[0:3], v[96:99], v[30:33]
    v_cvt_pk_bf16_f32 v203, v178, v179
    v_cvt_pk_bf16_f32 v216, v164, v165
    v_mfma_f32_16x16x32_bf16 v[152:155], a[4:7], v[100:103], v[152:155]
    v_mfma_f32_16x16x32_bf16 v[156:159], a[0:3], v[112:115], v[60:63]
    v_exp_f32 v166, v166
    v_mfma_f32_16x16x32_bf16 v[156:159], a[4:7], v[116:119], v[156:159]
    s_waitcnt lgkmcnt(0)
    v_exp_f32 v167, v167
    v_mfma_f32_16x16x32_bf16 v[144:147], a[8:11], v[72:75], v[144:147]
    ds_read_b64_tr_b16 a[0:1], v42 offset:0
    ds_read_b64_tr_b16 a[2:3], v42 offset:4096
    v_mfma_f32_16x16x32_bf16 v[144:147], a[12:15], v[76:79], v[144:147]
    v_exp_f32 v180, v180
    v_mfma_f32_16x16x32_bf16 v[148:151], a[8:11], v[88:91], v[148:151]
    ds_read_b64_tr_b16 a[4:5], v42 offset:8192
    ds_read_b64_tr_b16 a[6:7], v42 offset:12288
    v_mfma_f32_16x16x32_bf16 v[148:151], a[12:15], v[92:95], v[148:151]
    v_exp_f32 v181, v181
    v_mfma_f32_16x16x32_bf16 v[152:155], a[8:11], v[104:107], v[152:155]
    v_cvt_pk_bf16_f32 v217, v166, v167
    v_cvt_pk_bf16_f32 v218, v180, v181
    v_mfma_f32_16x16x32_bf16 v[152:155], a[12:15], v[108:111], v[152:155]
    s_cmp_eq_u32 s58, 8
    s_cbranch_scc1 L_hook
L_dback:
    v_mfma_f32_16x16x32_bf16 v[156:159], a[8:11], v[120:123], v[156:159]
    v_exp_f32 v182, v182
    v_mfma_f32_16x16x32_bf16 v[156:159], a[12:15], v[124:127], v[156:159]
    s_waitcnt lgkmcnt(0)
    v_exp_f32 v183, v183
    v_mfma_f32_16x16x32_bf16 a[192:195], a[0:3], v[204:207], a[192:195]
    ds_read_b64_tr_b16 a[8:9], v43 offset:0
    ds_read_b64_tr_b16 a[10:11], v43 offset:4096
    v_mfma_f32_16x16x32_bf16 a[192:195], a[4:7], v[196:199], a[192:195]
    v_exp_f32 v168, v168
    v_mfma_f32_16x16x32_bf16 a[196:199], a[0:3], v[220:223], a[196:199]
    ds_read_b64_tr_b16 a[12:13], v43 offset:8192
    ds_read_b64_tr_b16 a[14:15], v43 offset:12288
    v_mfma_f32_16x16x32_bf16 a[196:199], a[4:7], v[212:215], a[196:199]
    v_exp_f32 v169, v169
    v_mfma_f32_16x16x32_bf16 a[200:203], a[0:3], v[236:239], a[200:203]
    v_cvt_pk_bf16_f32 v219, v182, v183
    v_cvt_pk_bf16_f32 v232, v168, v169
    v_mfma_f32_16x16x32_bf16 a[200:203], a[4:7], v[228:231], a[200:203]
    v_mfma_f32_16x16x32_bf16 a[204:207], a[0:3], v[252:255], a[204:207]
    v_exp_f32 v170, v170
    v_mfma_f32_16x16x32_bf16 a[204:207], a[4:7], v[244:247], a[204:207]
    s_waitcnt lgkmcnt(0)
    v_exp_f32 v171, v171
    v_mfma_f32_16x16x32_bf16 a[208:211], a[8:11], v[204:207], a[208:211]
    ds_read_b64_tr_b16 a[0:1], v44 offset:0
    ds_read_b64_tr_b16 a[2:3], v44 offset:4096
    v_mfma_f32_16x16x32_bf16 a[208:211], a[12:15], v[196:199], a[208:211]
    v_exp_f32 v184, v184
    v_mfma_f32_16x16x32_bf16 a[212:215], a[8:11], v[220:223], a[212:215]
    ds_read_b64_tr_b16 a[4:5], v44 offset:8192
    ds_read_b64_tr_b16 a[6:7], v44 offset:12288
    v_mfma_f32_16x16x32_bf16 a[212:215], a[12:15], v[212:215], a[212:215]
    v_exp_f32 v185, v185
    v_mfma_f32_16x16x32_bf16 a[216:219], a[8:11], v[236:239], a[216:219]
    v_cvt_pk_bf16_f32 v233, v170, v171
    v_cvt_pk_bf16_f32 v234, v184, v185
    v_mfma_f32_16x16x32_bf16 a[216:219], a[12:15], v[228:231], a[216:219]
    v_mfma_f32_16x16x32_bf16 a[220:223], a[8:11], v[252:255], a[220:223]
    v_exp_f32 v186, v186
    v_mfma_f32_16x16x32_bf16 a[220:223], a[12:15], v[244:247], a[220:223]
    s_waitcnt lgkmcnt(0)
    v_exp_f32 v187, v187
    v_mfma_f32_16x16x32_bf16 a[224:227], a[0:3], v[204:207], a[224:227]
    ds_read_b64_tr_b16 a[8:9], v45 offset:0
    ds_read_b64_tr_b16 a[10:11], v45 offset:4096
    v_mfma_f32_16x16x32_bf16 a[224:227], a[4:7], v[196:199], a[224:227]
    v_exp_f32 v172, v172
    v_mfma_f32_16x16x32_bf16 a[228:231], a[0:3], v[220:223], a[228:231]
    ds_read_b64_tr_b16 a[12:13], v45 offset:8192
    ds_read_b64_tr_b16 a[14:15], v45 offset:12288
    v_mfma_f32_16x16x32_bf16 a[228:231], a[4:7], v[212:215], a[228:231]
    v_exp_f32 v173, v173
    v_mfma_f32_16x16x32_bf16 a[232:235], a[0:3], v[236:239], a[232:235]
    v_cvt_pk_bf16_f32 v235, v186, v187
    v_cvt_pk_bf16_f32 v248, v172, v173
    v_mfma_f32_16x16x32_bf16 a[232:235], a[4:7], v[228:231], a[232:235]
    v_mfma_f32_16x16x32_bf16 a[236:239], a[0:3], v[252:255], a[236:239]
    v_exp_f32 v174, v174
    v_mfma_f32_16x16x32_bf16 a[236:239], a[4:7], v[244:247], a[236:239]
    s_waitcnt vmcnt(9) lgkmcnt(0)
    v_exp_f32 v175, v175
    v_mfma_f32_16x16x32_bf16 a[240:243], a[8:11], v[204:207], a[240:243]
    s_barrier
    v_mfma_f32_16x16x32_bf16 a[240:243], a[12:15], v[196:199], a[240:243]
    v_exp_f32 v188, v188
    v_mfma_f32_16x16x32_bf16 a[244:247], a[8:11], v[220:223], a[244:247]
    ds_read_b128 a[0:3], v34 offset:16384
    ds_read_b128 a[4:7], v35 offset:16384
    v_mfma_f32_16x16x32_bf16 a[244:247], a[12:15], v[212:215], a[244:247]
    v_exp_f32 v189, v189
    v_mfma_f32_16x16x32_bf16 a[248:251], a[8:11], v[236:239], a[248:251]
    v_cvt_pk_bf16_f32 v249, v174, v175
    v_cvt_pk_bf16_f32 v250, v188, v189
    v_mfma_f32_16x16x32_bf16 a[248:251], a[12:15], v[228:231], a[248:251]
    v_mfma_f32_16x16x32_bf16 a[252:255], a[8:11], v[252:255], a[252:255]
    v_exp_f32 v190, v190
    v_mfma_f32_16x16x32_bf16 a[252:255], a[12:15], v[244:247], a[252:255]
    v_exp_f32 v191, v191
    v_smfmac_f32_16x16x64_bf16 a[108:111], a[112:115], v[196:203], v19
    v_cvt_pk_bf16_f32 v251, v190, v191
    v_smfmac_f32_16x16x64_bf16 a[108:111], a[116:119], v[212:219], v19
    s_add_u32 s58, s58, 1
    v_smfmac_f32_16x16x64_bf16 a[108:111], a[120:123], v[228:235], v19
    s_cmp_lt_u32 s58, 10
    v_smfmac_f32_16x16x64_bf16 a[108:111], a[124:127], v[244:251], v19
    s_waitcnt lgkmcnt(0)
    s_cbranch_scc1 L_loop
    s_add_u32 s46, s70, 0
    s_cmp_eq_u32 s42, 0
    s_cbranch_scc0 L_noread
    s_lshl_b32 s51, s41, 3
    v_mov_b32 v4, s51
    global_load_dwordx2 v[2:3], v4, s[84:85] sc1
L_noread:
    s_lshl_b32 s51, s41, 2
    s_add_u32 s51, s51, s42
    s_lshl_b32 s51, s51, 3
    s_add_u32 s51, s51, s40
    s_lshl_b32 s51, s51, 11
    s_add_u32 s28, s86, s51
    s_addc_u32 s29, s87, 0
    s_sub_u32 s30, 33554432, s51
    s_mov_b32 s31, 0x20000
    v_mfma_f32_16x16x32_bf16 v[160:163], a[0:3], v[64:67], v[10:13]
    s_add_u32 m0, s92, 0
    ds_read_b128 a[8:11], v36 offset:16384
    ds_read_b128 a[12:15], v37 offset:16384
    v_mfma_f32_16x16x32_bf16 v[160:163], a[4:7], v[68:71], v[160:163]
    buffer_load_dwordx4 v26, s[20:23], s46 offen offset:0 lds
    v_mfma_f32_16x16x32_bf16 v[164:167], a[0:3], v[80:83], v[14:17]
    s_add_u32 s47, s71, 0
    v_exp_f32 v128, v128
    v_mfma_f32_16x16x32_bf16 v[164:167], a[4:7], v[84:87], v[164:167]
    v_exp_f32 v129, v129
    v_mfma_f32_16x16x32_bf16 v[168:171], a[0:3], v[96:99], v[30:33]
    v_cvt_pk_bf16_f32 v192, v128, v129
    v_mfma_f32_16x16x32_bf16 v[168:171], a[4:7], v[100:103], v[168:171]
    buffer_load_dwordx4 v27, s[20:23], s46 offen offset:1024 lds
    v_mfma_f32_16x16x32_bf16 v[172:175], a[0:3], v[112:115], v[60:63]
    v_exp_f32 v130, v130
    v_mfma_f32_16x16x32_bf16 v[172:175], a[4:7], v[116:119], v[172:175]
    s_waitcnt lgkmcnt(0)
    v_exp_f32 v131, v131
    v_mfma_f32_16x16x32_bf16 v[160:163], a[8:11], v[72:75], v[160:163]
    ds_read_b128 a[0:3], v34 offset:20480
    ds_read_b128 a[4:7], v35 offset:20480
    v_mfma_f32_16x16x32_bf16 v[160:163], a[12:15], v[76:79], v[160:163]
    buffer_load_dwordx4 v28, s[20:23], s46 offen offset:2048 lds
    v_mfma_f32_16x16x32_bf16 v[164:167], a[8:11], v[88:91], v[164:167]
    v_exp_f32 v144, v144
    v_mfma_f32_16x16x32_bf16 v[164:167], a[12:15], v[92:95], v[164:167]
    v_exp_f32 v145, v145
    v_mfma_f32_16x16x32_bf16 v[168:171], a[8:11], v[104:107], v[168:171]
    v_cvt_pk_bf16_f32 v193, v130, v131
    v_cvt_pk_bf16_f32 v194, v144, v145
    v_mfma_f32_16x16x32_bf16 v[168:171], a[12:15], v[108:111], v[168:171]
    buffer_load_dwordx4 v29, s[20:23], s46 offen offset:3072 lds
    v_mfma_f32_16x16x32_bf16 v[172:175], a[8:11], v[120:123], v[172:175]
    v_exp_f32 v146, v146
    v_mfma_f32_16x16x32_bf16 v[172:175], a[12:15], v[124:127], v[172:175]
    s_waitcnt lgkmcnt(0)
    v_exp_f32 v147, v147
    v_mfma_f32_16x16x32_bf16 v[176:179], a[0:3], v[64:67], v[10:13]
    s_add_u32 m0, s92, 4096
    ds_read_b128 a[8:11], v36 offset:20480
    ds_read_b128 a[12:15], v37 offset:20480
    v_mfma_f32_16x16x32_bf16 v[176:179], a[4:7], v[68:71], v[176:179]
    buffer_load_dwordx4 v26, s[20:23], s47 offen offset:0 lds
    v_mfma_f32_16x16x32_bf16 v[180:183], a[0:3], v[80:83], v[14:17]
    s_add_u32 s46, s70, 0
    v_exp_f32 v132, v132
    v_mfma_f32_16x16x32_bf16 v[180:183], a[4:7], v[84:87], v[180:183]
    s_xor_b32 s46, s46, 128
    v_exp_f32 v133, v133
    v_mfma_f32_16x16x32_bf16 v[184:187], a[0:3], v[96:99], v[30:33]
    v_cvt_pk_bf16_f32 v195, v146, v147
    v_cvt_pk_bf16_f32 v208, v132, v133
    v_mfma_f32_16x16x32_bf16 v[184:187], a[4:7], v[100:103], v[184:187]
    buffer_load_dwordx4 v27, s[20:23], s47 offen offset:1024 lds
    v_mfma_f32_16x16x32_bf16 v[188:191], a[0:3], v[112:115], v[60:63]
    v_exp_f32 v134, v134
    v_mfma_f32_16x16x32_bf16 v[188:191], a[4:7], v[116:119], v[188:191]
    s_waitcnt lgkmcnt(0)
    v_exp_f32 v135, v135
    v_mfma_f32_16x16x32_bf16 v[176:179], a[8:11], v[72:75], v[176:179]
    ds_read_b64_tr_b16 a[0:1], v38 offset:8192
    ds_read_b64_tr_b16 a[2:3], v38 offset:12288
    v_mfma_f32_16x16x32_bf16 v[176:179], a[12:15], v[76:79], v[176:179]
    v_exp_f32 v148, v148
    v_mfma_f32_16x16x32_bf16 v[180:183], a[8:11], v[88:91], v[180:183]
    ds_read_b64_tr_b16 a[4:5], v38 offset:16384
    ds_read_b64_tr_b16 a[6:7], v38 offset:20480
    v_mfma_f32_16x16x32_bf16 v[180:183], a[12:15], v[92:95], v[180:183]
    v_exp_f32 v149, v149
    v_mfma_f32_16x16x32_bf16 v[184:187], a[8:11], v[104:107], v[184:187]
    v_cvt_pk_bf16_f32 v209, v134, v135
    v_cvt_pk_bf16_f32 v210, v148, v149
    v_mfma_f32_16x16x32_bf16 v[184:187], a[12:15], v[108:111], v[184:187]
    buffer_load_dwordx4 v28, s[20:23], s47 offen offset:2048 lds
    v_mfma_f32_16x16x32_bf16 v[188:191], a[8:11], v[120:123], v[188:191]
    v_exp_f32 v150, v150
    v_mfma_f32_16x16x32_bf16 v[188:191], a[12:15], v[124:127], v[188:191]
    s_waitcnt lgkmcnt(0)
    v_exp_f32 v151, v151
    v_mfma_f32_16x16x32_bf16 a[128:131], a[0:3], v[196:199], a[128:131]
    ds_read_b64_tr_b16 a[8:9], v39 offset:8192
    ds_read_b64_tr_b16 a[10:11], v39 offset:12288
    v_mfma_f32_16x16x32_bf16 a[128:131], a[4:7], v[200:203], a[128:131]
    v_exp_f32 v136, v136
    v_mfma_f32_16x16x32_bf16 a[132:135], a[0:3], v[212:215], a[132:135]
    ds_read_b64_tr_b16 a[12:13], v39 offset:16384
    ds_read_b64_tr_b16 a[14:15], v39 offset:20480
    v_mfma_f32_16x16x32_bf16 a[132:135], a[4:7], v[216:219], a[132:135]
    v_exp_f32 v137, v137
    v_mfma_f32_16x16x32_bf16 a[136:139], a[0:3], v[228:231], a[136:139]
    v_cvt_pk_bf16_f32 v211, v150, v151
    v_cvt_pk_bf16_f32 v224, v136, v137
    v_mfma_f32_16x16x32_bf16 a[136:139], a[4:7], v[232:235], a[136:139]
    buffer_load_dwordx4 v29, s[20:23], s47 offen offset:3072 lds
    v_mfma_f32_16x16x32_bf16 a[140:143], a[0:3], v[244:247], a[140:143]
    v_exp_f32 v138, v138
    v_mfma_f32_16x16x32_bf16 a[140:143], a[4:7], v[248:251], a[140:143]
    s_waitcnt lgkmcnt(0)
    v_exp_f32 v139, v139
    v_mfma_f32_16x16x32_bf16 a[144:147], a[8:11], v[196:199], a[144:147]
    ds_read_b64_tr_b16 a[0:1], v40 offset:8192
    ds_read_b64_tr_b16 a[2:3], v40 offset:12288
    v_mfma_f32_16x16x32_bf16 a[144:147], a[12:15], v[200:203], a[144:147]
    v_exp_f32 v152, v152
    v_mfma_f32_16x16x32_bf16 a[148:151], a[8:11], v[212:215], a[148:151]
    ds_read_b64_tr_b16 a[4:5], v40 offset:16384
    ds_read_b64_tr_b16 a[6:7], v40 offset:20480
    v_mfma_f32_16x16x32_bf16 a[148:151], a[12:15], v[216:219], a[148:151]
    v_exp_f32 v153, v153
    v_mfma_f32_16x16x32_bf16 a[152:155], a[8:11], v[228:231], a[152:155]
    v_cvt_pk_bf16_f32 v225, v138, v139
    v_cvt_pk_bf16_f32 v226, v152, v153
    v_mfma_f32_16x16x32_bf16 a[152:155], a[12:15], v[232:235], a[152:155]
    v_mfma_f32_16x16x32_bf16 a[156:159], a[8:11], v[244:247], a[156:159]
    v_exp_f32 v154, v154
    v_mfma_f32_16x16x32_bf16 a[156:159], a[12:15], v[248:251], a[156:159]
    s_waitcnt lgkmcnt(0)
    v_exp_f32 v155, v155
    v_mfma_f32_16x16x32_bf16 a[160:163], a[0:3], v[196:199], a[160:163]
    ds_read_b64_tr_b16 a[8:9], v41 offset:8192
    ds_read_b64_tr_b16 a[10:11], v41 offset:12288
    v_mfma_f32_16x16x32_bf16 a[160:163], a[4:7], v[200:203], a[160:163]
    v_exp_f32 v140, v140
    v_mfma_f32_16x16x32_bf16 a[164:167], a[0:3], v[212:215], a[164:167]
    ds_read_b64_tr_b16 a[12:13], v41 offset:16384
    ds_read_b64_tr_b16 a[14:15], v41 offset:20480
    v_mfma_f32_16x16x32_bf16 a[164:167], a[4:7], v[216:219], a[164:167]
    v_exp_f32 v141, v141
    v_mfma_f32_16x16x32_bf16 a[168:171], a[0:3], v[228:231], a[168:171]
    v_cvt_pk_bf16_f32 v227, v154, v155
    v_cvt_pk_bf16_f32 v240, v140, v141
    v_mfma_f32_16x16x32_bf16 a[168:171], a[4:7], v[232:235], a[168:171]
    v_mfma_f32_16x16x32_bf16 a[172:175], a[0:3], v[244:247], a[172:175]
    v_exp_f32 v142, v142
    v_mfma_f32_16x16x32_bf16 a[172:175], a[4:7], v[248:251], a[172:175]
    s_waitcnt lgkmcnt(0)
    v_exp_f32 v143, v143
    v_mfma_f32_16x16x32_bf16 a[176:179], a[8:11], v[196:199], a[176:179]
    ds_read_b64_tr_b16 a[0:1], v42 offset:16384
    ds_read_b64_tr_b16 a[2:3], v42 offset:20480
    v_mfma_f32_16x16x32_bf16 a[176:179], a[12:15], v[200:203], a[176:179]
    v_exp_f32 v156, v156
    v_mfma_f32_16x16x32_bf16 a[180:183], a[8:11], v[212:215], a[180:183]
    ds_read_b64_tr_b16 a[4:5], v42 offset:24576
    ds_read_b64_tr_b16 a[6:7], v42 offset:28672
    v_mfma_f32_16x16x32_bf16 a[180:183], a[12:15], v[216:219], a[180:183]
    v_exp_f32 v157, v157
    v_mfma_f32_16x16x32_bf16 a[184:187], a[8:11], v[228:231], a[184:187]
    v_cvt_pk_bf16_f32 v241, v142, v143
    v_cvt_pk_bf16_f32 v242, v156, v157
    v_mfma_f32_16x16x32_bf16 a[184:187], a[12:15], v[232:235], a[184:187]
    v_mfma_f32_16x16x32_bf16 a[188:191], a[8:11], v[244:247], a[188:191]
    v_exp_f32 v158, v158
    v_mfma_f32_16x16x32_bf16 a[188:191], a[12:15], v[248:251], a[188:191]
    s_waitcnt lgkmcnt(0)
    v_exp_f32 v159, v159
    v_mfma_f32_16x16x32_bf16 a[192:195], a[0:3], v[200:203], a[192:195]
    ds_read_b64_tr_b16 a[8:9], v43 offset:16384
    ds_read_b64_tr_b16 a[10:11], v43 offset:20480
    v_exp_f32 v160, v160
    v_mfma_f32_16x16x32_bf16 a[192:195], a[4:7], v[192:195], a[192:195]
    v_exp_f32 v161, v161
    v_cvt_pk_bf16_f32 v243, v158, v159
    v_mfma_f32_16x16x32_bf16 a[196:199], a[0:3], v[216:219], a[196:199]
    ds_read_b64_tr_b16 a[12:13], v43 offset:24576
    ds_read_b64_tr_b16 a[14:15], v43 offset:28672
    v_exp_f32 v162, v162
    v_mfma_f32_16x16x32_bf16 a[196:199], a[4:7], v[208:211], a[196:199]
    v_exp_f32 v163, v163
    v_cvt_pk_bf16_f32 v196, v160, v161
    v_mfma_f32_16x16x32_bf16 a[200:203], a[0:3], v[232:235], a[200:203]
    v_exp_f32 v176, v176
    v_mfma_f32_16x16x32_bf16 a[200:203], a[4:7], v[224:227], a[200:203]
    v_exp_f32 v177, v177
    v_cvt_pk_bf16_f32 v197, v162, v163
    v_mfma_f32_16x16x32_bf16 a[204:207], a[0:3], v[248:251], a[204:207]
    v_exp_f32 v178, v178
    v_mfma_f32_16x16x32_bf16 a[204:207], a[4:7], v[240:243], a[204:207]
    s_waitcnt lgkmcnt(0)
    v_exp_f32 v179, v179
    v_cvt_pk_bf16_f32 v198, v176, v177
    v_mfma_f32_16x16x32_bf16 a[208:211], a[8:11], v[200:203], a[208:211]
    ds_read_b64_tr_b16 a[0:1], v44 offset:16384
    ds_read_b64_tr_b16 a[2:3], v44 offset:20480
    v_exp_f32 v164, v164
    v_mfma_f32_16x16x32_bf16 a[208:211], a[12:15], v[192:195], a[208:211]
    v_exp_f32 v165, v165
    v_cvt_pk_bf16_f32 v199, v178, v179
    v_mfma_f32_16x16x32_bf16 a[212:215], a[8:11], v[216:219], a[212:215]
    ds_read_b64_tr_b16 a[4:5], v44 offset:24576
    ds_read_b64_tr_b16 a[6:7], v44 offset:28672
    v_exp_f32 v166, v166
    v_mfma_f32_16x16x32_bf16 a[212:215], a[12:15], v[208:211], a[212:215]
    v_exp_f32 v167, v167
    v_cvt_pk_bf16_f32 v212, v164, v165
    v_mfma_f32_16x16x32_bf16 a[216:219], a[8:11], v[232:235], a[216:219]
    v_exp_f32 v180, v180
    v_mfma_f32_16x16x32_bf16 a[216:219], a[12:15], v[224:227], a[216:219]
    v_exp_f32 v181, v181
    v_cvt_pk_bf16_f32 v213, v166, v167
    v_mfma_f32_16x16x32_bf16 a[220:223], a[8:11], v[248:251], a[220:223]
    v_exp_f32 v182, v182
    v_mfma_f32_16x16x32_bf16 a[220:223], a[12:15], v[240:243], a[220:223]
    s_waitcnt lgkmcnt(0)
    v_exp_f32 v183, v183
    v_cvt_pk_bf16_f32 v214, v180, v181
    v_mfma_f32_16x16x32_bf16 a[224:227], a[0:3], v[200:203], a[224:227]
    ds_read_b64_tr_b16 a[8:9], v45 offset:16384
    ds_read_b64_tr_b16 a[10:11], v45 offset:20480
    v_exp_f32 v168, v168
    v_mfma_f32_16x16x32_bf16 a[224:227], a[4:7], v[192:195], a[224:227]
    v_exp_f32 v169, v169
    v_cvt_pk_bf16_f32 v215, v182, v183
    s_cmp_eq_u32 s42, 0
    s_cbranch_scc0 L_shared
    s_waitcnt vmcnt(8)
    ds_write_b64 v54, v[2:3] offset:0
    ds_write_b64 v54, v[2:3] offset:4096
    ds_write_b64 v54, v[2:3] offset:8192
    ds_write_b64 v54, v[2:3] offset:12288
L_shared:
    v_mfma_f32_16x16x32_bf16 a[228:231], a[0:3], v[216:219], a[228:231]
    ds_read_b64_tr_b16 a[12:13], v45 offset:24576
    ds_read_b64_tr_b16 a[14:15], v45 offset:28672
    v_exp_f32 v170, v170
    v_mfma_f32_16x16x32_bf16 a[228:231], a[4:7], v[208:211], a[228:231]
    v_exp_f32 v171, v171
    v_cvt_pk_bf16_f32 v228, v168, v169
    v_mfma_f32_16x16x32_bf16 a[232:235], a[0:3], v[232:235], a[232:235]
    v_exp_f32 v184, v184
    v_mfma_f32_16x16x32_bf16 a[232:235], a[4:7], v[224:227], a[232:235]
    v_exp_f32 v185, v185
    v_cvt_pk_bf16_f32 v229, v170, v171
    v_mfma_f32_16x16x32_bf16 a[236:239], a[0:3], v[248:251], a[236:239]
    v_exp_f32 v186, v186
    v_mfma_f32_16x16x32_bf16 a[236:239], a[4:7], v[240:243], a[236:239]
    s_waitcnt vmcnt(8) lgkmcnt(0)
    v_exp_f32 v187, v187
    v_cvt_pk_bf16_f32 v230, v184, v185
    v_mfma_f32_16x16x32_bf16 a[240:243], a[8:11], v[200:203], a[240:243]
    s_barrier
    v_mfma_f32_16x16x32_bf16 a[240:243], a[12:15], v[192:195], a[240:243]
    v_exp_f32 v172, v172
    v_exp_f32 v173, v173
    v_cvt_pk_bf16_f32 v231, v186, v187
    v_mfma_f32_16x16x32_bf16 a[244:247], a[8:11], v[216:219], a[244:247]
    ds_read_b64_tr_b16 a[0:1], v38 offset:24576
    ds_read_b64_tr_b16 a[2:3], v38 offset:28672
    v_exp_f32 v174, v174
    v_mfma_f32_16x16x32_bf16 a[244:247], a[12:15], v[208:211], a[244:247]
    v_exp_f32 v175, v175
    v_cvt_pk_bf16_f32 v244, v172, v173
    v_mfma_f32_16x16x32_bf16 a[248:251], a[8:11], v[232:235], a[248:251]
    ds_read_b64_tr_b16 a[4:5], v38 offset:32768
    ds_read_b64_tr_b16 a[6:7], v38 offset:36864
    v_exp_f32 v188, v188
    v_mfma_f32_16x16x32_bf16 a[248:251], a[12:15], v[224:227], a[248:251]
    v_exp_f32 v189, v189
    v_cvt_pk_bf16_f32 v245, v174, v175
    v_mfma_f32_16x16x32_bf16 a[252:255], a[8:11], v[248:251], a[252:255]
    v_exp_f32 v190, v190
    v_mfma_f32_16x16x32_bf16 a[252:255], a[12:15], v[240:243], a[252:255]
    v_exp_f32 v191, v191
    v_cvt_pk_bf16_f32 v246, v188, v189
    v_smfmac_f32_16x16x64_bf16 a[108:111], a[112:115], v[192:199], v19
    v_cvt_pk_bf16_f32 v247, v190, v191
    v_smfmac_f32_16x16x64_bf16 a[108:111], a[116:119], v[208:215], v19
    v_smfmac_f32_16x16x64_bf16 a[108:111], a[120:123], v[224:231], v19
    v_smfmac_f32_16x16x64_bf16 a[108:111], a[124:127], v[240:247], v19
    s_waitcnt lgkmcnt(0)
    ds_read_b64 v[2:3], v56
    v_mfma_f32_16x16x32_bf16 a[128:131], a[0:3], v[192:195], a[128:131]
    ds_read_b64_tr_b16 a[8:9], v39 offset:24576
    ds_read_b64_tr_b16 a[10:11], v39 offset:28672
    v_mfma_f32_16x16x32_bf16 a[128:131], a[4:7], v[196:199], a[128:131]
    s_add_u32 m0, s92, 8192
    s_nop 0
    buffer_load_dwordx4 v26, s[20:23], s46 offen offset:0 lds
    s_add_u32 s47, s71, 0
    s_xor_b32 s47, s47, 128
    v_mfma_f32_16x16x32_bf16 a[132:135], a[0:3], v[208:211], a[132:135]
    ds_read_b64_tr_b16 a[12:13], v39 offset:32768
    ds_read_b64_tr_b16 a[14:15], v39 offset:36864
    v_mfma_f32_16x16x32_bf16 a[132:135], a[4:7], v[212:215], a[132:135]
    buffer_load_dwordx4 v27, s[20:23], s46 offen offset:1024 lds
    v_mfma_f32_16x16x32_bf16 a[136:139], a[0:3], v[224:227], a[136:139]
    v_mfma_f32_16x16x32_bf16 a[136:139], a[4:7], v[228:231], a[136:139]
    buffer_load_dwordx4 v28, s[20:23], s46 offen offset:2048 lds
    v_mfma_f32_16x16x32_bf16 a[140:143], a[0:3], v[240:243], a[140:143]
    v_mfma_f32_16x16x32_bf16 a[140:143], a[4:7], v[244:247], a[140:143]
    s_waitcnt lgkmcnt(0)
    v_mfma_f32_16x16x32_bf16 a[144:147], a[8:11], v[192:195], a[144:147]
    ds_read_b64_tr_b16 a[0:1], v40 offset:24576
    ds_read_b64_tr_b16 a[2:3], v40 offset:28672
    v_mfma_f32_16x16x32_bf16 a[144:147], a[12:15], v[196:199], a[144:147]
    buffer_load_dwordx4 v29, s[20:23], s46 offen offset:3072 lds
    v_mfma_f32_16x16x32_bf16 a[148:151], a[8:11], v[208:211], a[148:151]
    ds_read_b64_tr_b16 a[4:5], v40 offset:32768
    ds_read_b64_tr_b16 a[6:7], v40 offset:36864
    v_mfma_f32_16x16x32_bf16 a[148:151], a[12:15], v[212:215], a[148:151]
    s_add_u32 m0, s92, 12288
    s_nop 0
    buffer_load_dwordx4 v26, s[20:23], s47 offen offset:0 lds
    s_add_u32 s46, s72, 0
    v_mfma_f32_16x16x32_bf16 a[152:155], a[8:11], v[224:227], a[152:155]
    v_accvgpr_read_b32 v10, a108
    v_accvgpr_read_b32 v11, a109
    v_mfma_f32_16x16x32_bf16 a[152:155], a[12:15], v[228:231], a[152:155]
    buffer_load_dwordx4 v27, s[20:23], s47 offen offset:1024 lds
    v_mfma_f32_16x16x32_bf16 a[156:159], a[8:11], v[240:243], a[156:159]
    v_accvgpr_read_b32 v12, a110
    v_accvgpr_read_b32 v13, a111
    v_mfma_f32_16x16x32_bf16 a[156:159], a[12:15], v[244:247], a[156:159]
    s_waitcnt lgkmcnt(0)
    v_add_f32 v30, v10, v11
    v_add_f32 v32, v10, v11
    v_mfma_f32_16x16x32_bf16 a[160:163], a[0:3], v[192:195], a[160:163]
    ds_read_b64_tr_b16 a[8:9], v41 offset:24576
    ds_read_b64_tr_b16 a[10:11], v41 offset:28672
    v_mfma_f32_16x16x32_bf16 a[160:163], a[4:7], v[196:199], a[160:163]
    buffer_load_dwordx4 v28, s[20:23], s47 offen offset:2048 lds
    v_mfma_f32_16x16x32_bf16 a[164:167], a[0:3], v[208:211], a[164:167]
    ds_read_b64_tr_b16 a[12:13], v41 offset:32768
    ds_read_b64_tr_b16 a[14:15], v41 offset:36864
    v_mfma_f32_16x16x32_bf16 a[164:167], a[4:7], v[212:215], a[164:167]
    buffer_load_dwordx4 v29, s[20:23], s47 offen offset:3072 lds
    v_mfma_f32_16x16x32_bf16 a[168:171], a[0:3], v[224:227], a[168:171]
    v_add_f32 v31, v12, v13
    v_add_f32 v33, v12, v13
    v_mfma_f32_16x16x32_bf16 a[168:171], a[4:7], v[228:231], a[168:171]
    v_readfirstlane_b32 s51, v2
    s_nop 0
    s_cmp_eq_u32 s51, 8
    s_cselect_b32 s66, 1, 0
    s_mov_b32 s63, s30
    s_cselect_b32 s30, s30, 0
    s_mov_b32 s3, 0
    s_nop 0
    buffer_load_dwordx4 a[16:19], v1, s[28:31], s3 offen offset:0 sc1
    v_mfma_f32_16x16x32_bf16 a[172:175], a[0:3], v[240:243], a[172:175]
    v_permlane16_swap_b32 v30, v32
    v_permlane16_swap_b32 v31, v33
    v_mfma_f32_16x16x32_bf16 a[172:175], a[4:7], v[244:247], a[172:175]
    s_waitcnt lgkmcnt(0)
    v_rcp_f32 v60, v30
    v_mfma_f32_16x16x32_bf16 a[176:179], a[8:11], v[192:195], a[176:179]
    ds_read_b64_tr_b16 a[0:1], v42 offset:32768
    ds_read_b64_tr_b16 a[2:3], v42 offset:36864
    v_mfma_f32_16x16x32_bf16 a[176:179], a[12:15], v[196:199], a[176:179]
    buffer_load_dwordx4 a[20:23], v1, s[28:31], s3 offen offset:1024 sc1
    v_mfma_f32_16x16x32_bf16 a[180:183], a[8:11], v[208:211], a[180:183]
    ds_read_b64_tr_b16 a[4:5], v43 offset:32768
    ds_read_b64_tr_b16 a[6:7], v43 offset:36864
    v_mfma_f32_16x16x32_bf16 a[180:183], a[12:15], v[212:215], a[180:183]
    s_mov_b32 s3, 2097152
    s_nop 0
    buffer_load_dwordx4 a[24:27], v1, s[28:31], s3 offen offset:0 sc1
    v_mfma_f32_16x16x32_bf16 a[184:187], a[8:11], v[224:227], a[184:187]
    v_rcp_f32 v61, v31
    v_mfma_f32_16x16x32_bf16 a[184:187], a[12:15], v[228:231], a[184:187]
    buffer_load_dwordx4 a[28:31], v1, s[28:31], s3 offen offset:1024 sc1
    v_mfma_f32_16x16x32_bf16 a[188:191], a[8:11], v[240:243], a[188:191]
    v_rcp_f32 v62, v32
    v_mfma_f32_16x16x32_bf16 a[188:191], a[12:15], v[244:247], a[188:191]
    s_waitcnt lgkmcnt(0)
    v_rcp_f32 v63, v33
    v_mfma_f32_16x16x32_bf16 a[192:195], a[0:3], v[196:199], a[192:195]
    ds_read_b64_tr_b16 a[8:9], v44 offset:32768
    ds_read_b64_tr_b16 a[10:11], v44 offset:36864
    v_mfma_f32_16x16x32_bf16 a[208:211], a[4:7], v[196:199], a[208:211]
    s_mov_b32 s3, 4194304
    s_nop 0
    buffer_load_dwordx4 a[32:35], v1, s[28:31], s3 offen offset:0 sc1
    v_mfma_f32_16x16x32_bf16 a[196:199], a[0:3], v[212:215], a[196:199]
    ds_read_b64_tr_b16 a[12:13], v45 offset:32768
    ds_read_b64_tr_b16 a[14:15], v45 offset:36864
    v_mfma_f32_16x16x32_bf16 a[212:215], a[4:7], v[212:215], a[212:215]
    buffer_load_dwordx4 a[36:39], v1, s[28:31], s3 offen offset:1024 sc1
    v_mfma_f32_16x16x32_bf16 a[200:203], a[0:3], v[228:231], a[200:203]
    v_accvgpr_read_b32 v14, a92
    v_mfma_f32_16x16x32_bf16 a[216:219], a[4:7], v[228:231], a[216:219]
    s_mov_b32 s3, 6291456
    s_nop 0
    buffer_load_dwordx4 a[40:43], v1, s[28:31], s3 offen offset:0 sc1
    v_mfma_f32_16x16x32_bf16 a[204:207], a[0:3], v[244:247], a[204:207]
    v_mul_f32 v20, v14, v60
    v_mul_f32 v21, v14, v61
    v_mfma_f32_16x16x32_bf16 a[220:223], a[4:7], v[244:247], a[220:223]
    s_waitcnt lgkmcnt(0)
    v_mul_f32 v22, v14, v62
    v_mul_f32 v23, v14, v63
    v_mfma_f32_16x16x32_bf16 a[224:227], a[8:11], v[196:199], a[224:227]
    v_accvgpr_read_b32 v128, a128
    v_accvgpr_read_b32 v129, a129
    v_mfma_f32_16x16x32_bf16 a[240:243], a[12:15], v[196:199], a[240:243]
    buffer_load_dwordx4 a[44:47], v1, s[28:31], s3 offen offset:1024 sc1
    v_mfma_f32_16x16x32_bf16 a[228:231], a[8:11], v[212:215], a[228:231]
    v_accvgpr_read_b32 v130, a130
    v_accvgpr_read_b32 v131, a131
    v_mfma_f32_16x16x32_bf16 a[244:247], a[12:15], v[212:215], a[244:247]
    v_accvgpr_read_b32 v132, a144
    v_accvgpr_read_b32 v133, a145
    v_mfma_f32_16x16x32_bf16 a[232:235], a[8:11], v[228:231], a[232:235]
    v_accvgpr_read_b32 v134, a146
    v_accvgpr_read_b32 v135, a147
    v_mfma_f32_16x16x32_bf16 a[248:251], a[12:15], v[228:231], a[248:251]
    v_accvgpr_read_b32 v144, a132
    v_accvgpr_read_b32 v145, a133
    v_mfma_f32_16x16x32_bf16 a[236:239], a[8:11], v[244:247], a[236:239]
    v_accvgpr_read_b32 v146, a134
    v_accvgpr_read_b32 v147, a135
    v_mfma_f32_16x16x32_bf16 a[252:255], a[12:15], v[244:247], a[252:255]
    v_accvgpr_read_b32 v148, a148
    v_accvgpr_read_b32 v149, a149
    v_accvgpr_read_b32 v150, a150
    v_accvgpr_read_b32 v151, a151
    v_accvgpr_read_b32 v160, a136
    v_accvgpr_read_b32 v161, a137
    v_accvgpr_read_b32 v162, a138
    v_accvgpr_read_b32 v163, a139
    v_accvgpr_read_b32 v164, a152
    v_accvgpr_read_b32 v165, a153
    v_accvgpr_read_b32 v166, a154
    v_accvgpr_read_b32 v167, a155
    v_accvgpr_read_b32 v176, a140
    v_accvgpr_read_b32 v177, a141
    v_accvgpr_read_b32 v178, a142
    v_accvgpr_read_b32 v179, a143
    v_accvgpr_read_b32 v180, a156
    v_accvgpr_read_b32 v181, a157
    v_accvgpr_read_b32 v182, a158
    v_accvgpr_read_b32 v183, a159
    s_mov_b32 s51, 0x57800000
    v_mov_b32 v10, 0
    v_cmp_nlt_f32 vcc, v30, s51
    s_nop 1
    v_cndmask_b32 v10, v10, 1, vcc
    v_cmp_nlt_f32 vcc, v31, s51
    s_nop 1
    v_cndmask_b32 v10, v10, 1, vcc
    v_cmp_nlt_f32 vcc, v32, s51
    s_nop 1
    v_cndmask_b32 v10, v10, 1, vcc
    v_cmp_nlt_f32 vcc, v33, s51
    s_nop 1
    v_cndmask_b32 v10, v10, 1, vcc
    s_lshl_b32 s51, s42, 8
    s_add_u32 s51, s51, 131072
    v_lshl_add_u32 v11, v0, 2, s51
    ds_write_b32 v11, v10 offset:0
    ds_write_b32 v11, v10 offset:4096
    ds_write_b32 v11, v10 offset:24576
    ds_write_b32 v11, v10 offset:28672
    v_pk_fma_f32 v[128:129], v[128:129], v[60:61], v[20:21] op_sel:[0,0,0] op_sel_hi:[1,0,0] neg_lo:[0,0,1] neg_hi:[0,0,1]
    v_pk_fma_f32 v[130:131], v[130:131], v[60:61], v[20:21] op_sel:[0,0,0] op_sel_hi:[1,0,0] neg_lo:[0,0,1] neg_hi:[0,0,1]
    v_pk_fma_f32 v[132:133], v[132:133], v[60:61], v[20:21] op_sel:[0,0,0] op_sel_hi:[1,0,0] neg_lo:[0,0,1] neg_hi:[0,0,1]
    v_pk_fma_f32 v[134:135], v[134:135], v[60:61], v[20:21] op_sel:[0,0,0] op_sel_hi:[1,0,0] neg_lo:[0,0,1] neg_hi:[0,0,1]
    v_cvt_pk_bf16_f32 v136, v128, v129
    v_cvt_pk_bf16_f32 v137, v130, v131
    v_cvt_pk_bf16_f32 v138, v132, v133
    v_cvt_pk_bf16_f32 v139, v134, v135
    ds_write_b128 v56, v[136:139] offset:0
    s_mov_b32 s3, 8388608
    buffer_load_dwordx4 a[48:51], v1, s[28:31], s3 offen offset:0 sc1
    v_pk_fma_f32 v[144:145], v[144:145], v[60:61], v[20:21] op_sel:[0,1,1] op_sel_hi:[1,1,1] neg_lo:[0,0,1] neg_hi:[0,0,1]
    v_pk_fma_f32 v[146:147], v[146:147], v[60:61], v[20:21] op_sel:[0,1,1] op_sel_hi:[1,1,1] neg_lo:[0,0,1] neg_hi:[0,0,1]
    v_pk_fma_f32 v[148:149], v[148:149], v[60:61], v[20:21] op_sel:[0,1,1] op_sel_hi:[1,1,1] neg_lo:[0,0,1] neg_hi:[0,0,1]
    v_pk_fma_f32 v[150:151], v[150:151], v[60:61], v[20:21] op_sel:[0,1,1] op_sel_hi:[1,1,1] neg_lo:[0,0,1] neg_hi:[0,0,1]
    v_cvt_pk_bf16_f32 v152, v144, v145
    v_cvt_pk_bf16_f32 v153, v146, v147
    v_cvt_pk_bf16_f32 v154, v148, v149
    v_cvt_pk_bf16_f32 v155, v150, v151
    ds_write_b128 v56, v[152:155] offset:1024
    buffer_load_dwordx4 a[52:55], v1, s[28:31], s3 offen offset:1024 sc1
    v_pk_fma_f32 v[160:161], v[160:161], v[62:63], v[22:23] op_sel:[0,0,0] op_sel_hi:[1,0,0] neg_lo:[0,0,1] neg_hi:[0,0,1]
    v_pk_fma_f32 v[162:163], v[162:163], v[62:63], v[22:23] op_sel:[0,0,0] op_sel_hi:[1,0,0] neg_lo:[0,0,1] neg_hi:[0,0,1]
    v_pk_fma_f32 v[164:165], v[164:165], v[62:63], v[22:23] op_sel:[0,0,0] op_sel_hi:[1,0,0] neg_lo:[0,0,1] neg_hi:[0,0,1]
    v_pk_fma_f32 v[166:167], v[166:167], v[62:63], v[22:23] op_sel:[0,0,0] op_sel_hi:[1,0,0] neg_lo:[0,0,1] neg_hi:[0,0,1]
    v_cvt_pk_bf16_f32 v168, v160, v161
    v_cvt_pk_bf16_f32 v169, v162, v163
    v_cvt_pk_bf16_f32 v170, v164, v165
    v_cvt_pk_bf16_f32 v171, v166, v167
    ds_write_b128 v56, v[168:171] offset:2048
    s_mov_b32 s3, 10485760
    buffer_load_dwordx4 a[56:59], v1, s[28:31], s3 offen offset:0 sc1
    v_pk_fma_f32 v[176:177], v[176:177], v[62:63], v[22:23] op_sel:[0,1,1] op_sel_hi:[1,1,1] neg_lo:[0,0,1] neg_hi:[0,0,1]
    v_pk_fma_f32 v[178:179], v[178:179], v[62:63], v[22:23] op_sel:[0,1,1] op_sel_hi:[1,1,1] neg_lo:[0,0,1] neg_hi:[0,0,1]
    v_pk_fma_f32 v[180:181], v[180:181], v[62:63], v[22:23] op_sel:[0,1,1] op_sel_hi:[1,1,1] neg_lo:[0,0,1] neg_hi:[0,0,1]
    v_pk_fma_f32 v[182:183], v[182:183], v[62:63], v[22:23] op_sel:[0,1,1] op_sel_hi:[1,1,1] neg_lo:[0,0,1] neg_hi:[0,0,1]
    v_cvt_pk_bf16_f32 v184, v176, v177
    v_cvt_pk_bf16_f32 v185, v178, v179
    v_cvt_pk_bf16_f32 v186, v180, v181
    v_cvt_pk_bf16_f32 v187, v182, v183
    ds_write_b128 v56, v[184:187] offset:3072
    buffer_load_dwordx4 a[60:63], v1, s[28:31], s3 offen offset:1024 sc1
    v_accvgpr_read_b32 v128, a160
    v_accvgpr_read_b32 v129, a161
    v_accvgpr_read_b32 v130, a162
    v_accvgpr_read_b32 v131, a163
    v_accvgpr_read_b32 v132, a176
    v_accvgpr_read_b32 v133, a177
    v_accvgpr_read_b32 v134, a178
    v_accvgpr_read_b32 v135, a179
    v_pk_fma_f32 v[128:129], v[128:129], v[60:61], v[20:21] op_sel:[0,0,0] op_sel_hi:[1,0,0] neg_lo:[0,0,1] neg_hi:[0,0,1]
    v_pk_fma_f32 v[130:131], v[130:131], v[60:61], v[20:21] op_sel:[0,0,0] op_sel_hi:[1,0,0] neg_lo:[0,0,1] neg_hi:[0,0,1]
    v_pk_fma_f32 v[132:133], v[132:133], v[60:61], v[20:21] op_sel:[0,0,0] op_sel_hi:[1,0,0] neg_lo:[0,0,1] neg_hi:[0,0,1]
    v_pk_fma_f32 v[134:135], v[134:135], v[60:61], v[20:21] op_sel:[0,0,0] op_sel_hi:[1,0,0] neg_lo:[0,0,1] neg_hi:[0,0,1]
    v_cvt_pk_bf16_f32 v136, v128, v129
    v_cvt_pk_bf16_f32 v137, v130, v131
    v_cvt_pk_bf16_f32 v138, v132, v133
    v_cvt_pk_bf16_f32 v139, v134, v135
    ds_write_b128 v56, v[136:139] offset:16384
    s_mov_b32 s3, 12582912
    buffer_load_dwordx4 a[64:67], v1, s[28:31], s3 offen offset:0 sc1
    v_accvgpr_read_b32 v144, a164
    v_accvgpr_read_b32 v145, a165
    v_accvgpr_read_b32 v146, a166
    v_accvgpr_read_b32 v147, a167
    v_accvgpr_read_b32 v148, a180
    v_accvgpr_read_b32 v149, a181
    v_accvgpr_read_b32 v150, a182
    v_accvgpr_read_b32 v151, a183
    v_pk_fma_f32 v[144:145], v[144:145], v[60:61], v[20:21] op_sel:[0,1,1] op_sel_hi:[1,1,1] neg_lo:[0,0,1] neg_hi:[0,0,1]
    v_pk_fma_f32 v[146:147], v[146:147], v[60:61], v[20:21] op_sel:[0,1,1] op_sel_hi:[1,1,1] neg_lo:[0,0,1] neg_hi:[0,0,1]
    v_pk_fma_f32 v[148:149], v[148:149], v[60:61], v[20:21] op_sel:[0,1,1] op_sel_hi:[1,1,1] neg_lo:[0,0,1] neg_hi:[0,0,1]
    v_pk_fma_f32 v[150:151], v[150:151], v[60:61], v[20:21] op_sel:[0,1,1] op_sel_hi:[1,1,1] neg_lo:[0,0,1] neg_hi:[0,0,1]
    v_cvt_pk_bf16_f32 v152, v144, v145
    v_cvt_pk_bf16_f32 v153, v146, v147
    v_cvt_pk_bf16_f32 v154, v148, v149
    v_cvt_pk_bf16_f32 v155, v150, v151
    ds_write_b128 v56, v[152:155] offset:17408
    buffer_load_dwordx4 a[68:71], v1, s[28:31], s3 offen offset:1024 sc1
    v_accvgpr_read_b32 v160, a168
    v_accvgpr_read_b32 v161, a169
    v_accvgpr_read_b32 v162, a170
    v_accvgpr_read_b32 v163, a171
    v_accvgpr_read_b32 v164, a184
    v_accvgpr_read_b32 v165, a185
    v_accvgpr_read_b32 v166, a186
    v_accvgpr_read_b32 v167, a187
    v_pk_fma_f32 v[160:161], v[160:161], v[62:63], v[22:23] op_sel:[0,0,0] op_sel_hi:[1,0,0] neg_lo:[0,0,1] neg_hi:[0,0,1]
    v_pk_fma_f32 v[162:163], v[162:163], v[62:63], v[22:23] op_sel:[0,0,0] op_sel_hi:[1,0,0] neg_lo:[0,0,1] neg_hi:[0,0,1]
    v_pk_fma_f32 v[164:165], v[164:165], v[62:63], v[22:23] op_sel:[0,0,0] op_sel_hi:[1,0,0] neg_lo:[0,0,1] neg_hi:[0,0,1]
    v_pk_fma_f32 v[166:167], v[166:167], v[62:63], v[22:23] op_sel:[0,0,0] op_sel_hi:[1,0,0] neg_lo:[0,0,1] neg_hi:[0,0,1]
    v_cvt_pk_bf16_f32 v168, v160, v161
    v_cvt_pk_bf16_f32 v169, v162, v163
    v_cvt_pk_bf16_f32 v170, v164, v165
    v_cvt_pk_bf16_f32 v171, v166, v167
    ds_write_b128 v56, v[168:171] offset:18432
    s_mov_b32 s3, 14680064
    buffer_load_dwordx4 a[72:75], v1, s[28:31], s3 offen offset:0 sc1
    v_accvgpr_read_b32 v176, a172
    v_accvgpr_read_b32 v177, a173
    v_accvgpr_read_b32 v178, a174
    v_accvgpr_read_b32 v179, a175
    v_accvgpr_read_b32 v180, a188
    v_accvgpr_read_b32 v181, a189
    v_accvgpr_read_b32 v182, a190
    v_accvgpr_read_b32 v183, a191
    v_pk_fma_f32 v[176:177], v[176:177], v[62:63], v[22:23] op_sel:[0,1,1] op_sel_hi:[1,1,1] neg_lo:[0,0,1] neg_hi:[0,0,1]
    v_pk_fma_f32 v[178:179], v[178:179], v[62:63], v[22:23] op_sel:[0,1,1] op_sel_hi:[1,1,1] neg_lo:[0,0,1] neg_hi:[0,0,1]
    v_pk_fma_f32 v[180:181], v[180:181], v[62:63], v[22:23] op_sel:[0,1,1] op_sel_hi:[1,1,1] neg_lo:[0,0,1] neg_hi:[0,0,1]
    v_pk_fma_f32 v[182:183], v[182:183], v[62:63], v[22:23] op_sel:[0,1,1] op_sel_hi:[1,1,1] neg_lo:[0,0,1] neg_hi:[0,0,1]
    v_cvt_pk_bf16_f32 v184, v176, v177
    v_cvt_pk_bf16_f32 v185, v178, v179
    v_cvt_pk_bf16_f32 v186, v180, v181
    v_cvt_pk_bf16_f32 v187, v182, v183
    ds_write_b128 v56, v[184:187] offset:19456
    buffer_load_dwordx4 a[76:79], v1, s[28:31], s3 offen offset:1024 sc1
    v_accvgpr_read_b32 v128, a192
    v_accvgpr_read_b32 v129, a193
    v_accvgpr_read_b32 v130, a194
    v_accvgpr_read_b32 v131, a195
    v_accvgpr_read_b32 v132, a208
    v_accvgpr_read_b32 v133, a209
    v_accvgpr_read_b32 v134, a210
    v_accvgpr_read_b32 v135, a211
    v_pk_fma_f32 v[128:129], v[128:129], v[60:61], v[20:21] op_sel:[0,0,0] op_sel_hi:[1,0,0] neg_lo:[0,0,1] neg_hi:[0,0,1]
    v_pk_fma_f32 v[130:131], v[130:131], v[60:61], v[20:21] op_sel:[0,0,0] op_sel_hi:[1,0,0] neg_lo:[0,0,1] neg_hi:[0,0,1]
    v_pk_fma_f32 v[132:133], v[132:133], v[60:61], v[20:21] op_sel:[0,0,0] op_sel_hi:[1,0,0] neg_lo:[0,0,1] neg_hi:[0,0,1]
    v_pk_fma_f32 v[134:135], v[134:135], v[60:61], v[20:21] op_sel:[0,0,0] op_sel_hi:[1,0,0] neg_lo:[0,0,1] neg_hi:[0,0,1]
    v_cvt_pk_bf16_f32 v136, v128, v129
    v_cvt_pk_bf16_f32 v137, v130, v131
    v_cvt_pk_bf16_f32 v138, v132, v133
    v_cvt_pk_bf16_f32 v139, v134, v135
    ds_write_b128 v56, v[136:139] offset:32768
    v_accvgpr_read_b32 v144, a196
    v_accvgpr_read_b32 v145, a197
    v_accvgpr_read_b32 v146, a198
    v_accvgpr_read_b32 v147, a199
    v_accvgpr_read_b32 v148, a212
    v_accvgpr_read_b32 v149, a213
    v_accvgpr_read_b32 v150, a214
    v_accvgpr_read_b32 v151, a215
    v_pk_fma_f32 v[144:145], v[144:145], v[60:61], v[20:21] op_sel:[0,1,1] op_sel_hi:[1,1,1] neg_lo:[0,0,1] neg_hi:[0,0,1]
    v_pk_fma_f32 v[146:147], v[146:147], v[60:61], v[20:21] op_sel:[0,1,1] op_sel_hi:[1,1,1] neg_lo:[0,0,1] neg_hi:[0,0,1]
    v_pk_fma_f32 v[148:149], v[148:149], v[60:61], v[20:21] op_sel:[0,1,1] op_sel_hi:[1,1,1] neg_lo:[0,0,1] neg_hi:[0,0,1]
    v_pk_fma_f32 v[150:151], v[150:151], v[60:61], v[20:21] op_sel:[0,1,1] op_sel_hi:[1,1,1] neg_lo:[0,0,1] neg_hi:[0,0,1]
    v_cvt_pk_bf16_f32 v152, v144, v145
    v_cvt_pk_bf16_f32 v153, v146, v147
    v_cvt_pk_bf16_f32 v154, v148, v149
    v_cvt_pk_bf16_f32 v155, v150, v151
    ds_write_b128 v56, v[152:155] offset:33792
    v_accvgpr_read_b32 v160, a200
    v_accvgpr_read_b32 v161, a201
    v_accvgpr_read_b32 v162, a202
    v_accvgpr_read_b32 v163, a203
    v_accvgpr_read_b32 v164, a216
    v_accvgpr_read_b32 v165, a217
    v_accvgpr_read_b32 v166, a218
    v_accvgpr_read_b32 v167, a219
    v_pk_fma_f32 v[160:161], v[160:161], v[62:63], v[22:23] op_sel:[0,0,0] op_sel_hi:[1,0,0] neg_lo:[0,0,1] neg_hi:[0,0,1]
    v_pk_fma_f32 v[162:163], v[162:163], v[62:63], v[22:23] op_sel:[0,0,0] op_sel_hi:[1,0,0] neg_lo:[0,0,1] neg_hi:[0,0,1]
    v_pk_fma_f32 v[164:165], v[164:165], v[62:63], v[22:23] op_sel:[0,0,0] op_sel_hi:[1,0,0] neg_lo:[0,0,1] neg_hi:[0,0,1]
    v_pk_fma_f32 v[166:167], v[166:167], v[62:63], v[22:23] op_sel:[0,0,0] op_sel_hi:[1,0,0] neg_lo:[0,0,1] neg_hi:[0,0,1]
    v_cvt_pk_bf16_f32 v168, v160, v161
    v_cvt_pk_bf16_f32 v169, v162, v163
    v_cvt_pk_bf16_f32 v170, v164, v165
    v_cvt_pk_bf16_f32 v171, v166, v167
    ds_write_b128 v56, v[168:171] offset:34816
    v_accvgpr_read_b32 v176, a204
    v_accvgpr_read_b32 v177, a205
    v_accvgpr_read_b32 v178, a206
    v_accvgpr_read_b32 v179, a207
    v_accvgpr_read_b32 v180, a220
    v_accvgpr_read_b32 v181, a221
    v_accvgpr_read_b32 v182, a222
    v_accvgpr_read_b32 v183, a223
    v_pk_fma_f32 v[176:177], v[176:177], v[62:63], v[22:23] op_sel:[0,1,1] op_sel_hi:[1,1,1] neg_lo:[0,0,1] neg_hi:[0,0,1]
    v_pk_fma_f32 v[178:179], v[178:179], v[62:63], v[22:23] op_sel:[0,1,1] op_sel_hi:[1,1,1] neg_lo:[0,0,1] neg_hi:[0,0,1]
    v_pk_fma_f32 v[180:181], v[180:181], v[62:63], v[22:23] op_sel:[0,1,1] op_sel_hi:[1,1,1] neg_lo:[0,0,1] neg_hi:[0,0,1]
    v_pk_fma_f32 v[182:183], v[182:183], v[62:63], v[22:23] op_sel:[0,1,1] op_sel_hi:[1,1,1] neg_lo:[0,0,1] neg_hi:[0,0,1]
    v_cvt_pk_bf16_f32 v184, v176, v177
    v_cvt_pk_bf16_f32 v185, v178, v179
    v_cvt_pk_bf16_f32 v186, v180, v181
    v_cvt_pk_bf16_f32 v187, v182, v183
    ds_write_b128 v56, v[184:187] offset:35840
    v_accvgpr_read_b32 v128, a224
    v_accvgpr_read_b32 v129, a225
    v_accvgpr_read_b32 v130, a226
    v_accvgpr_read_b32 v131, a227
    v_accvgpr_read_b32 v132, a240
    v_accvgpr_read_b32 v133, a241
    v_accvgpr_read_b32 v134, a242
    v_accvgpr_read_b32 v135, a243
    v_pk_fma_f32 v[128:129], v[128:129], v[60:61], v[20:21] op_sel:[0,0,0] op_sel_hi:[1,0,0] neg_lo:[0,0,1] neg_hi:[0,0,1]
    v_pk_fma_f32 v[130:131], v[130:131], v[60:61], v[20:21] op_sel:[0,0,0] op_sel_hi:[1,0,0] neg_lo:[0,0,1] neg_hi:[0,0,1]
    v_pk_fma_f32 v[132:133], v[132:133], v[60:61], v[20:21] op_sel:[0,0,0] op_sel_hi:[1,0,0] neg_lo:[0,0,1] neg_hi:[0,0,1]
    v_pk_fma_f32 v[134:135], v[134:135], v[60:61], v[20:21] op_sel:[0,0,0] op_sel_hi:[1,0,0] neg_lo:[0,0,1] neg_hi:[0,0,1]
    v_cvt_pk_bf16_f32 v136, v128, v129
    v_cvt_pk_bf16_f32 v137, v130, v131
    v_cvt_pk_bf16_f32 v138, v132, v133
    v_cvt_pk_bf16_f32 v139, v134, v135
    ds_write_b128 v56, v[136:139] offset:49152
    v_accvgpr_read_b32 v144, a228
    v_accvgpr_read_b32 v145, a229
    v_accvgpr_read_b32 v146, a230
    v_accvgpr_read_b32 v147, a231
    v_accvgpr_read_b32 v148, a244
    v_accvgpr_read_b32 v149, a245
    v_accvgpr_read_b32 v150, a246
    v_accvgpr_read_b32 v151, a247
    v_pk_fma_f32 v[144:145], v[144:145], v[60:61], v[20:21] op_sel:[0,1,1] op_sel_hi:[1,1,1] neg_lo:[0,0,1] neg_hi:[0,0,1]
    v_pk_fma_f32 v[146:147], v[146:147], v[60:61], v[20:21] op_sel:[0,1,1] op_sel_hi:[1,1,1] neg_lo:[0,0,1] neg_hi:[0,0,1]
    v_pk_fma_f32 v[148:149], v[148:149], v[60:61], v[20:21] op_sel:[0,1,1] op_sel_hi:[1,1,1] neg_lo:[0,0,1] neg_hi:[0,0,1]
    v_pk_fma_f32 v[150:151], v[150:151], v[60:61], v[20:21] op_sel:[0,1,1] op_sel_hi:[1,1,1] neg_lo:[0,0,1] neg_hi:[0,0,1]
    v_cvt_pk_bf16_f32 v152, v144, v145
    v_cvt_pk_bf16_f32 v153, v146, v147
    v_cvt_pk_bf16_f32 v154, v148, v149
    v_cvt_pk_bf16_f32 v155, v150, v151
    ds_write_b128 v56, v[152:155] offset:50176
    v_accvgpr_read_b32 v160, a232
    v_accvgpr_read_b32 v161, a233
    v_accvgpr_read_b32 v162, a234
    v_accvgpr_read_b32 v163, a235
    v_accvgpr_read_b32 v164, a248
    v_accvgpr_read_b32 v165, a249
    v_accvgpr_read_b32 v166, a250
    v_accvgpr_read_b32 v167, a251
    v_pk_fma_f32 v[160:161], v[160:161], v[62:63], v[22:23] op_sel:[0,0,0] op_sel_hi:[1,0,0] neg_lo:[0,0,1] neg_hi:[0,0,1]
    v_pk_fma_f32 v[162:163], v[162:163], v[62:63], v[22:23] op_sel:[0,0,0] op_sel_hi:[1,0,0] neg_lo:[0,0,1] neg_hi:[0,0,1]
    v_pk_fma_f32 v[164:165], v[164:165], v[62:63], v[22:23] op_sel:[0,0,0] op_sel_hi:[1,0,0] neg_lo:[0,0,1] neg_hi:[0,0,1]
    v_pk_fma_f32 v[166:167], v[166:167], v[62:63], v[22:23] op_sel:[0,0,0] op_sel_hi:[1,0,0] neg_lo:[0,0,1] neg_hi:[0,0,1]
    v_cvt_pk_bf16_f32 v168, v160, v161
    v_cvt_pk_bf16_f32 v169, v162, v163
    v_cvt_pk_bf16_f32 v170, v164, v165
    v_cvt_pk_bf16_f32 v171, v166, v167
    ds_write_b128 v56, v[168:171] offset:51200
    v_accvgpr_read_b32 v176, a236
    v_accvgpr_read_b32 v177, a237
    v_accvgpr_read_b32 v178, a238
    v_accvgpr_read_b32 v179, a239
    v_accvgpr_read_b32 v180, a252
    v_accvgpr_read_b32 v181, a253
    v_accvgpr_read_b32 v182, a254
    v_accvgpr_read_b32 v183, a255
    v_pk_fma_f32 v[176:177], v[176:177], v[62:63], v[22:23] op_sel:[0,1,1] op_sel_hi:[1,1,1] neg_lo:[0,0,1] neg_hi:[0,0,1]
    v_pk_fma_f32 v[178:179], v[178:179], v[62:63], v[22:23] op_sel:[0,1,1] op_sel_hi:[1,1,1] neg_lo:[0,0,1] neg_hi:[0,0,1]
    v_pk_fma_f32 v[180:181], v[180:181], v[62:63], v[22:23] op_sel:[0,1,1] op_sel_hi:[1,1,1] neg_lo:[0,0,1] neg_hi:[0,0,1]
    v_pk_fma_f32 v[182:183], v[182:183], v[62:63], v[22:23] op_sel:[0,1,1] op_sel_hi:[1,1,1] neg_lo:[0,0,1] neg_hi:[0,0,1]
    v_cvt_pk_bf16_f32 v184, v176, v177
    v_cvt_pk_bf16_f32 v185, v178, v179
    v_cvt_pk_bf16_f32 v186, v180, v181
    v_cvt_pk_bf16_f32 v187, v182, v183
    ds_write_b128 v56, v[184:187] offset:52224
    s_lshr_b32 s51, s42, 1
    s_lshl_b32 s51, s51, 14
    s_add_u32 s51, s51, s93
    v_lshl_add_u32 v30, v0, 2, s51
    s_waitcnt lgkmcnt(0)
    s_barrier
    ds_read_b32 v60, v30 offset:0
    ds_read_b32 v61, v30 offset:256
    ds_read_b32 v62, v30 offset:512
    ds_read_b32 v63, v30 offset:768
    v_accvgpr_read_b32 v10, a100
    v_accvgpr_read_b32 v11, a101
    v_accvgpr_read_b32 v12, a102
    v_accvgpr_read_b32 v13, a103
    v_accvgpr_read_b32 v14, a104
    v_accvgpr_read_b32 v15, a105
    v_accvgpr_read_b32 v16, a106
    v_accvgpr_read_b32 v17, a107
    s_waitcnt lgkmcnt(0)
    v_or_b32 v60, v60, v61
    v_or3_b32 v60, v60, v62, v63
    v_cmp_ne_u32 vcc, 0, v60
    s_cmp_eq_u32 s59, 0
    s_cselect_b64 vcc, vcc, 0
    s_cmp_lg_u64 vcc, 0
    s_cbranch_scc1 L_slow
    s_lshr_b32 s51, s40, 1
    s_and_b32 s52, s51, 2
    s_xor_b32 s52, s52, 2
    s_lshl_b32 s53, s52, 6
    s_and_b32 s54, s51, 1
    s_xor_b32 s54, s54, 1
    s_lshl_b32 s54, s54, 6
    s_lshl_b32 s3, s52, 12
    s_add_u32 s3, s3, 16777216
    s_add_u32 s67, s3, 4096
    s_lshl_b32 s69, s51, 12
    s_add_u32 s69, s69, 16777216
    s_xor_b32 s68, s69, 4096
    s_brev_b32 s65, 1
    v_xor_b32 v30, s54, v14
    v_xor_b32 v22, s54, v10
    v_xor_b32 v31, s54, v15
    v_xor_b32 v23, s54, v11
    v_xor_b32 v32, s54, v16
    v_xor_b32 v24, s54, v12
    v_xor_b32 v33, s54, v17
    v_xor_b32 v25, s54, v13
    v_readfirstlane_b32 s75, v3
    s_mov_b32 s12, s28
    s_mov_b32 s13, s29
    s_mov_b32 s14, s63
    s_mov_b32 s15, 0x20000
    s_cmp_lg_u32 s75, 0
    s_cbranch_scc1 L_havetok
    s_lshl_b32 s51, s41, 3
    v_mov_b32 v6, s74
    v_mov_b32 v7, 0
    v_mov_b32 v9, s51
    global_atomic_cmpswap v8, v9, v[6:7], s[84:85] offset:4 sc0 sc1
    s_waitcnt vmcnt(0)
    v_readfirstlane_b32 s75, v8
    s_nop 0
    s_cmp_eq_u32 s75, 0
    s_cselect_b32 s75, s74, s75
L_havetok:
    s_mov_b32 s57, 16384
    s_waitcnt vmcnt(24)
    ds_read_b128 a[128:131], v54 offset:0
    ds_read_b128 a[132:135], v54 offset:1024
    ds_read_b128 a[136:139], v54 offset:2048
    ds_read_b128 a[140:143], v54 offset:3072
    ds_read_b128 a[144:147], v54 offset:4096
    ds_read_b128 a[148:151], v54 offset:5120
    ds_read_b128 a[152:155], v54 offset:6144
    ds_read_b128 a[156:159], v54 offset:7168
    ds_read_b64_tr_b16 a[0:1], v14 offset:0
    ds_read_b64_tr_b16 a[2:3], v14 offset:2048
    ds_read_b64_tr_b16 a[4:5], v14 offset:4096
    ds_read_b64_tr_b16 a[6:7], v14 offset:6144
    s_waitcnt lgkmcnt(0)
    v_mfma_f32_16x16x32_bf16 v[128:131], a[0:3], a[128:131], 0
    s_add_u32 m0, s93, 16384
    ds_read_b64_tr_b16 a[8:9], v15 offset:0
    ds_read_b64_tr_b16 a[10:11], v15 offset:2048
    v_mfma_f32_16x16x32_bf16 v[128:131], a[4:7], a[144:147], v[128:131]
    buffer_load_dwordx4 v26, s[20:23], s46 offen offset:0 lds
    v_mfma_f32_16x16x32_bf16 v[132:135], a[0:3], a[132:135], 0
    s_add_u32 s47, s73, 0
    ds_read_b64_tr_b16 a[12:13], v15 offset:4096
    ds_read_b64_tr_b16 a[14:15], v15 offset:6144
    v_mfma_f32_16x16x32_bf16 v[132:135], a[4:7], a[148:151], v[132:135]
    buffer_load_dwordx4 v27, s[20:23], s46 offen offset:1024 lds
    v_mfma_f32_16x16x32_bf16 v[136:139], a[0:3], a[136:139], 0
    ds_read_b128 a[160:163], v54 offset:8192
    v_mfma_f32_16x16x32_bf16 v[136:139], a[4:7], a[152:155], v[136:139]
    buffer_load_dwordx4 v28, s[20:23], s46 offen offset:2048 lds
    v_mfma_f32_16x16x32_bf16 v[140:143], a[0:3], a[140:143], 0
    buffer_load_dwordx4 v29, s[20:23], s46 offen offset:3072 lds
    v_mfma_f32_16x16x32_bf16 v[140:143], a[4:7], a[156:159], v[140:143]
    s_waitcnt lgkmcnt(1)
    v_mfma_f32_16x16x32_bf16 v[144:147], a[8:11], a[128:131], 0
    s_add_u32 m0, s93, 0
    ds_read_b64_tr_b16 a[0:1], v16 offset:0
    ds_read_b64_tr_b16 a[2:3], v16 offset:2048
    v_mfma_f32_16x16x32_bf16 v[144:147], a[12:15], a[144:147], v[144:147]
    buffer_load_dwordx4 v26, s[20:23], s47 offen offset:0 lds
    v_mfma_f32_16x16x32_bf16 v[148:151], a[8:11], a[132:135], 0
    s_add_u32 s46, s72, 0
    ds_read_b64_tr_b16 a[4:5], v16 offset:4096
    ds_read_b64_tr_b16 a[6:7], v16 offset:6144
    v_mfma_f32_16x16x32_bf16 v[148:151], a[12:15], a[148:151], v[148:151]
    buffer_load_dwordx4 v27, s[20:23], s47 offen offset:1024 lds
    v_mfma_f32_16x16x32_bf16 v[152:155], a[8:11], a[136:139], 0
    s_xor_b32 s46, s46, 128
    ds_read_b128 a[164:167], v54 offset:9216
    v_mfma_f32_16x16x32_bf16 v[152:155], a[12:15], a[152:155], v[152:155]
    buffer_load_dwordx4 v28, s[20:23], s47 offen offset:2048 lds
    v_mfma_f32_16x16x32_bf16 v[156:159], a[8:11], a[140:143], 0
    buffer_load_dwordx4 v29, s[20:23], s47 offen offset:3072 lds
    v_mfma_f32_16x16x32_bf16 v[156:159], a[12:15], a[156:159], v[156:159]
    s_waitcnt lgkmcnt(1)
    v_mfma_f32_16x16x32_bf16 v[160:163], a[0:3], a[128:131], 0
    ds_read_b64_tr_b16 a[8:9], v17 offset:0
    ds_read_b64_tr_b16 a[10:11], v17 offset:2048
    v_mfma_f32_16x16x32_bf16 v[160:163], a[4:7], a[144:147], v[160:163]
    v_mfma_f32_16x16x32_bf16 v[164:167], a[0:3], a[132:135], 0
    ds_read_b64_tr_b16 a[12:13], v17 offset:4096
    ds_read_b64_tr_b16 a[14:15], v17 offset:6144
    v_mfma_f32_16x16x32_bf16 v[164:167], a[4:7], a[148:151], v[164:167]
    v_mfma_f32_16x16x32_bf16 v[168:171], a[0:3], a[136:139], 0
    ds_read_b128 a[168:171], v54 offset:10240
    v_mfma_f32_16x16x32_bf16 v[168:171], a[4:7], a[152:155], v[168:171]
    v_mfma_f32_16x16x32_bf16 v[172:175], a[0:3], a[140:143], 0
    v_mfma_f32_16x16x32_bf16 v[172:175], a[4:7], a[156:159], v[172:175]
    s_waitcnt vmcnt(24) lgkmcnt(1)
    v_mfma_f32_16x16x32_bf16 v[176:179], a[8:11], a[128:131], 0
    ds_read_b64_tr_b16 a[0:1], v30 offset:8192
    ds_read_b64_tr_b16 a[2:3], v30 offset:10240
    v_mfma_f32_16x16x32_bf16 v[176:179], a[12:15], a[144:147], v[176:179]
    v_mfma_f32_16x16x32_bf16 v[180:183], a[8:11], a[132:135], 0
    ds_read_b64_tr_b16 a[4:5], v30 offset:12288
    ds_read_b64_tr_b16 a[6:7], v30 offset:14336
    v_mfma_f32_16x16x32_bf16 v[180:183], a[12:15], a[148:151], v[180:183]
    v_mfma_f32_16x16x32_bf16 v[184:187], a[8:11], a[136:139], 0
    ds_read_b128 a[172:175], v54 offset:11264
    v_mfma_f32_16x16x32_bf16 v[184:187], a[12:15], a[152:155], v[184:187]
    v_mfma_f32_16x16x32_bf16 v[188:191], a[8:11], a[140:143], 0
    v_mfma_f32_16x16x32_bf16 v[188:191], a[12:15], a[156:159], v[188:191]
    s_waitcnt lgkmcnt(1)
    v_mfma_f32_16x16x32_bf16 v[192:195], a[0:3], a[128:131], 0
    s_add_u32 m0, s92, 0
    ds_read_b64_tr_b16 a[8:9], v31 offset:8192
    ds_read_b64_tr_b16 a[10:11], v31 offset:10240
    v_mfma_f32_16x16x32_bf16 v[192:195], a[4:7], a[144:147], v[192:195]
    buffer_load_dwordx4 v26, s[20:23], s46 offen offset:0 lds
    v_mfma_f32_16x16x32_bf16 v[196:199], a[0:3], a[132:135], 0
    s_add_u32 s47, s73, 0
    ds_read_b64_tr_b16 a[12:13], v31 offset:12288
    ds_read_b64_tr_b16 a[14:15], v31 offset:14336
    v_mfma_f32_16x16x32_bf16 v[196:199], a[4:7], a[148:151], v[196:199]
    buffer_load_dwordx4 v27, s[20:23], s46 offen offset:1024 lds
    v_mfma_f32_16x16x32_bf16 v[200:203], a[0:3], a[136:139], 0
    s_xor_b32 s47, s47, 128
    ds_read_b128 a[176:179], v54 offset:12288
    v_mfma_f32_16x16x32_bf16 v[200:203], a[4:7], a[152:155], v[200:203]
    buffer_load_dwordx4 v28, s[20:23], s46 offen offset:2048 lds
    v_mfma_f32_16x16x32_bf16 v[204:207], a[0:3], a[140:143], 0
    buffer_load_dwordx4 v29, s[20:23], s46 offen offset:3072 lds
    v_mfma_f32_16x16x32_bf16 v[204:207], a[4:7], a[156:159], v[204:207]
    s_waitcnt lgkmcnt(1)
    v_mfma_f32_16x16x32_bf16 v[208:211], a[8:11], a[128:131], 0
    s_add_u32 m0, s92, 4096
    ds_read_b64_tr_b16 a[0:1], v32 offset:8192
    ds_read_b64_tr_b16 a[2:3], v32 offset:10240
    v_mfma_f32_16x16x32_bf16 v[208:211], a[12:15], a[144:147], v[208:211]
    buffer_load_dwordx4 v26, s[20:23], s47 offen offset:0 lds
    v_mfma_f32_16x16x32_bf16 v[212:215], a[8:11], a[132:135], 0
    s_add_u32 s46, s70, 32768
    ds_read_b64_tr_b16 a[4:5], v32 offset:12288
    ds_read_b64_tr_b16 a[6:7], v32 offset:14336
    v_mfma_f32_16x16x32_bf16 v[212:215], a[12:15], a[148:151], v[212:215]
    buffer_load_dwordx4 v27, s[20:23], s47 offen offset:1024 lds
    v_mfma_f32_16x16x32_bf16 v[216:219], a[8:11], a[136:139], 0
    ds_read_b128 a[180:183], v54 offset:13312
    v_mfma_f32_16x16x32_bf16 v[216:219], a[12:15], a[152:155], v[216:219]
    buffer_load_dwordx4 v28, s[20:23], s47 offen offset:2048 lds
    v_mfma_f32_16x16x32_bf16 v[220:223], a[8:11], a[140:143], 0
    buffer_load_dwordx4 v29, s[20:23], s47 offen offset:3072 lds
    v_mfma_f32_16x16x32_bf16 v[220:223], a[12:15], a[156:159], v[220:223]
    s_waitcnt lgkmcnt(1)
    v_mfma_f32_16x16x32_bf16 v[224:227], a[0:3], a[128:131], 0
    ds_read_b64_tr_b16 a[8:9], v33 offset:8192
    ds_read_b64_tr_b16 a[10:11], v33 offset:10240
    v_mfma_f32_16x16x32_bf16 v[224:227], a[4:7], a[144:147], v[224:227]
    v_mfma_f32_16x16x32_bf16 v[228:231], a[0:3], a[132:135], 0
    ds_read_b64_tr_b16 a[12:13], v33 offset:12288
    ds_read_b64_tr_b16 a[14:15], v33 offset:14336
    v_mfma_f32_16x16x32_bf16 v[228:231], a[4:7], a[148:151], v[228:231]
    v_mfma_f32_16x16x32_bf16 v[232:235], a[0:3], a[136:139], 0
    ds_read_b128 a[184:187], v54 offset:14336
    v_mfma_f32_16x16x32_bf16 v[232:235], a[4:7], a[152:155], v[232:235]
    v_mfma_f32_16x16x32_bf16 v[236:239], a[0:3], a[140:143], 0
    v_mfma_f32_16x16x32_bf16 v[236:239], a[4:7], a[156:159], v[236:239]
    s_waitcnt vmcnt(8) lgkmcnt(1)
    v_mfma_f32_16x16x32_bf16 v[240:243], a[8:11], a[128:131], 0
    ds_read_b64_tr_b16 a[0:1], v10 offset:16384
    ds_read_b64_tr_b16 a[2:3], v10 offset:18432
    v_mfma_f32_16x16x32_bf16 v[240:243], a[12:15], a[144:147], v[240:243]
    v_mfma_f32_16x16x32_bf16 v[244:247], a[8:11], a[132:135], 0
    ds_read_b64_tr_b16 a[4:5], v10 offset:0
    ds_read_b64_tr_b16 a[6:7], v10 offset:2048
    v_mfma_f32_16x16x32_bf16 v[244:247], a[12:15], a[148:151], v[244:247]
    v_mfma_f32_16x16x32_bf16 v[248:251], a[8:11], a[136:139], 0
    ds_read_b128 a[188:191], v54 offset:15360
    v_mfma_f32_16x16x32_bf16 v[248:251], a[12:15], a[152:155], v[248:251]
    v_mfma_f32_16x16x32_bf16 v[252:255], a[8:11], a[140:143], 0
    v_mfma_f32_16x16x32_bf16 v[252:255], a[12:15], a[156:159], v[252:255]
    s_waitcnt lgkmcnt(0)
    v_mfma_f32_16x16x32_bf16 v[128:131], a[0:3], a[160:163], v[128:131]
    s_add_u32 m0, s92, 8192
    ds_read_b64_tr_b16 a[8:9], v11 offset:16384
    ds_read_b64_tr_b16 a[10:11], v11 offset:18432
    v_mfma_f32_16x16x32_bf16 v[128:131], a[4:7], a[176:179], v[128:131]
    buffer_load_dwordx4 v26, s[20:23], s46 offen offset:0 lds
    v_mfma_f32_16x16x32_bf16 v[132:135], a[0:3], a[164:167], v[132:135]
    s_add_u32 s47, s71, 32768
    ds_read_b64_tr_b16 a[12:13], v11 offset:0
    ds_read_b64_tr_b16 a[14:15], v11 offset:2048
    v_mfma_f32_16x16x32_bf16 v[132:135], a[4:7], a[180:183], v[132:135]
    buffer_load_dwordx4 v27, s[20:23], s46 offen offset:1024 lds
    v_mfma_f32_16x16x32_bf16 v[136:139], a[0:3], a[168:171], v[136:139]
    ds_read_b128 a[192:195], v54 offset:16384
    v_mfma_f32_16x16x32_bf16 v[136:139], a[4:7], a[184:187], v[136:139]
    buffer_load_dwordx4 v28, s[20:23], s46 offen offset:2048 lds
    v_mfma_f32_16x16x32_bf16 v[140:143], a[0:3], a[172:175], v[140:143]
    buffer_load_dwordx4 v29, s[20:23], s46 offen offset:3072 lds
    v_mfma_f32_16x16x32_bf16 v[140:143], a[4:7], a[188:191], v[140:143]
    s_waitcnt lgkmcnt(1)
    v_mfma_f32_16x16x32_bf16 v[144:147], a[8:11], a[160:163], v[144:147]
    s_add_u32 m0, s92, 12288
    ds_read_b64_tr_b16 a[0:1], v12 offset:16384
    ds_read_b64_tr_b16 a[2:3], v12 offset:18432
    v_mfma_f32_16x16x32_bf16 v[144:147], a[12:15], a[176:179], v[144:147]
    buffer_load_dwordx4 v26, s[20:23], s47 offen offset:0 lds
    v_mfma_f32_16x16x32_bf16 v[148:151], a[8:11], a[164:167], v[148:151]
    s_add_u32 s46, s70, 32768
    ds_read_b64_tr_b16 a[4:5], v12 offset:0
    ds_read_b64_tr_b16 a[6:7], v12 offset:2048
    v_mfma_f32_16x16x32_bf16 v[148:151], a[12:15], a[180:183], v[148:151]
    buffer_load_dwordx4 v27, s[20:23], s47 offen offset:1024 lds
    v_mfma_f32_16x16x32_bf16 v[152:155], a[8:11], a[168:171], v[152:155]
    s_xor_b32 s46, s46, 128
    ds_read_b128 a[196:199], v54 offset:17408
    v_mfma_f32_16x16x32_bf16 v[152:155], a[12:15], a[184:187], v[152:155]
    buffer_load_dwordx4 v28, s[20:23], s47 offen offset:2048 lds
    v_mfma_f32_16x16x32_bf16 v[156:159], a[8:11], a[172:175], v[156:159]
    buffer_load_dwordx4 v29, s[20:23], s47 offen offset:3072 lds
    v_mfma_f32_16x16x32_bf16 v[156:159], a[12:15], a[188:191], v[156:159]
    s_waitcnt lgkmcnt(1)
    v_mfma_f32_16x16x32_bf16 v[160:163], a[0:3], a[160:163], v[160:163]
    ds_read_b64_tr_b16 a[8:9], v13 offset:16384
    ds_read_b64_tr_b16 a[10:11], v13 offset:18432
    v_mfma_f32_16x16x32_bf16 v[160:163], a[4:7], a[176:179], v[160:163]
    v_mfma_f32_16x16x32_bf16 v[164:167], a[0:3], a[164:167], v[164:167]
    ds_read_b64_tr_b16 a[12:13], v13 offset:0
    ds_read_b64_tr_b16 a[14:15], v13 offset:2048
    v_mfma_f32_16x16x32_bf16 v[164:167], a[4:7], a[180:183], v[164:167]
    v_mfma_f32_16x16x32_bf16 v[168:171], a[0:3], a[168:171], v[168:171]
    ds_read_b128 a[200:203], v54 offset:18432
    v_mfma_f32_16x16x32_bf16 v[168:171], a[4:7], a[184:187], v[168:171]
    v_mfma_f32_16x16x32_bf16 v[172:175], a[0:3], a[172:175], v[172:175]
    v_mfma_f32_16x16x32_bf16 v[172:175], a[4:7], a[188:191], v[172:175]
    s_waitcnt vmcnt(8) lgkmcnt(1)
    v_mfma_f32_16x16x32_bf16 v[176:179], a[8:11], a[160:163], v[176:179]
    ds_read_b64_tr_b16 a[0:1], v30 offset:0
    ds_read_b64_tr_b16 a[2:3], v30 offset:2048
    v_mfma_f32_16x16x32_bf16 v[176:179], a[12:15], a[176:179], v[176:179]
    v_mfma_f32_16x16x32_bf16 v[180:183], a[8:11], a[164:167], v[180:183]
    ds_read_b64_tr_b16 a[4:5], v30 offset:4096
    ds_read_b64_tr_b16 a[6:7], v30 offset:6144
    v_mfma_f32_16x16x32_bf16 v[180:183], a[12:15], a[180:183], v[180:183]
    v_mfma_f32_16x16x32_bf16 v[184:187], a[8:11], a[168:171], v[184:187]
    ds_read_b128 a[204:207], v54 offset:19456
    v_mfma_f32_16x16x32_bf16 v[184:187], a[12:15], a[184:187], v[184:187]
    v_mfma_f32_16x16x32_bf16 v[188:191], a[8:11], a[172:175], v[188:191]
    v_mfma_f32_16x16x32_bf16 v[188:191], a[12:15], a[188:191], v[188:191]
    s_waitcnt lgkmcnt(1)
    v_mfma_f32_16x16x32_bf16 v[192:195], a[0:3], a[160:163], v[192:195]
    s_add_u32 m0, s93, 16384
    ds_read_b64_tr_b16 a[8:9], v31 offset:0
    ds_read_b64_tr_b16 a[10:11], v31 offset:2048
    v_mfma_f32_16x16x32_bf16 v[192:195], a[4:7], a[176:179], v[192:195]
    buffer_load_dwordx4 v26, s[20:23], s46 offen offset:0 lds
    v_mfma_f32_16x16x32_bf16 v[196:199], a[0:3], a[164:167], v[196:199]
    s_add_u32 s47, s71, 32768
    ds_read_b64_tr_b16 a[12:13], v31 offset:4096
    ds_read_b64_tr_b16 a[14:15], v31 offset:6144
    v_mfma_f32_16x16x32_bf16 v[196:199], a[4:7], a[180:183], v[196:199]
    buffer_load_dwordx4 v27, s[20:23], s46 offen offset:1024 lds
    v_mfma_f32_16x16x32_bf16 v[200:203], a[0:3], a[168:171], v[200:203]
    s_xor_b32 s47, s47, 128
    ds_read_b128 a[208:211], v54 offset:20480
    v_mfma_f32_16x16x32_bf16 v[200:203], a[4:7], a[184:187], v[200:203]
    buffer_load_dwordx4 v28, s[20:23], s46 offen offset:2048 lds
    v_mfma_f32_16x16x32_bf16 v[204:207], a[0:3], a[172:175], v[204:207]
    buffer_load_dwordx4 v29, s[20:23], s46 offen offset:3072 lds
    v_mfma_f32_16x16x32_bf16 v[204:207], a[4:7], a[188:191], v[204:207]
    s_waitcnt lgkmcnt(1)
    v_mfma_f32_16x16x32_bf16 v[208:211], a[8:11], a[160:163], v[208:211]
    s_add_u32 m0, s93, 0
    ds_read_b64_tr_b16 a[0:1], v32 offset:0
    ds_read_b64_tr_b16 a[2:3], v32 offset:2048
    v_mfma_f32_16x16x32_bf16 v[208:211], a[12:15], a[176:179], v[208:211]
    buffer_load_dwordx4 v26, s[20:23], s47 offen offset:0 lds
    v_mfma_f32_16x16x32_bf16 v[212:215], a[8:11], a[164:167], v[212:215]
    s_add_u32 s46, s72, 32768
    ds_read_b64_tr_b16 a[4:5], v32 offset:4096
    ds_read_b64_tr_b16 a[6:7], v32 offset:6144
    v_mfma_f32_16x16x32_bf16 v[212:215], a[12:15], a[180:183], v[212:215]
    buffer_load_dwordx4 v27, s[20:23], s47 offen offset:1024 lds
    v_mfma_f32_16x16x32_bf16 v[216:219], a[8:11], a[168:171], v[216:219]
    ds_read_b128 a[212:215], v54 offset:21504
    v_mfma_f32_16x16x32_bf16 v[216:219], a[12:15], a[184:187], v[216:219]
    buffer_load_dwordx4 v28, s[20:23], s47 offen offset:2048 lds
    v_mfma_f32_16x16x32_bf16 v[220:223], a[8:11], a[172:175], v[220:223]
    buffer_load_dwordx4 v29, s[20:23], s47 offen offset:3072 lds
    v_mfma_f32_16x16x32_bf16 v[220:223], a[12:15], a[188:191], v[220:223]
    s_waitcnt lgkmcnt(1)
    v_mfma_f32_16x16x32_bf16 v[224:227], a[0:3], a[160:163], v[224:227]
    ds_read_b64_tr_b16 a[8:9], v33 offset:0
    ds_read_b64_tr_b16 a[10:11], v33 offset:2048
    v_mfma_f32_16x16x32_bf16 v[224:227], a[4:7], a[176:179], v[224:227]
    v_mfma_f32_16x16x32_bf16 v[228:231], a[0:3], a[164:167], v[228:231]
    ds_read_b64_tr_b16 a[12:13], v33 offset:4096
    ds_read_b64_tr_b16 a[14:15], v33 offset:6144
    v_mfma_f32_16x16x32_bf16 v[228:231], a[4:7], a[180:183], v[228:231]
    v_mfma_f32_16x16x32_bf16 v[232:235], a[0:3], a[168:171], v[232:235]
    ds_read_b128 a[216:219], v54 offset:22528
    v_mfma_f32_16x16x32_bf16 v[232:235], a[4:7], a[184:187], v[232:235]
    v_mfma_f32_16x16x32_bf16 v[236:239], a[0:3], a[172:175], v[236:239]
    v_mfma_f32_16x16x32_bf16 v[236:239], a[4:7], a[188:191], v[236:239]
    s_waitcnt vmcnt(8) lgkmcnt(1)
    v_mfma_f32_16x16x32_bf16 v[240:243], a[8:11], a[160:163], v[240:243]
    ds_read_b64_tr_b16 a[0:1], v14 offset:8192
    ds_read_b64_tr_b16 a[2:3], v14 offset:10240
    v_mfma_f32_16x16x32_bf16 v[240:243], a[12:15], a[176:179], v[240:243]
    v_mfma_f32_16x16x32_bf16 v[244:247], a[8:11], a[164:167], v[244:247]
    ds_read_b64_tr_b16 a[4:5], v14 offset:12288
    ds_read_b64_tr_b16 a[6:7], v14 offset:14336
    v_mfma_f32_16x16x32_bf16 v[244:247], a[12:15], a[180:183], v[244:247]
    v_mfma_f32_16x16x32_bf16 v[248:251], a[8:11], a[168:171], v[248:251]
    ds_read_b128 a[220:223], v54 offset:23552
    v_mfma_f32_16x16x32_bf16 v[248:251], a[12:15], a[184:187], v[248:251]
    v_mfma_f32_16x16x32_bf16 v[252:255], a[8:11], a[172:175], v[252:255]
    v_mfma_f32_16x16x32_bf16 v[252:255], a[12:15], a[188:191], v[252:255]
    s_waitcnt lgkmcnt(0)
    v_mfma_f32_16x16x32_bf16 v[128:131], a[0:3], a[192:195], v[128:131]
    s_add_u32 m0, s92, 0
    ds_read_b64_tr_b16 a[8:9], v15 offset:8192
    ds_read_b64_tr_b16 a[10:11], v15 offset:10240
    v_mfma_f32_16x16x32_bf16 v[128:131], a[4:7], a[208:211], v[128:131]
    buffer_load_dwordx4 v26, s[20:23], s46 offen offset:0 lds
    v_mfma_f32_16x16x32_bf16 v[132:135], a[0:3], a[196:199], v[132:135]
    s_add_u32 s47, s73, 32768
    ds_read_b64_tr_b16 a[12:13], v15 offset:12288
    ds_read_b64_tr_b16 a[14:15], v15 offset:14336
    v_mfma_f32_16x16x32_bf16 v[132:135], a[4:7], a[212:215], v[132:135]
    buffer_load_dwordx4 v27, s[20:23], s46 offen offset:1024 lds
    v_mfma_f32_16x16x32_bf16 v[136:139], a[0:3], a[200:203], v[136:139]
    ds_read_b128 a[128:131], v54 offset:24576
    v_mfma_f32_16x16x32_bf16 v[136:139], a[4:7], a[216:219], v[136:139]
    buffer_load_dwordx4 v28, s[20:23], s46 offen offset:2048 lds
    v_mfma_f32_16x16x32_bf16 v[140:143], a[0:3], a[204:207], v[140:143]
    buffer_load_dwordx4 v29, s[20:23], s46 offen offset:3072 lds
    v_mfma_f32_16x16x32_bf16 v[140:143], a[4:7], a[220:223], v[140:143]
    s_waitcnt lgkmcnt(1)
    v_mfma_f32_16x16x32_bf16 v[144:147], a[8:11], a[192:195], v[144:147]
    s_add_u32 m0, s92, 4096
    ds_read_b64_tr_b16 a[0:1], v16 offset:8192
    ds_read_b64_tr_b16 a[2:3], v16 offset:10240
    v_mfma_f32_16x16x32_bf16 v[144:147], a[12:15], a[208:211], v[144:147]
    buffer_load_dwordx4 v26, s[20:23], s47 offen offset:0 lds
    v_mfma_f32_16x16x32_bf16 v[148:151], a[8:11], a[196:199], v[148:151]
    s_add_u32 s46, s72, 32768
    ds_read_b64_tr_b16 a[4:5], v16 offset:12288
    ds_read_b64_tr_b16 a[6:7], v16 offset:14336
    v_mfma_f32_16x16x32_bf16 v[148:151], a[12:15], a[212:215], v[148:151]
    buffer_load_dwordx4 v27, s[20:23], s47 offen offset:1024 lds
    v_mfma_f32_16x16x32_bf16 v[152:155], a[8:11], a[200:203], v[152:155]
    s_xor_b32 s46, s46, 128
    ds_read_b128 a[132:135], v54 offset:25600
    v_mfma_f32_16x16x32_bf16 v[152:155], a[12:15], a[216:219], v[152:155]
    buffer_load_dwordx4 v28, s[20:23], s47 offen offset:2048 lds
    v_mfma_f32_16x16x32_bf16 v[156:159], a[8:11], a[204:207], v[156:159]
    buffer_load_dwordx4 v29, s[20:23], s47 offen offset:3072 lds
    v_mfma_f32_16x16x32_bf16 v[156:159], a[12:15], a[220:223], v[156:159]
    s_waitcnt lgkmcnt(1)
    v_mfma_f32_16x16x32_bf16 v[160:163], a[0:3], a[192:195], v[160:163]
    ds_read_b64_tr_b16 a[8:9], v17 offset:8192
    ds_read_b64_tr_b16 a[10:11], v17 offset:10240
    v_mfma_f32_16x16x32_bf16 v[160:163], a[4:7], a[208:211], v[160:163]
    v_mfma_f32_16x16x32_bf16 v[164:167], a[0:3], a[196:199], v[164:167]
    ds_read_b64_tr_b16 a[12:13], v17 offset:12288
    ds_read_b64_tr_b16 a[14:15], v17 offset:14336
    v_mfma_f32_16x16x32_bf16 v[164:167], a[4:7], a[212:215], v[164:167]
    v_mfma_f32_16x16x32_bf16 v[168:171], a[0:3], a[200:203], v[168:171]
    ds_read_b128 a[136:139], v54 offset:26624
    v_mfma_f32_16x16x32_bf16 v[168:171], a[4:7], a[216:219], v[168:171]
    v_mfma_f32_16x16x32_bf16 v[172:175], a[0:3], a[204:207], v[172:175]
    v_mfma_f32_16x16x32_bf16 v[172:175], a[4:7], a[220:223], v[172:175]
    s_waitcnt vmcnt(8) lgkmcnt(1)
    v_mfma_f32_16x16x32_bf16 v[176:179], a[8:11], a[192:195], v[176:179]
    ds_read_b64_tr_b16 a[0:1], v22 offset:16384
    ds_read_b64_tr_b16 a[2:3], v22 offset:18432
    v_mfma_f32_16x16x32_bf16 v[176:179], a[12:15], a[208:211], v[176:179]
    v_mfma_f32_16x16x32_bf16 v[180:183], a[8:11], a[196:199], v[180:183]
    ds_read_b64_tr_b16 a[4:5], v22 offset:0
    ds_read_b64_tr_b16 a[6:7], v22 offset:2048
    v_mfma_f32_16x16x32_bf16 v[180:183], a[12:15], a[212:215], v[180:183]
    v_mfma_f32_16x16x32_bf16 v[184:187], a[8:11], a[200:203], v[184:187]
    ds_read_b128 a[140:143], v54 offset:27648
    v_mfma_f32_16x16x32_bf16 v[184:187], a[12:15], a[216:219], v[184:187]
    v_mfma_f32_16x16x32_bf16 v[188:191], a[8:11], a[204:207], v[188:191]
    v_mfma_f32_16x16x32_bf16 v[188:191], a[12:15], a[220:223], v[188:191]
    s_waitcnt lgkmcnt(1)
    v_mfma_f32_16x16x32_bf16 v[192:195], a[0:3], a[192:195], v[192:195]
    s_add_u32 m0, s92, 8192
    ds_read_b64_tr_b16 a[8:9], v23 offset:16384
    ds_read_b64_tr_b16 a[10:11], v23 offset:18432
    v_mfma_f32_16x16x32_bf16 v[192:195], a[4:7], a[208:211], v[192:195]
    buffer_load_dwordx4 v26, s[20:23], s46 offen offset:0 lds
    v_mfma_f32_16x16x32_bf16 v[196:199], a[0:3], a[196:199], v[196:199]
    s_add_u32 s47, s73, 32768
    ds_read_b64_tr_b16 a[12:13], v23 offset:0
    ds_read_b64_tr_b16 a[14:15], v23 offset:2048
    v_mfma_f32_16x16x32_bf16 v[196:199], a[4:7], a[212:215], v[196:199]
    buffer_load_dwordx4 v27, s[20:23], s46 offen offset:1024 lds
    v_mfma_f32_16x16x32_bf16 v[200:203], a[0:3], a[200:203], v[200:203]
    s_xor_b32 s47, s47, 128
    ds_read_b128 a[144:147], v54 offset:28672
    v_mfma_f32_16x16x32_bf16 v[200:203], a[4:7], a[216:219], v[200:203]
    buffer_load_dwordx4 v28, s[20:23], s46 offen offset:2048 lds
    v_mfma_f32_16x16x32_bf16 v[204:207], a[0:3], a[204:207], v[204:207]
    buffer_load_dwordx4 v29, s[20:23], s46 offen offset:3072 lds
    v_mfma_f32_16x16x32_bf16 v[204:207], a[4:7], a[220:223], v[204:207]
    s_waitcnt lgkmcnt(1)
    v_mfma_f32_16x16x32_bf16 v[208:211], a[8:11], a[192:195], v[208:211]
    s_add_u32 m0, s92, 12288
    ds_read_b64_tr_b16 a[0:1], v24 offset:16384
    ds_read_b64_tr_b16 a[2:3], v24 offset:18432
    v_mfma_f32_16x16x32_bf16 v[208:211], a[12:15], a[208:211], v[208:211]
    buffer_load_dwordx4 v26, s[20:23], s47 offen offset:0 lds
    v_mfma_f32_16x16x32_bf16 v[212:215], a[8:11], a[196:199], v[212:215]
    s_add_u32 s46, s70, 65536
    ds_read_b64_tr_b16 a[4:5], v24 offset:0
    ds_read_b64_tr_b16 a[6:7], v24 offset:2048
    v_mfma_f32_16x16x32_bf16 v[212:215], a[12:15], a[212:215], v[212:215]
    buffer_load_dwordx4 v27, s[20:23], s47 offen offset:1024 lds
    v_mfma_f32_16x16x32_bf16 v[216:219], a[8:11], a[200:203], v[216:219]
    ds_read_b128 a[148:151], v54 offset:29696
    v_mfma_f32_16x16x32_bf16 v[216:219], a[12:15], a[216:219], v[216:219]
    buffer_load_dwordx4 v28, s[20:23], s47 offen offset:2048 lds
    v_mfma_f32_16x16x32_bf16 v[220:223], a[8:11], a[204:207], v[220:223]
    buffer_load_dwordx4 v29, s[20:23], s47 offen offset:3072 lds
    v_mfma_f32_16x16x32_bf16 v[220:223], a[12:15], a[220:223], v[220:223]
    s_waitcnt lgkmcnt(1)
    v_mfma_f32_16x16x32_bf16 v[224:227], a[0:3], a[192:195], v[224:227]
    ds_read_b64_tr_b16 a[8:9], v25 offset:16384
    ds_read_b64_tr_b16 a[10:11], v25 offset:18432
    v_mfma_f32_16x16x32_bf16 v[224:227], a[4:7], a[208:211], v[224:227]
    v_mfma_f32_16x16x32_bf16 v[228:231], a[0:3], a[196:199], v[228:231]
    ds_read_b64_tr_b16 a[12:13], v25 offset:0
    ds_read_b64_tr_b16 a[14:15], v25 offset:2048
    v_mfma_f32_16x16x32_bf16 v[228:231], a[4:7], a[212:215], v[228:231]
    v_mfma_f32_16x16x32_bf16 v[232:235], a[0:3], a[200:203], v[232:235]
    ds_read_b128 a[152:155], v54 offset:30720
    v_mfma_f32_16x16x32_bf16 v[232:235], a[4:7], a[216:219], v[232:235]
    v_mfma_f32_16x16x32_bf16 v[236:239], a[0:3], a[204:207], v[236:239]
    v_mfma_f32_16x16x32_bf16 v[236:239], a[4:7], a[220:223], v[236:239]
    s_waitcnt vmcnt(8) lgkmcnt(1)
    v_mfma_f32_16x16x32_bf16 v[240:243], a[8:11], a[192:195], v[240:243]
    ds_read_b64_tr_b16 a[0:1], v14 offset:0
    ds_read_b64_tr_b16 a[2:3], v14 offset:2048
    v_mfma_f32_16x16x32_bf16 v[240:243], a[12:15], a[208:211], v[240:243]
    v_mfma_f32_16x16x32_bf16 v[244:247], a[8:11], a[196:199], v[244:247]
    ds_read_b64_tr_b16 a[4:5], v14 offset:4096
    ds_read_b64_tr_b16 a[6:7], v14 offset:6144
    v_mfma_f32_16x16x32_bf16 v[244:247], a[12:15], a[212:215], v[244:247]
    v_mfma_f32_16x16x32_bf16 v[248:251], a[8:11], a[200:203], v[248:251]
    ds_read_b128 a[156:159], v54 offset:31744
    v_mfma_f32_16x16x32_bf16 v[248:251], a[12:15], a[216:219], v[248:251]
    v_mfma_f32_16x16x32_bf16 v[252:255], a[8:11], a[204:207], v[252:255]
    v_mfma_f32_16x16x32_bf16 v[252:255], a[12:15], a[220:223], v[252:255]
    s_waitcnt lgkmcnt(0)
    v_mfma_f32_16x16x32_bf16 v[128:131], a[0:3], a[128:131], v[128:131]
    s_add_u32 m0, s93, 16384
    ds_read_b64_tr_b16 a[8:9], v15 offset:0
    ds_read_b64_tr_b16 a[10:11], v15 offset:2048
    v_mfma_f32_16x16x32_bf16 v[128:131], a[4:7], a[144:147], v[128:131]
    buffer_load_dwordx4 v26, s[20:23], s46 offen offset:0 lds
    v_mfma_f32_16x16x32_bf16 v[132:135], a[0:3], a[132:135], v[132:135]
    s_add_u32 s47, s71, 65536
    ds_read_b64_tr_b16 a[12:13], v15 offset:4096
    ds_read_b64_tr_b16 a[14:15], v15 offset:6144
    v_mfma_f32_16x16x32_bf16 v[132:135], a[4:7], a[148:151], v[132:135]
    buffer_load_dwordx4 v27, s[20:23], s46 offen offset:1024 lds
    v_mfma_f32_16x16x32_bf16 v[136:139], a[0:3], a[136:139], v[136:139]
    ds_read_b128 a[160:163], v54 offset:32768
    v_mfma_f32_16x16x32_bf16 v[136:139], a[4:7], a[152:155], v[136:139]
    buffer_load_dwordx4 v28, s[20:23], s46 offen offset:2048 lds
    v_mfma_f32_16x16x32_bf16 v[140:143], a[0:3], a[140:143], v[140:143]
    buffer_load_dwordx4 v29, s[20:23], s46 offen offset:3072 lds
    v_mfma_f32_16x16x32_bf16 v[140:143], a[4:7], a[156:159], v[140:143]
    s_waitcnt lgkmcnt(1)
    v_mfma_f32_16x16x32_bf16 v[144:147], a[8:11], a[128:131], v[144:147]
    s_add_u32 m0, s93, 0
    ds_read_b64_tr_b16 a[0:1], v16 offset:0
    ds_read_b64_tr_b16 a[2:3], v16 offset:2048
    v_mfma_f32_16x16x32_bf16 v[144:147], a[12:15], a[144:147], v[144:147]
    buffer_load_dwordx4 v26, s[20:23], s47 offen offset:0 lds
    v_mfma_f32_16x16x32_bf16 v[148:151], a[8:11], a[132:135], v[148:151]
    s_add_u32 s46, s70, 65536
    ds_read_b64_tr_b16 a[4:5], v16 offset:4096
    ds_read_b64_tr_b16 a[6:7], v16 offset:6144
    v_mfma_f32_16x16x32_bf16 v[148:151], a[12:15], a[148:151], v[148:151]
    buffer_load_dwordx4 v27, s[20:23], s47 offen offset:1024 lds
    v_mfma_f32_16x16x32_bf16 v[152:155], a[8:11], a[136:139], v[152:155]
    s_xor_b32 s46, s46, 128
    ds_read_b128 a[164:167], v54 offset:33792
    v_mfma_f32_16x16x32_bf16 v[152:155], a[12:15], a[152:155], v[152:155]
    buffer_load_dwordx4 v28, s[20:23], s47 offen offset:2048 lds
    v_mfma_f32_16x16x32_bf16 v[156:159], a[8:11], a[140:143], v[156:159]
    buffer_load_dwordx4 v29, s[20:23], s47 offen offset:3072 lds
    v_mfma_f32_16x16x32_bf16 v[156:159], a[12:15], a[156:159], v[156:159]
    s_waitcnt lgkmcnt(1)
    v_mfma_f32_16x16x32_bf16 v[160:163], a[0:3], a[128:131], v[160:163]
    ds_read_b64_tr_b16 a[8:9], v17 offset:0
    ds_read_b64_tr_b16 a[10:11], v17 offset:2048
    v_mfma_f32_16x16x32_bf16 v[160:163], a[4:7], a[144:147], v[160:163]
    v_mfma_f32_16x16x32_bf16 v[164:167], a[0:3], a[132:135], v[164:167]
    ds_read_b64_tr_b16 a[12:13], v17 offset:4096
    ds_read_b64_tr_b16 a[14:15], v17 offset:6144
    v_mfma_f32_16x16x32_bf16 v[164:167], a[4:7], a[148:151], v[164:167]
    v_mfma_f32_16x16x32_bf16 v[168:171], a[0:3], a[136:139], v[168:171]
    ds_read_b128 a[168:171], v54 offset:34816
    v_mfma_f32_16x16x32_bf16 v[168:171], a[4:7], a[152:155], v[168:171]
    v_mfma_f32_16x16x32_bf16 v[172:175], a[0:3], a[140:143], v[172:175]
    v_mfma_f32_16x16x32_bf16 v[172:175], a[4:7], a[156:159], v[172:175]
    s_waitcnt vmcnt(8) lgkmcnt(1)
    v_mfma_f32_16x16x32_bf16 v[176:179], a[8:11], a[128:131], v[176:179]
    ds_read_b64_tr_b16 a[0:1], v30 offset:8192
    ds_read_b64_tr_b16 a[2:3], v30 offset:10240
    v_mfma_f32_16x16x32_bf16 v[176:179], a[12:15], a[144:147], v[176:179]
    v_mfma_f32_16x16x32_bf16 v[180:183], a[8:11], a[132:135], v[180:183]
    ds_read_b64_tr_b16 a[4:5], v30 offset:12288
    ds_read_b64_tr_b16 a[6:7], v30 offset:14336
    v_mfma_f32_16x16x32_bf16 v[180:183], a[12:15], a[148:151], v[180:183]
    v_mfma_f32_16x16x32_bf16 v[184:187], a[8:11], a[136:139], v[184:187]
    ds_read_b128 a[172:175], v54 offset:35840
    v_mfma_f32_16x16x32_bf16 v[184:187], a[12:15], a[152:155], v[184:187]
    v_mfma_f32_16x16x32_bf16 v[188:191], a[8:11], a[140:143], v[188:191]
    v_mfma_f32_16x16x32_bf16 v[188:191], a[12:15], a[156:159], v[188:191]
    s_waitcnt lgkmcnt(1)
    v_mfma_f32_16x16x32_bf16 v[192:195], a[0:3], a[128:131], v[192:195]
    s_add_u32 m0, s92, 0
    ds_read_b64_tr_b16 a[8:9], v31 offset:8192
    ds_read_b64_tr_b16 a[10:11], v31 offset:10240
    v_mfma_f32_16x16x32_bf16 v[192:195], a[4:7], a[144:147], v[192:195]
    buffer_load_dwordx4 v26, s[20:23], s46 offen offset:0 lds
    v_mfma_f32_16x16x32_bf16 v[196:199], a[0:3], a[132:135], v[196:199]
    s_add_u32 s47, s71, 65536
    ds_read_b64_tr_b16 a[12:13], v31 offset:12288
    ds_read_b64_tr_b16 a[14:15], v31 offset:14336
    v_mfma_f32_16x16x32_bf16 v[196:199], a[4:7], a[148:151], v[196:199]
    buffer_load_dwordx4 v27, s[20:23], s46 offen offset:1024 lds
    v_mfma_f32_16x16x32_bf16 v[200:203], a[0:3], a[136:139], v[200:203]
    s_xor_b32 s47, s47, 128
    ds_read_b128 a[176:179], v54 offset:36864
    v_mfma_f32_16x16x32_bf16 v[200:203], a[4:7], a[152:155], v[200:203]
    buffer_load_dwordx4 v28, s[20:23], s46 offen offset:2048 lds
    v_mfma_f32_16x16x32_bf16 v[204:207], a[0:3], a[140:143], v[204:207]
    buffer_load_dwordx4 v29, s[20:23], s46 offen offset:3072 lds
    v_mfma_f32_16x16x32_bf16 v[204:207], a[4:7], a[156:159], v[204:207]
    s_waitcnt lgkmcnt(1)
    v_mfma_f32_16x16x32_bf16 v[208:211], a[8:11], a[128:131], v[208:211]
    s_add_u32 m0, s92, 4096
    ds_read_b64_tr_b16 a[0:1], v32 offset:8192
    ds_read_b64_tr_b16 a[2:3], v32 offset:10240
    v_mfma_f32_16x16x32_bf16 v[208:211], a[12:15], a[144:147], v[208:211]
    buffer_load_dwordx4 v26, s[20:23], s47 offen offset:0 lds
    v_mfma_f32_16x16x32_bf16 v[212:215], a[8:11], a[132:135], v[212:215]
    s_add_u32 s46, s72, 65536
    ds_read_b64_tr_b16 a[4:5], v32 offset:12288
    ds_read_b64_tr_b16 a[6:7], v32 offset:14336
    v_mfma_f32_16x16x32_bf16 v[212:215], a[12:15], a[148:151], v[212:215]
    buffer_load_dwordx4 v27, s[20:23], s47 offen offset:1024 lds
    v_mfma_f32_16x16x32_bf16 v[216:219], a[8:11], a[136:139], v[216:219]
    ds_read_b128 a[180:183], v54 offset:37888
    v_mfma_f32_16x16x32_bf16 v[216:219], a[12:15], a[152:155], v[216:219]
    buffer_load_dwordx4 v28, s[20:23], s47 offen offset:2048 lds
    v_mfma_f32_16x16x32_bf16 v[220:223], a[8:11], a[140:143], v[220:223]
    buffer_load_dwordx4 v29, s[20:23], s47 offen offset:3072 lds
    v_mfma_f32_16x16x32_bf16 v[220:223], a[12:15], a[156:159], v[220:223]
    s_waitcnt lgkmcnt(1)
    v_mfma_f32_16x16x32_bf16 v[224:227], a[0:3], a[128:131], v[224:227]
    ds_read_b64_tr_b16 a[8:9], v33 offset:8192
    ds_read_b64_tr_b16 a[10:11], v33 offset:10240
    v_mfma_f32_16x16x32_bf16 v[224:227], a[4:7], a[144:147], v[224:227]
    v_mfma_f32_16x16x32_bf16 v[228:231], a[0:3], a[132:135], v[228:231]
    ds_read_b64_tr_b16 a[12:13], v33 offset:12288
    ds_read_b64_tr_b16 a[14:15], v33 offset:14336
    v_mfma_f32_16x16x32_bf16 v[228:231], a[4:7], a[148:151], v[228:231]
    v_mfma_f32_16x16x32_bf16 v[232:235], a[0:3], a[136:139], v[232:235]
    ds_read_b128 a[184:187], v54 offset:38912
    v_mfma_f32_16x16x32_bf16 v[232:235], a[4:7], a[152:155], v[232:235]
    v_mfma_f32_16x16x32_bf16 v[236:239], a[0:3], a[140:143], v[236:239]
    v_mfma_f32_16x16x32_bf16 v[236:239], a[4:7], a[156:159], v[236:239]
    s_waitcnt vmcnt(8) lgkmcnt(1)
    v_mfma_f32_16x16x32_bf16 v[240:243], a[8:11], a[128:131], v[240:243]
    ds_read_b64_tr_b16 a[0:1], v10 offset:16384
    ds_read_b64_tr_b16 a[2:3], v10 offset:18432
    v_mfma_f32_16x16x32_bf16 v[240:243], a[12:15], a[144:147], v[240:243]
    v_mfma_f32_16x16x32_bf16 v[244:247], a[8:11], a[132:135], v[244:247]
    ds_read_b64_tr_b16 a[4:5], v10 offset:0
    ds_read_b64_tr_b16 a[6:7], v10 offset:2048
    v_mfma_f32_16x16x32_bf16 v[244:247], a[12:15], a[148:151], v[244:247]
    v_mfma_f32_16x16x32_bf16 v[248:251], a[8:11], a[136:139], v[248:251]
    ds_read_b128 a[188:191], v54 offset:39936
    v_mfma_f32_16x16x32_bf16 v[248:251], a[12:15], a[152:155], v[248:251]
    v_mfma_f32_16x16x32_bf16 v[252:255], a[8:11], a[140:143], v[252:255]
    v_mfma_f32_16x16x32_bf16 v[252:255], a[12:15], a[156:159], v[252:255]
    s_waitcnt lgkmcnt(0)
    v_mfma_f32_16x16x32_bf16 v[128:131], a[0:3], a[160:163], v[128:131]
    s_add_u32 m0, s92, 8192
    ds_read_b64_tr_b16 a[8:9], v11 offset:16384
    ds_read_b64_tr_b16 a[10:11], v11 offset:18432
    v_mfma_f32_16x16x32_bf16 v[128:131], a[4:7], a[176:179], v[128:131]
    buffer_load_dwordx4 v26, s[20:23], s46 offen offset:0 lds
    v_mfma_f32_16x16x32_bf16 v[132:135], a[0:3], a[164:167], v[132:135]
    s_add_u32 s47, s73, 65536
    ds_read_b64_tr_b16 a[12:13], v11 offset:0
    ds_read_b64_tr_b16 a[14:15], v11 offset:2048
    v_mfma_f32_16x16x32_bf16 v[132:135], a[4:7], a[180:183], v[132:135]
    buffer_load_dwordx4 v27, s[20:23], s46 offen offset:1024 lds
    v_mfma_f32_16x16x32_bf16 v[136:139], a[0:3], a[168:171], v[136:139]
    ds_read_b128 a[192:195], v54 offset:40960
    v_mfma_f32_16x16x32_bf16 v[136:139], a[4:7], a[184:187], v[136:139]
    buffer_load_dwordx4 v28, s[20:23], s46 offen offset:2048 lds
    v_mfma_f32_16x16x32_bf16 v[140:143], a[0:3], a[172:175], v[140:143]
    buffer_load_dwordx4 v29, s[20:23], s46 offen offset:3072 lds
    v_mfma_f32_16x16x32_bf16 v[140:143], a[4:7], a[188:191], v[140:143]
    s_waitcnt lgkmcnt(1)
    v_mfma_f32_16x16x32_bf16 v[144:147], a[8:11], a[160:163], v[144:147]
    s_add_u32 m0, s92, 12288
    ds_read_b64_tr_b16 a[0:1], v12 offset:16384
    ds_read_b64_tr_b16 a[2:3], v12 offset:18432
    v_mfma_f32_16x16x32_bf16 v[144:147], a[12:15], a[176:179], v[144:147]
    buffer_load_dwordx4 v26, s[20:23], s47 offen offset:0 lds
    v_mfma_f32_16x16x32_bf16 v[148:151], a[8:11], a[164:167], v[148:151]
    s_add_u32 s46, s70, 98304
    ds_read_b64_tr_b16 a[4:5], v12 offset:0
    ds_read_b64_tr_b16 a[6:7], v12 offset:2048
    v_mfma_f32_16x16x32_bf16 v[148:151], a[12:15], a[180:183], v[148:151]
    buffer_load_dwordx4 v27, s[20:23], s47 offen offset:1024 lds
    v_mfma_f32_16x16x32_bf16 v[152:155], a[8:11], a[168:171], v[152:155]
    ds_read_b128 a[196:199], v54 offset:41984
    v_mfma_f32_16x16x32_bf16 v[152:155], a[12:15], a[184:187], v[152:155]
    buffer_load_dwordx4 v28, s[20:23], s47 offen offset:2048 lds
    v_mfma_f32_16x16x32_bf16 v[156:159], a[8:11], a[172:175], v[156:159]
    buffer_load_dwordx4 v29, s[20:23], s47 offen offset:3072 lds
    v_mfma_f32_16x16x32_bf16 v[156:159], a[12:15], a[188:191], v[156:159]
    s_waitcnt lgkmcnt(1)
    v_mfma_f32_16x16x32_bf16 v[160:163], a[0:3], a[160:163], v[160:163]
    ds_read_b64_tr_b16 a[8:9], v13 offset:16384
    ds_read_b64_tr_b16 a[10:11], v13 offset:18432
    v_mfma_f32_16x16x32_bf16 v[160:163], a[4:7], a[176:179], v[160:163]
    v_mfma_f32_16x16x32_bf16 v[164:167], a[0:3], a[164:167], v[164:167]
    ds_read_b64_tr_b16 a[12:13], v13 offset:0
    ds_read_b64_tr_b16 a[14:15], v13 offset:2048
    v_mfma_f32_16x16x32_bf16 v[164:167], a[4:7], a[180:183], v[164:167]
    v_mfma_f32_16x16x32_bf16 v[168:171], a[0:3], a[168:171], v[168:171]
    ds_read_b128 a[200:203], v54 offset:43008
    v_mfma_f32_16x16x32_bf16 v[168:171], a[4:7], a[184:187], v[168:171]
    v_mfma_f32_16x16x32_bf16 v[172:175], a[0:3], a[172:175], v[172:175]
    v_mfma_f32_16x16x32_bf16 v[172:175], a[4:7], a[188:191], v[172:175]
    s_waitcnt vmcnt(8) lgkmcnt(1)
    v_mfma_f32_16x16x32_bf16 v[176:179], a[8:11], a[160:163], v[176:179]
    ds_read_b64_tr_b16 a[0:1], v30 offset:0
    ds_read_b64_tr_b16 a[2:3], v30 offset:2048
    v_mfma_f32_16x16x32_bf16 v[176:179], a[12:15], a[176:179], v[176:179]
    v_mfma_f32_16x16x32_bf16 v[180:183], a[8:11], a[164:167], v[180:183]
    ds_read_b64_tr_b16 a[4:5], v30 offset:4096
    ds_read_b64_tr_b16 a[6:7], v30 offset:6144
    v_mfma_f32_16x16x32_bf16 v[180:183], a[12:15], a[180:183], v[180:183]
    v_mfma_f32_16x16x32_bf16 v[184:187], a[8:11], a[168:171], v[184:187]
    ds_read_b128 a[204:207], v54 offset:44032
    v_mfma_f32_16x16x32_bf16 v[184:187], a[12:15], a[184:187], v[184:187]
    v_mfma_f32_16x16x32_bf16 v[188:191], a[8:11], a[172:175], v[188:191]
    v_mfma_f32_16x16x32_bf16 v[188:191], a[12:15], a[188:191], v[188:191]
    s_waitcnt lgkmcnt(1)
    v_mfma_f32_16x16x32_bf16 v[192:195], a[0:3], a[160:163], v[192:195]
    s_add_u32 m0, s93, 16384
    ds_read_b64_tr_b16 a[8:9], v31 offset:0
    ds_read_b64_tr_b16 a[10:11], v31 offset:2048
    v_mfma_f32_16x16x32_bf16 v[192:195], a[4:7], a[176:179], v[192:195]
    buffer_load_dwordx4 v26, s[20:23], s46 offen offset:0 lds
    v_mfma_f32_16x16x32_bf16 v[196:199], a[0:3], a[164:167], v[196:199]
    s_add_u32 s47, s71, 98304
    ds_read_b64_tr_b16 a[12:13], v31 offset:4096
    ds_read_b64_tr_b16 a[14:15], v31 offset:6144
    v_mfma_f32_16x16x32_bf16 v[196:199], a[4:7], a[180:183], v[196:199]
    buffer_load_dwordx4 v27, s[20:23], s46 offen offset:1024 lds
    v_mfma_f32_16x16x32_bf16 v[200:203], a[0:3], a[168:171], v[200:203]
    ds_read_b128 a[208:211], v54 offset:45056
    v_mfma_f32_16x16x32_bf16 v[200:203], a[4:7], a[184:187], v[200:203]
    buffer_load_dwordx4 v28, s[20:23], s46 offen offset:2048 lds
    v_mfma_f32_16x16x32_bf16 v[204:207], a[0:3], a[172:175], v[204:207]
    buffer_load_dwordx4 v29, s[20:23], s46 offen offset:3072 lds
    v_mfma_f32_16x16x32_bf16 v[204:207], a[4:7], a[188:191], v[204:207]
    s_waitcnt lgkmcnt(1)
    v_mfma_f32_16x16x32_bf16 v[208:211], a[8:11], a[160:163], v[208:211]
    s_add_u32 m0, s93, 0
    ds_read_b64_tr_b16 a[0:1], v32 offset:0
    ds_read_b64_tr_b16 a[2:3], v32 offset:2048
    v_mfma_f32_16x16x32_bf16 v[208:211], a[12:15], a[176:179], v[208:211]
    buffer_load_dwordx4 v26, s[20:23], s47 offen offset:0 lds
    v_mfma_f32_16x16x32_bf16 v[212:215], a[8:11], a[164:167], v[212:215]
    s_add_u32 s46, s72, 98304
    ds_read_b64_tr_b16 a[4:5], v32 offset:4096
    ds_read_b64_tr_b16 a[6:7], v32 offset:6144
    v_mfma_f32_16x16x32_bf16 v[212:215], a[12:15], a[180:183], v[212:215]
    buffer_load_dwordx4 v27, s[20:23], s47 offen offset:1024 lds
    v_mfma_f32_16x16x32_bf16 v[216:219], a[8:11], a[168:171], v[216:219]
    ds_read_b128 a[212:215], v54 offset:46080
    v_mfma_f32_16x16x32_bf16 v[216:219], a[12:15], a[184:187], v[216:219]
    buffer_load_dwordx4 v28, s[20:23], s47 offen offset:2048 lds
    v_mfma_f32_16x16x32_bf16 v[220:223], a[8:11], a[172:175], v[220:223]
    buffer_load_dwordx4 v29, s[20:23], s47 offen offset:3072 lds
    v_mfma_f32_16x16x32_bf16 v[220:223], a[12:15], a[188:191], v[220:223]
    s_waitcnt lgkmcnt(1)
    v_mfma_f32_16x16x32_bf16 v[224:227], a[0:3], a[160:163], v[224:227]
    ds_read_b64_tr_b16 a[8:9], v33 offset:0
    ds_read_b64_tr_b16 a[10:11], v33 offset:2048
    v_mfma_f32_16x16x32_bf16 v[224:227], a[4:7], a[176:179], v[224:227]
    v_mfma_f32_16x16x32_bf16 v[228:231], a[0:3], a[164:167], v[228:231]
    ds_read_b64_tr_b16 a[12:13], v33 offset:4096
    ds_read_b64_tr_b16 a[14:15], v33 offset:6144
    v_mfma_f32_16x16x32_bf16 v[228:231], a[4:7], a[180:183], v[228:231]
    v_mfma_f32_16x16x32_bf16 v[232:235], a[0:3], a[168:171], v[232:235]
    ds_read_b128 a[216:219], v54 offset:47104
    v_mfma_f32_16x16x32_bf16 v[232:235], a[4:7], a[184:187], v[232:235]
    v_mfma_f32_16x16x32_bf16 v[236:239], a[0:3], a[172:175], v[236:239]
    v_mfma_f32_16x16x32_bf16 v[236:239], a[4:7], a[188:191], v[236:239]
    s_waitcnt vmcnt(8) lgkmcnt(1)
    v_mfma_f32_16x16x32_bf16 v[240:243], a[8:11], a[160:163], v[240:243]
    ds_read_b64_tr_b16 a[0:1], v14 offset:8192
    ds_read_b64_tr_b16 a[2:3], v14 offset:10240
    v_mfma_f32_16x16x32_bf16 v[240:243], a[12:15], a[176:179], v[240:243]
    v_mfma_f32_16x16x32_bf16 v[244:247], a[8:11], a[164:167], v[244:247]
    ds_read_b64_tr_b16 a[4:5], v14 offset:12288
    ds_read_b64_tr_b16 a[6:7], v14 offset:14336
    v_mfma_f32_16x16x32_bf16 v[244:247], a[12:15], a[180:183], v[244:247]
    v_mfma_f32_16x16x32_bf16 v[248:251], a[8:11], a[168:171], v[248:251]
    ds_read_b128 a[220:223], v54 offset:48128
    v_mfma_f32_16x16x32_bf16 v[248:251], a[12:15], a[184:187], v[248:251]
    v_mfma_f32_16x16x32_bf16 v[252:255], a[8:11], a[172:175], v[252:255]
    v_mfma_f32_16x16x32_bf16 v[252:255], a[12:15], a[188:191], v[252:255]
    s_waitcnt lgkmcnt(0)
    v_mfma_f32_16x16x32_bf16 v[128:131], a[0:3], a[192:195], v[128:131]
    s_add_u32 m0, s92, 0
    ds_read_b64_tr_b16 a[8:9], v15 offset:8192
    ds_read_b64_tr_b16 a[10:11], v15 offset:10240
    v_mfma_f32_16x16x32_bf16 v[128:131], a[4:7], a[208:211], v[128:131]
    buffer_load_dwordx4 v26, s[20:23], s46 offen offset:0 lds
    v_mfma_f32_16x16x32_bf16 v[132:135], a[0:3], a[196:199], v[132:135]
    s_add_u32 s47, s73, 98304
    ds_read_b64_tr_b16 a[12:13], v15 offset:12288
    ds_read_b64_tr_b16 a[14:15], v15 offset:14336
    v_mfma_f32_16x16x32_bf16 v[132:135], a[4:7], a[212:215], v[132:135]
    buffer_load_dwordx4 v27, s[20:23], s46 offen offset:1024 lds
    v_mfma_f32_16x16x32_bf16 v[136:139], a[0:3], a[200:203], v[136:139]
    ds_read_b128 a[128:131], v54 offset:49152
    ds_read_b128 a[132:135], v54 offset:50176
    v_mfma_f32_16x16x32_bf16 v[136:139], a[4:7], a[216:219], v[136:139]
    buffer_load_dwordx4 v28, s[20:23], s46 offen offset:2048 lds
    v_mfma_f32_16x16x32_bf16 v[140:143], a[0:3], a[204:207], v[140:143]
    buffer_load_dwordx4 v29, s[20:23], s46 offen offset:3072 lds
    v_mfma_f32_16x16x32_bf16 v[140:143], a[4:7], a[220:223], v[140:143]
    s_waitcnt lgkmcnt(2)
    v_mfma_f32_16x16x32_bf16 v[144:147], a[8:11], a[192:195], v[144:147]
    s_add_u32 m0, s92, 4096
    ds_read_b64_tr_b16 a[0:1], v16 offset:8192
    ds_read_b64_tr_b16 a[2:3], v16 offset:10240
    v_mfma_f32_16x16x32_bf16 v[144:147], a[12:15], a[208:211], v[144:147]
    buffer_load_dwordx4 v26, s[20:23], s47 offen offset:0 lds
    v_mfma_f32_16x16x32_bf16 v[148:151], a[8:11], a[196:199], v[148:151]
    s_add_u32 s46, s72, 65536
    ds_read_b64_tr_b16 a[4:5], v16 offset:12288
    ds_read_b64_tr_b16 a[6:7], v16 offset:14336
    v_mfma_f32_16x16x32_bf16 v[148:151], a[12:15], a[212:215], v[148:151]
    buffer_load_dwordx4 v27, s[20:23], s47 offen offset:1024 lds
    v_mfma_f32_16x16x32_bf16 v[152:155], a[8:11], a[200:203], v[152:155]
    s_xor_b32 s46, s46, 128
    ds_read_b128 a[136:139], v54 offset:51200
    ds_read_b128 a[140:143], v54 offset:52224
    v_mfma_f32_16x16x32_bf16 v[152:155], a[12:15], a[216:219], v[152:155]
    buffer_load_dwordx4 v28, s[20:23], s47 offen offset:2048 lds
    v_mfma_f32_16x16x32_bf16 v[156:159], a[8:11], a[204:207], v[156:159]
    buffer_load_dwordx4 v29, s[20:23], s47 offen offset:3072 lds
    v_mfma_f32_16x16x32_bf16 v[156:159], a[12:15], a[220:223], v[156:159]
    s_waitcnt lgkmcnt(2)
    v_mfma_f32_16x16x32_bf16 v[160:163], a[0:3], a[192:195], v[160:163]
    ds_read_b64_tr_b16 a[8:9], v17 offset:8192
    ds_read_b64_tr_b16 a[10:11], v17 offset:10240
    v_mfma_f32_16x16x32_bf16 v[160:163], a[4:7], a[208:211], v[160:163]
    v_mfma_f32_16x16x32_bf16 v[164:167], a[0:3], a[196:199], v[164:167]
    ds_read_b64_tr_b16 a[12:13], v17 offset:12288
    ds_read_b64_tr_b16 a[14:15], v17 offset:14336
    v_mfma_f32_16x16x32_bf16 v[164:167], a[4:7], a[212:215], v[164:167]
    v_mfma_f32_16x16x32_bf16 v[168:171], a[0:3], a[200:203], v[168:171]
    ds_read_b128 a[144:147], v54 offset:53248
    ds_read_b128 a[148:151], v54 offset:54272
    v_mfma_f32_16x16x32_bf16 v[168:171], a[4:7], a[216:219], v[168:171]
    v_mfma_f32_16x16x32_bf16 v[172:175], a[0:3], a[204:207], v[172:175]
    v_mfma_f32_16x16x32_bf16 v[172:175], a[4:7], a[220:223], v[172:175]
    s_waitcnt vmcnt(8) lgkmcnt(2)
    v_mfma_f32_16x16x32_bf16 v[176:179], a[8:11], a[192:195], v[176:179]
    ds_read_b64_tr_b16 a[0:1], v10 offset:16384
    ds_read_b64_tr_b16 a[2:3], v10 offset:18432
    v_mfma_f32_16x16x32_bf16 v[176:179], a[12:15], a[208:211], v[176:179]
    v_mfma_f32_16x16x32_bf16 v[180:183], a[8:11], a[196:199], v[180:183]
    ds_read_b64_tr_b16 a[4:5], v10 offset:0
    ds_read_b64_tr_b16 a[6:7], v10 offset:2048
    v_mfma_f32_16x16x32_bf16 v[180:183], a[12:15], a[212:215], v[180:183]
    v_mfma_f32_16x16x32_bf16 v[184:187], a[8:11], a[200:203], v[184:187]
    ds_read_b128 a[152:155], v54 offset:55296
    ds_read_b128 a[156:159], v54 offset:56320
    v_mfma_f32_16x16x32_bf16 v[184:187], a[12:15], a[216:219], v[184:187]
    v_mfma_f32_16x16x32_bf16 v[188:191], a[8:11], a[204:207], v[188:191]
    v_mfma_f32_16x16x32_bf16 v[188:191], a[12:15], a[220:223], v[188:191]
    s_waitcnt lgkmcnt(0)
    v_mfma_f32_16x16x32_bf16 v[128:131], a[0:3], a[128:131], v[128:131]
    s_add_u32 m0, s92, 8192
    ds_read_b64_tr_b16 a[8:9], v11 offset:16384
    ds_read_b64_tr_b16 a[10:11], v11 offset:18432
    v_mfma_f32_16x16x32_bf16 v[128:131], a[4:7], a[144:147], v[128:131]
    buffer_load_dwordx4 v26, s[20:23], s46 offen offset:0 lds
    v_mfma_f32_16x16x32_bf16 v[132:135], a[0:3], a[132:135], v[132:135]
    s_add_u32 s47, s73, 65536
    ds_read_b64_tr_b16 a[12:13], v11 offset:0
    ds_read_b64_tr_b16 a[14:15], v11 offset:2048
    v_mfma_f32_16x16x32_bf16 v[132:135], a[4:7], a[148:151], v[132:135]
    buffer_load_dwordx4 v27, s[20:23], s46 offen offset:1024 lds
    v_mfma_f32_16x16x32_bf16 v[136:139], a[0:3], a[136:139], v[136:139]
    s_xor_b32 s47, s47, 128
    ds_read_b128 a[160:163], v54 offset:57344
    ds_read_b128 a[164:167], v54 offset:58368
    v_mfma_f32_16x16x32_bf16 v[136:139], a[4:7], a[152:155], v[136:139]
    buffer_load_dwordx4 v28, s[20:23], s46 offen offset:2048 lds
    v_mfma_f32_16x16x32_bf16 v[140:143], a[0:3], a[140:143], v[140:143]
    buffer_load_dwordx4 v29, s[20:23], s46 offen offset:3072 lds
    v_mfma_f32_16x16x32_bf16 v[140:143], a[4:7], a[156:159], v[140:143]
    s_waitcnt lgkmcnt(2)
    v_mfma_f32_16x16x32_bf16 v[144:147], a[8:11], a[128:131], v[144:147]
    s_add_u32 m0, s92, 12288
    ds_read_b64_tr_b16 a[0:1], v12 offset:16384
    ds_read_b64_tr_b16 a[2:3], v12 offset:18432
    v_mfma_f32_16x16x32_bf16 v[144:147], a[12:15], a[144:147], v[144:147]
    buffer_load_dwordx4 v26, s[20:23], s47 offen offset:0 lds
    v_mfma_f32_16x16x32_bf16 v[148:151], a[8:11], a[132:135], v[148:151]
    s_add_u32 s46, s70, 98304
    ds_read_b64_tr_b16 a[4:5], v12 offset:0
    ds_read_b64_tr_b16 a[6:7], v12 offset:2048
    v_mfma_f32_16x16x32_bf16 v[148:151], a[12:15], a[148:151], v[148:151]
    buffer_load_dwordx4 v27, s[20:23], s47 offen offset:1024 lds
    v_mfma_f32_16x16x32_bf16 v[152:155], a[8:11], a[136:139], v[152:155]
    s_xor_b32 s46, s46, 128
    ds_read_b128 a[168:171], v54 offset:59392
    ds_read_b128 a[172:175], v54 offset:60416
    v_mfma_f32_16x16x32_bf16 v[152:155], a[12:15], a[152:155], v[152:155]
    buffer_load_dwordx4 v28, s[20:23], s47 offen offset:2048 lds
    v_mfma_f32_16x16x32_bf16 v[156:159], a[8:11], a[140:143], v[156:159]
    buffer_load_dwordx4 v29, s[20:23], s47 offen offset:3072 lds
    v_mfma_f32_16x16x32_bf16 v[156:159], a[12:15], a[156:159], v[156:159]
    s_waitcnt lgkmcnt(2)
    v_mfma_f32_16x16x32_bf16 v[160:163], a[0:3], a[128:131], v[160:163]
    ds_read_b64_tr_b16 a[8:9], v13 offset:16384
    ds_read_b64_tr_b16 a[10:11], v13 offset:18432
    v_mfma_f32_16x16x32_bf16 v[160:163], a[4:7], a[144:147], v[160:163]
    v_mfma_f32_16x16x32_bf16 v[164:167], a[0:3], a[132:135], v[164:167]
    ds_read_b64_tr_b16 a[12:13], v13 offset:0
    ds_read_b64_tr_b16 a[14:15], v13 offset:2048
    v_mfma_f32_16x16x32_bf16 v[164:167], a[4:7], a[148:151], v[164:167]
    v_mfma_f32_16x16x32_bf16 v[168:171], a[0:3], a[136:139], v[168:171]
    ds_read_b128 a[176:179], v54 offset:61440
    ds_read_b128 a[180:183], v54 offset:62464
    v_mfma_f32_16x16x32_bf16 v[168:171], a[4:7], a[152:155], v[168:171]
    v_mfma_f32_16x16x32_bf16 v[172:175], a[0:3], a[140:143], v[172:175]
    v_mfma_f32_16x16x32_bf16 v[172:175], a[4:7], a[156:159], v[172:175]
    s_waitcnt vmcnt(8) lgkmcnt(2)
    v_mfma_f32_16x16x32_bf16 v[176:179], a[8:11], a[128:131], v[176:179]
    ds_read_b64_tr_b16 a[0:1], v14 offset:0
    ds_read_b64_tr_b16 a[2:3], v14 offset:2048
    v_mfma_f32_16x16x32_bf16 v[176:179], a[12:15], a[144:147], v[176:179]
    v_mfma_f32_16x16x32_bf16 v[180:183], a[8:11], a[132:135], v[180:183]
    ds_read_b64_tr_b16 a[4:5], v14 offset:4096
    ds_read_b64_tr_b16 a[6:7], v14 offset:6144
    v_mfma_f32_16x16x32_bf16 v[180:183], a[12:15], a[148:151], v[180:183]
    v_mfma_f32_16x16x32_bf16 v[184:187], a[8:11], a[136:139], v[184:187]
    ds_read_b128 a[184:187], v54 offset:63488
    ds_read_b128 a[188:191], v54 offset:64512
    v_mfma_f32_16x16x32_bf16 v[184:187], a[12:15], a[152:155], v[184:187]
    v_mfma_f32_16x16x32_bf16 v[188:191], a[8:11], a[140:143], v[188:191]
    v_mfma_f32_16x16x32_bf16 v[188:191], a[12:15], a[156:159], v[188:191]
    s_waitcnt lgkmcnt(0)
    v_mfma_f32_16x16x32_bf16 v[128:131], a[0:3], a[160:163], v[128:131]
    s_add_u32 m0, s93, 16384
    ds_read_b64_tr_b16 a[8:9], v15 offset:0
    ds_read_b64_tr_b16 a[10:11], v15 offset:2048
    v_mfma_f32_16x16x32_bf16 v[128:131], a[4:7], a[176:179], v[128:131]
    buffer_load_dwordx4 v26, s[20:23], s46 offen offset:0 lds
    v_mfma_f32_16x16x32_bf16 v[132:135], a[0:3], a[164:167], v[132:135]
    s_add_u32 s47, s71, 98304
    ds_read_b64_tr_b16 a[12:13], v15 offset:4096
    ds_read_b64_tr_b16 a[14:15], v15 offset:6144
    v_mfma_f32_16x16x32_bf16 v[132:135], a[4:7], a[180:183], v[132:135]
    buffer_load_dwordx4 v27, s[20:23], s46 offen offset:1024 lds
    v_mfma_f32_16x16x32_bf16 v[136:139], a[0:3], a[168:171], v[136:139]
    s_xor_b32 s47, s47, 128
    ds_read_b128 a[192:195], v54 offset:40960
    ds_read_b128 a[196:199], v54 offset:41984
    v_mfma_f32_16x16x32_bf16 v[136:139], a[4:7], a[184:187], v[136:139]
    buffer_load_dwordx4 v28, s[20:23], s46 offen offset:2048 lds
    v_mfma_f32_16x16x32_bf16 v[140:143], a[0:3], a[172:175], v[140:143]
    buffer_load_dwordx4 v29, s[20:23], s46 offen offset:3072 lds
    v_mfma_f32_16x16x32_bf16 v[140:143], a[4:7], a[188:191], v[140:143]
    s_waitcnt lgkmcnt(2)
    v_mfma_f32_16x16x32_bf16 v[144:147], a[8:11], a[160:163], v[144:147]
    s_add_u32 m0, s93, 0
    ds_read_b64_tr_b16 a[0:1], v16 offset:0
    ds_read_b64_tr_b16 a[2:3], v16 offset:2048
    v_mfma_f32_16x16x32_bf16 v[144:147], a[12:15], a[176:179], v[144:147]
    buffer_load_dwordx4 v26, s[20:23], s47 offen offset:0 lds
    v_mfma_f32_16x16x32_bf16 v[148:151], a[8:11], a[164:167], v[148:151]
    s_add_u32 s46, s72, 98304
    ds_read_b64_tr_b16 a[4:5], v16 offset:4096
    ds_read_b64_tr_b16 a[6:7], v16 offset:6144
    v_mfma_f32_16x16x32_bf16 v[148:151], a[12:15], a[180:183], v[148:151]
    buffer_load_dwordx4 v27, s[20:23], s47 offen offset:1024 lds
    v_mfma_f32_16x16x32_bf16 v[152:155], a[8:11], a[168:171], v[152:155]
    s_xor_b32 s46, s46, 128
    ds_read_b128 a[200:203], v54 offset:43008
    ds_read_b128 a[204:207], v54 offset:44032
    v_mfma_f32_16x16x32_bf16 v[152:155], a[12:15], a[184:187], v[152:155]
    buffer_load_dwordx4 v28, s[20:23], s47 offen offset:2048 lds
    v_mfma_f32_16x16x32_bf16 v[156:159], a[8:11], a[172:175], v[156:159]
    buffer_load_dwordx4 v29, s[20:23], s47 offen offset:3072 lds
    v_mfma_f32_16x16x32_bf16 v[156:159], a[12:15], a[188:191], v[156:159]
    s_waitcnt lgkmcnt(2)
    v_mfma_f32_16x16x32_bf16 v[160:163], a[0:3], a[160:163], v[160:163]
    ds_read_b64_tr_b16 a[8:9], v17 offset:0
    ds_read_b64_tr_b16 a[10:11], v17 offset:2048
    v_mfma_f32_16x16x32_bf16 v[160:163], a[4:7], a[176:179], v[160:163]
    v_mfma_f32_16x16x32_bf16 v[164:167], a[0:3], a[164:167], v[164:167]
    ds_read_b64_tr_b16 a[12:13], v17 offset:4096
    ds_read_b64_tr_b16 a[14:15], v17 offset:6144
    v_mfma_f32_16x16x32_bf16 v[164:167], a[4:7], a[180:183], v[164:167]
    v_mfma_f32_16x16x32_bf16 v[168:171], a[0:3], a[168:171], v[168:171]
    ds_read_b128 a[208:211], v54 offset:45056
    ds_read_b128 a[212:215], v54 offset:46080
    v_mfma_f32_16x16x32_bf16 v[168:171], a[4:7], a[184:187], v[168:171]
    v_mfma_f32_16x16x32_bf16 v[172:175], a[0:3], a[172:175], v[172:175]
    v_mfma_f32_16x16x32_bf16 v[172:175], a[4:7], a[188:191], v[172:175]
    s_waitcnt vmcnt(8) lgkmcnt(2)
    v_mfma_f32_16x16x32_bf16 v[176:179], a[8:11], a[160:163], v[176:179]
    ds_read_b64_tr_b16 a[0:1], v30 offset:8192
    ds_read_b64_tr_b16 a[2:3], v30 offset:10240
    v_mfma_f32_16x16x32_bf16 v[176:179], a[12:15], a[176:179], v[176:179]
    v_mfma_f32_16x16x32_bf16 v[180:183], a[8:11], a[164:167], v[180:183]
    ds_read_b64_tr_b16 a[4:5], v30 offset:12288
    ds_read_b64_tr_b16 a[6:7], v30 offset:14336
    v_mfma_f32_16x16x32_bf16 v[180:183], a[12:15], a[180:183], v[180:183]
    v_mfma_f32_16x16x32_bf16 v[184:187], a[8:11], a[168:171], v[184:187]
    ds_read_b128 a[216:219], v54 offset:47104
    ds_read_b128 a[220:223], v54 offset:48128
    v_mfma_f32_16x16x32_bf16 v[184:187], a[12:15], a[184:187], v[184:187]
    v_mfma_f32_16x16x32_bf16 v[188:191], a[8:11], a[172:175], v[188:191]
    v_mfma_f32_16x16x32_bf16 v[188:191], a[12:15], a[188:191], v[188:191]
    s_waitcnt lgkmcnt(0)
    v_mfma_f32_16x16x32_bf16 v[192:195], a[0:3], a[192:195], v[192:195]
    s_add_u32 m0, s92, 0
    ds_read_b64_tr_b16 a[8:9], v31 offset:8192
    ds_read_b64_tr_b16 a[10:11], v31 offset:10240
    v_mfma_f32_16x16x32_bf16 v[192:195], a[4:7], a[208:211], v[192:195]
    buffer_load_dwordx4 v26, s[20:23], s46 offen offset:0 lds
    v_mfma_f32_16x16x32_bf16 v[196:199], a[0:3], a[196:199], v[196:199]
    s_add_u32 s47, s73, 98304
    ds_read_b64_tr_b16 a[12:13], v31 offset:12288
    ds_read_b64_tr_b16 a[14:15], v31 offset:14336
    v_mfma_f32_16x16x32_bf16 v[196:199], a[4:7], a[212:215], v[196:199]
    buffer_load_dwordx4 v27, s[20:23], s46 offen offset:1024 lds
    v_mfma_f32_16x16x32_bf16 v[200:203], a[0:3], a[200:203], v[200:203]
    s_xor_b32 s47, s47, 128
    ds_read_b128 a[128:131], v54 offset:49152
    ds_read_b128 a[132:135], v54 offset:50176
    v_mfma_f32_16x16x32_bf16 v[200:203], a[4:7], a[216:219], v[200:203]
    buffer_load_dwordx4 v28, s[20:23], s46 offen offset:2048 lds
    v_cvt_pk_bf16_f32 v128, v128, v129
    v_mfma_f32_16x16x32_bf16 v[204:207], a[0:3], a[204:207], v[204:207]
    ds_read_b128 a[136:139], v54 offset:51200
    ds_read_b128 a[140:143], v54 offset:52224
    v_mfma_f32_16x16x32_bf16 v[204:207], a[4:7], a[220:223], v[204:207]
    s_waitcnt lgkmcnt(4)
    buffer_load_dword v21, v59, s[76:79], 0 offen sc1
    v_mfma_f32_16x16x32_bf16 v[208:211], a[8:11], a[192:195], v[208:211]
    ds_read_b64_tr_b16 a[0:1], v32 offset:8192
    ds_read_b64_tr_b16 a[2:3], v32 offset:10240
    v_mfma_f32_16x16x32_bf16 v[208:211], a[12:15], a[208:211], v[208:211]
    buffer_load_dwordx4 v29, s[20:23], s46 offen offset:3072 lds
    v_cvt_pk_bf16_f32 v129, v130, v131
    v_mfma_f32_16x16x32_bf16 v[212:215], a[8:11], a[196:199], v[212:215]
    ds_read_b64_tr_b16 a[4:5], v32 offset:12288
    ds_read_b64_tr_b16 a[6:7], v32 offset:14336
    v_mfma_f32_16x16x32_bf16 v[212:215], a[12:15], a[212:215], v[212:215]
    v_cvt_pk_bf16_f32 v130, v144, v145
    v_cvt_pk_bf16_f32 v131, v146, v147
    v_mfma_f32_16x16x32_bf16 v[216:219], a[8:11], a[200:203], v[216:219]
    s_add_u32 m0, s92, 4096
    ds_read_b128 a[144:147], v54 offset:53248
    ds_read_b128 a[148:151], v54 offset:54272
    v_mfma_f32_16x16x32_bf16 v[216:219], a[12:15], a[216:219], v[216:219]
    buffer_load_dwordx4 v26, s[20:23], s47 offen offset:0 lds
    v_mfma_f32_16x16x32_bf16 v[220:223], a[8:11], a[204:207], v[220:223]
    ds_read_b128 a[152:155], v54 offset:55296
    ds_read_b128 a[156:159], v54 offset:56320
    v_mfma_f32_16x16x32_bf16 v[220:223], a[12:15], a[220:223], v[220:223]
    s_waitcnt lgkmcnt(4)
    buffer_store_dwordx4 v[128:131], v1, s[36:39], s3 offen offset:0 sc1
    v_mfma_f32_16x16x32_bf16 v[224:227], a[0:3], a[192:195], v[224:227]
    ds_read_b64_tr_b16 a[8:9], v33 offset:8192
    ds_read_b64_tr_b16 a[10:11], v33 offset:10240
    v_mfma_f32_16x16x32_bf16 v[224:227], a[4:7], a[208:211], v[224:227]
    buffer_load_dwordx4 v27, s[20:23], s47 offen offset:1024 lds
    v_cvt_pk_bf16_f32 v132, v132, v133
    v_mfma_f32_16x16x32_bf16 v[228:231], a[0:3], a[196:199], v[228:231]
    ds_read_b64_tr_b16 a[12:13], v33 offset:12288
    ds_read_b64_tr_b16 a[14:15], v33 offset:14336
    v_mfma_f32_16x16x32_bf16 v[228:231], a[4:7], a[212:215], v[228:231]
    buffer_load_dwordx4 v28, s[20:23], s47 offen offset:2048 lds
    v_cvt_pk_bf16_f32 v133, v134, v135
    v_mfma_f32_16x16x32_bf16 v[232:235], a[0:3], a[200:203], v[232:235]
    ds_read_b128 a[160:163], v54 offset:57344
    ds_read_b128 a[164:167], v54 offset:58368
    v_mfma_f32_16x16x32_bf16 v[232:235], a[4:7], a[216:219], v[232:235]
    buffer_load_dwordx4 v29, s[20:23], s47 offen offset:3072 lds
    v_cvt_pk_bf16_f32 v134, v148, v149
    v_mfma_f32_16x16x32_bf16 v[236:239], a[0:3], a[204:207], v[236:239]
    ds_read_b128 a[168:171], v54 offset:59392
    ds_read_b128 a[172:175], v54 offset:60416
    v_mfma_f32_16x16x32_bf16 v[236:239], a[4:7], a[220:223], v[236:239]
    s_waitcnt vmcnt(10) lgkmcnt(4)
    v_cvt_pk_bf16_f32 v135, v150, v151
    v_mfma_f32_16x16x32_bf16 v[240:243], a[8:11], a[192:195], v[240:243]
    ds_read_b64_tr_b16 a[0:1], v22 offset:16384
    ds_read_b64_tr_b16 a[2:3], v22 offset:18432
    v_mfma_f32_16x16x32_bf16 v[240:243], a[12:15], a[208:211], v[240:243]
    buffer_store_dwordx4 v[132:135], v1, s[36:39], s3 offen offset:1024 sc1
    v_mfma_f32_16x16x32_bf16 v[244:247], a[8:11], a[196:199], v[244:247]
    ds_read_b64_tr_b16 a[4:5], v22 offset:0
    ds_read_b64_tr_b16 a[6:7], v22 offset:2048
    v_mfma_f32_16x16x32_bf16 v[244:247], a[12:15], a[212:215], v[244:247]
    v_cvt_pk_bf16_f32 v136, v136, v137
    v_cvt_pk_bf16_f32 v137, v138, v139
    v_mfma_f32_16x16x32_bf16 v[248:251], a[8:11], a[200:203], v[248:251]
    ds_read_b128 a[176:179], v54 offset:61440
    ds_read_b128 a[180:183], v54 offset:62464
    v_mfma_f32_16x16x32_bf16 v[248:251], a[12:15], a[216:219], v[248:251]
    v_cvt_pk_bf16_f32 v138, v152, v153
    v_cvt_pk_bf16_f32 v139, v154, v155
    v_mfma_f32_16x16x32_bf16 v[252:255], a[8:11], a[204:207], v[252:255]
    ds_read_b128 a[184:187], v54 offset:63488
    ds_read_b128 a[188:191], v54 offset:64512
    v_mfma_f32_16x16x32_bf16 v[252:255], a[12:15], a[220:223], v[252:255]
    s_waitcnt lgkmcnt(4)
    buffer_store_dwordx4 v[136:139], v1, s[36:39], s3 offen offset:2048 sc1
    v_mfma_f32_16x16x32_bf16 v[192:195], a[0:3], a[128:131], v[192:195]
    ds_read_b64_tr_b16 a[8:9], v23 offset:16384
    ds_read_b64_tr_b16 a[10:11], v23 offset:18432
    v_mfma_f32_16x16x32_bf16 v[192:195], a[4:7], a[144:147], v[192:195]
    v_cvt_pk_bf16_f32 v140, v140, v141
    v_cvt_pk_bf16_f32 v141, v142, v143
    v_mfma_f32_16x16x32_bf16 v[196:199], a[0:3], a[132:135], v[196:199]
    ds_read_b64_tr_b16 a[12:13], v23 offset:0
    ds_read_b64_tr_b16 a[14:15], v23 offset:2048
    v_mfma_f32_16x16x32_bf16 v[196:199], a[4:7], a[148:151], v[196:199]
    v_cvt_pk_bf16_f32 v142, v156, v157
    v_cvt_pk_bf16_f32 v143, v158, v159
    v_mfma_f32_16x16x32_bf16 v[200:203], a[0:3], a[136:139], v[200:203]
    ds_read_b128 a[192:195], v54 offset:49152
    ds_read_b128 a[196:199], v54 offset:50176
    v_mfma_f32_16x16x32_bf16 v[200:203], a[4:7], a[152:155], v[200:203]
    buffer_store_dwordx4 v[140:143], v1, s[36:39], s3 offen offset:3072 sc1
    v_mfma_f32_16x16x32_bf16 v[204:207], a[0:3], a[140:143], v[204:207]
    ds_read_b128 a[200:203], v54 offset:51200
    ds_read_b128 a[204:207], v54 offset:52224
    v_mfma_f32_16x16x32_bf16 v[204:207], a[4:7], a[156:159], v[204:207]
    s_waitcnt vmcnt(3) lgkmcnt(4)
    v_cvt_pk_bf16_f32 v160, v160, v161
    v_cvt_pk_bf16_f32 v161, v162, v163
    v_mfma_f32_16x16x32_bf16 v[208:211], a[8:11], a[128:131], v[208:211]
    ds_read_b64_tr_b16 a[0:1], v30 offset:0
    ds_read_b64_tr_b16 a[2:3], v30 offset:2048
    v_mfma_f32_16x16x32_bf16 v[208:211], a[12:15], a[144:147], v[208:211]
    v_cvt_pk_bf16_f32 v162, v176, v177
    v_cvt_pk_bf16_f32 v163, v178, v179
    v_mfma_f32_16x16x32_bf16 v[212:215], a[8:11], a[132:135], v[212:215]
    ds_read_b64_tr_b16 a[4:5], v30 offset:4096
    ds_read_b64_tr_b16 a[6:7], v30 offset:6144
    v_mfma_f32_16x16x32_bf16 v[212:215], a[12:15], a[148:151], v[212:215]
    buffer_store_dwordx4 v[160:163], v1, s[36:39], s67 offen offset:0 sc1
    v_mfma_f32_16x16x32_bf16 v[216:219], a[8:11], a[136:139], v[216:219]
    ds_read_b128 a[208:211], v54 offset:53248
    ds_read_b128 a[212:215], v54 offset:54272
    v_mfma_f32_16x16x32_bf16 v[216:219], a[12:15], a[152:155], v[216:219]
    v_cvt_pk_bf16_f32 v164, v164, v165
    v_cvt_pk_bf16_f32 v165, v166, v167
    v_mfma_f32_16x16x32_bf16 v[220:223], a[8:11], a[140:143], v[220:223]
    ds_read_b128 a[216:219], v54 offset:55296
    ds_read_b128 a[220:223], v54 offset:56320
    v_mfma_f32_16x16x32_bf16 v[220:223], a[12:15], a[156:159], v[220:223]
    s_waitcnt lgkmcnt(4)
    v_cvt_pk_bf16_f32 v166, v180, v181
    v_cvt_pk_bf16_f32 v167, v182, v183
    v_mfma_f32_16x16x32_bf16 v[192:195], a[0:3], a[160:163], v[192:195]
    ds_read_b64_tr_b16 a[8:9], v31 offset:0
    ds_read_b64_tr_b16 a[10:11], v31 offset:2048
    v_mfma_f32_16x16x32_bf16 v[192:195], a[4:7], a[176:179], v[192:195]
    buffer_store_dwordx4 v[164:167], v1, s[36:39], s67 offen offset:1024 sc1
    v_mfma_f32_16x16x32_bf16 v[196:199], a[0:3], a[164:167], v[196:199]
    ds_read_b64_tr_b16 a[12:13], v31 offset:4096
    ds_read_b64_tr_b16 a[14:15], v31 offset:6144
    v_mfma_f32_16x16x32_bf16 v[196:199], a[4:7], a[180:183], v[196:199]
    v_cvt_pk_bf16_f32 v168, v168, v169
    v_cvt_pk_bf16_f32 v169, v170, v171
    v_mfma_f32_16x16x32_bf16 v[200:203], a[0:3], a[168:171], v[200:203]
    ds_read_b128 a[128:131], v54 offset:57344
    ds_read_b128 a[132:135], v54 offset:58368
    v_mfma_f32_16x16x32_bf16 v[200:203], a[4:7], a[184:187], v[200:203]
    v_cvt_pk_bf16_f32 v170, v184, v185
    v_cvt_pk_bf16_f32 v171, v186, v187
    v_mfma_f32_16x16x32_bf16 v[204:207], a[0:3], a[172:175], v[204:207]
    ds_read_b128 a[136:139], v54 offset:59392
    ds_read_b128 a[140:143], v54 offset:60416
    v_mfma_f32_16x16x32_bf16 v[204:207], a[4:7], a[188:191], v[204:207]
    s_waitcnt lgkmcnt(4)
    buffer_store_dwordx4 v[168:171], v1, s[36:39], s67 offen offset:2048 sc1
    v_mfma_f32_16x16x32_bf16 v[208:211], a[8:11], a[160:163], v[208:211]
    ds_read_b64_tr_b16 a[0:1], v24 offset:16384
    ds_read_b64_tr_b16 a[2:3], v24 offset:18432
    v_mfma_f32_16x16x32_bf16 v[208:211], a[12:15], a[176:179], v[208:211]
    v_cvt_pk_bf16_f32 v172, v172, v173
    v_cvt_pk_bf16_f32 v173, v174, v175
    v_mfma_f32_16x16x32_bf16 v[212:215], a[8:11], a[164:167], v[212:215]
    ds_read_b64_tr_b16 a[4:5], v24 offset:0
    ds_read_b64_tr_b16 a[6:7], v24 offset:2048
    v_mfma_f32_16x16x32_bf16 v[212:215], a[12:15], a[180:183], v[212:215]
    v_cvt_pk_bf16_f32 v174, v188, v189
    v_cvt_pk_bf16_f32 v175, v190, v191
    v_mfma_f32_16x16x32_bf16 v[216:219], a[8:11], a[168:171], v[216:219]
    ds_read_b128 a[144:147], v54 offset:61440
    ds_read_b128 a[148:151], v54 offset:62464
    v_mfma_f32_16x16x32_bf16 v[216:219], a[12:15], a[184:187], v[216:219]
    buffer_store_dwordx4 v[172:175], v1, s[36:39], s67 offen offset:3072 sc1
    v_mfma_f32_16x16x32_bf16 v[220:223], a[8:11], a[172:175], v[220:223]
    ds_read_b128 a[152:155], v54 offset:63488
    ds_read_b128 a[156:159], v54 offset:64512
    v_mfma_f32_16x16x32_bf16 v[220:223], a[12:15], a[188:191], v[220:223]
    s_waitcnt lgkmcnt(4)
    v_mfma_f32_16x16x32_bf16 v[224:227], a[0:3], a[192:195], v[224:227]
    ds_read_b64_tr_b16 a[8:9], v25 offset:16384
    ds_read_b64_tr_b16 a[10:11], v25 offset:18432
    v_mfma_f32_16x16x32_bf16 v[224:227], a[4:7], a[208:211], v[224:227]
    v_mfma_f32_16x16x32_bf16 v[228:231], a[0:3], a[196:199], v[228:231]
    ds_read_b64_tr_b16 a[12:13], v25 offset:0
    ds_read_b64_tr_b16 a[14:15], v25 offset:2048
    v_mfma_f32_16x16x32_bf16 v[228:231], a[4:7], a[212:215], v[228:231]
    v_mfma_f32_16x16x32_bf16 v[232:235], a[0:3], a[200:203], v[232:235]
    v_cvt_pk_bf16_f32 v192, v192, v193
    v_cvt_pk_bf16_f32 v193, v194, v195
    v_mfma_f32_16x16x32_bf16 v[232:235], a[4:7], a[216:219], v[232:235]
    v_cvt_pk_bf16_f32 v194, v208, v209
    v_cvt_pk_bf16_f32 v195, v210, v211
    v_mfma_f32_16x16x32_bf16 v[236:239], a[0:3], a[204:207], v[236:239]
    buffer_store_dwordx4 v[192:195], v1, s[36:39], s68 offen offset:0 sc1
    v_mfma_f32_16x16x32_bf16 v[236:239], a[4:7], a[220:223], v[236:239]
    s_waitcnt lgkmcnt(0)
    s_waitcnt vmcnt(14)
    v_cmp_eq_u32 vcc, s75, v21
    s_nop 0
    s_and_b32 s11, vcc_lo, 0xff
    s_lshr_b32 s94, vcc_lo, 8
    s_and_b32 s94, s94, 0xff
    s_lshl_b32 s9, 1, s40
    s_andn2_b32 s53, s11, s9
    s_or_b32 s9, s9, s11
    s_mov_b32 s10, s9
    s_bitcmp1_b32 s53, 0
    s_cselect_b32 s51, 16777216, s65
    s_bitcmp1_b32 s53, 1
    s_cselect_b32 s70, 18874368, s65
    s_bitcmp1_b32 s53, 2
    s_cselect_b32 s71, 20971520, s65
    s_bitcmp1_b32 s53, 3
    s_cselect_b32 s72, 23068672, s65
    s_bitcmp1_b32 s53, 4
    s_cselect_b32 s73, 25165824, s65
    s_bitcmp1_b32 s53, 5
    s_cselect_b32 s54, 27262976, s65
    s_bitcmp1_b32 s53, 6
    s_cselect_b32 s55, 29360128, s65
    s_bitcmp1_b32 s53, 7
    s_cselect_b32 s50, 31457280, s65
    v_mfma_f32_16x16x32_bf16 v[240:243], a[8:11], a[192:195], v[240:243]
    ds_read_b64_tr_b16 a[0:1], v32 offset:0
    ds_read_b64_tr_b16 a[2:3], v32 offset:2048
    v_mfma_f32_16x16x32_bf16 v[240:243], a[12:15], a[208:211], v[240:243]
    v_cvt_pk_bf16_f32 v196, v196, v197
    v_cvt_pk_bf16_f32 v197, v198, v199
    v_mfma_f32_16x16x32_bf16 v[244:247], a[8:11], a[196:199], v[244:247]
    ds_read_b64_tr_b16 a[4:5], v32 offset:4096
    ds_read_b64_tr_b16 a[6:7], v32 offset:6144
    v_mfma_f32_16x16x32_bf16 v[244:247], a[12:15], a[212:215], v[244:247]
    v_cvt_pk_bf16_f32 v198, v212, v213
    v_cvt_pk_bf16_f32 v199, v214, v215
    v_mfma_f32_16x16x32_bf16 v[248:251], a[8:11], a[200:203], v[248:251]
    buffer_store_dwordx4 v[196:199], v1, s[36:39], s68 offen offset:1024 sc1
    v_mfma_f32_16x16x32_bf16 v[248:251], a[12:15], a[216:219], v[248:251]
    v_cvt_pk_bf16_f32 v200, v200, v201
    v_cvt_pk_bf16_f32 v201, v202, v203
    v_mfma_f32_16x16x32_bf16 v[252:255], a[8:11], a[204:207], v[252:255]
    v_cvt_pk_bf16_f32 v202, v216, v217
    v_cvt_pk_bf16_f32 v203, v218, v219
    v_mfma_f32_16x16x32_bf16 v[252:255], a[12:15], a[220:223], v[252:255]
    s_waitcnt lgkmcnt(0)
    buffer_store_dwordx4 v[200:203], v1, s[36:39], s68 offen offset:2048 sc1
    v_mfma_f32_16x16x32_bf16 v[224:227], a[0:3], a[128:131], v[224:227]
    ds_read_b64_tr_b16 a[8:9], v33 offset:0
    ds_read_b64_tr_b16 a[10:11], v33 offset:2048
    v_mfma_f32_16x16x32_bf16 v[224:227], a[4:7], a[144:147], v[224:227]
    v_cvt_pk_bf16_f32 v204, v204, v205
    v_cvt_pk_bf16_f32 v205, v206, v207
    v_mfma_f32_16x16x32_bf16 v[228:231], a[0:3], a[132:135], v[228:231]
    ds_read_b64_tr_b16 a[12:13], v33 offset:4096
    ds_read_b64_tr_b16 a[14:15], v33 offset:6144
    v_mfma_f32_16x16x32_bf16 v[228:231], a[4:7], a[148:151], v[228:231]
    v_cvt_pk_bf16_f32 v206, v220, v221
    v_cvt_pk_bf16_f32 v207, v222, v223
    v_mfma_f32_16x16x32_bf16 v[232:235], a[0:3], a[136:139], v[232:235]
    buffer_store_dwordx4 v[204:207], v1, s[36:39], s68 offen offset:3072 sc1
    v_mfma_f32_16x16x32_bf16 v[232:235], a[4:7], a[152:155], v[232:235]
    v_mfma_f32_16x16x32_bf16 v[236:239], a[0:3], a[140:143], v[236:239]
    v_mfma_f32_16x16x32_bf16 v[236:239], a[4:7], a[156:159], v[236:239]
    s_waitcnt lgkmcnt(0)
    v_mfma_f32_16x16x32_bf16 v[240:243], a[8:11], a[128:131], v[240:243]
    v_mfma_f32_16x16x32_bf16 v[240:243], a[12:15], a[144:147], v[240:243]
    v_mfma_f32_16x16x32_bf16 v[244:247], a[8:11], a[132:135], v[244:247]
    v_mfma_f32_16x16x32_bf16 v[244:247], a[12:15], a[148:151], v[244:247]
    v_mfma_f32_16x16x32_bf16 v[248:251], a[8:11], a[136:139], v[248:251]
    v_mfma_f32_16x16x32_bf16 v[248:251], a[12:15], a[152:155], v[248:251]
    v_mfma_f32_16x16x32_bf16 v[252:255], a[8:11], a[140:143], v[252:255]
    v_mfma_f32_16x16x32_bf16 v[252:255], a[12:15], a[156:159], v[252:255]
    s_bitcmp1_b32 s40, 0
    s_cbranch_scc1 L_odd
    v_cvt_pk_bf16_f32 v232, v232, v233
    v_cvt_pk_bf16_f32 v233, v234, v235
    s_nop 1
    v_cvt_pk_bf16_f32 v234, v248, v249
    v_cvt_pk_bf16_f32 v235, v250, v251
    buffer_store_dwordx4 v[232:235], v1, s[36:39], s69 offen offset:2048 sc1
    v_cvt_pk_bf16_f32 v236, v236, v237
    v_cvt_pk_bf16_f32 v237, v238, v239
    v_cvt_pk_bf16_f32 v238, v252, v253
    v_cvt_pk_bf16_f32 v239, v254, v255
    buffer_store_dwordx4 v[236:239], v1, s[36:39], s69 offen offset:3072 sc1
    buffer_load_dwordx2 v[112:113], v57, s[4:7], 0 offen offset:0
    buffer_load_dwordx2 v[114:115], v57, s[4:7], 0 offen offset:32
    buffer_load_dwordx2 v[116:117], v57, s[4:7], s57 offen offset:0
    buffer_load_dwordx2 v[118:119], v57, s[4:7], s57 offen offset:32
    buffer_load_dwordx4 v[128:131], v1, s[12:15], s51 offen offset:0 sc1
    buffer_load_dwordx4 v[132:135], v1, s[12:15], s70 offen offset:0 sc1
    buffer_load_dwordx4 v[136:139], v1, s[12:15], s71 offen offset:0 sc1
    buffer_load_dwordx4 v[140:143], v1, s[12:15], s72 offen offset:0 sc1
    buffer_load_dwordx4 v[144:147], v1, s[12:15], s73 offen offset:0 sc1
    buffer_load_dwordx4 v[148:151], v1, s[12:15], s54 offen offset:0 sc1
    buffer_load_dwordx4 v[152:155], v1, s[12:15], s55 offen offset:0 sc1
    buffer_load_dwordx4 v[156:159], v1, s[12:15], s50 offen offset:0 sc1
    buffer_load_dwordx4 v[160:163], v1, s[12:15], s51 offen offset:1024 sc1
    buffer_load_dwordx4 v[164:167], v1, s[12:15], s70 offen offset:1024 sc1
    buffer_load_dwordx4 v[168:171], v1, s[12:15], s71 offen offset:1024 sc1
    buffer_load_dwordx4 v[172:175], v1, s[12:15], s72 offen offset:1024 sc1
    buffer_load_dwordx4 v[176:179], v1, s[12:15], s73 offen offset:1024 sc1
    buffer_load_dwordx4 v[180:183], v1, s[12:15], s54 offen offset:1024 sc1
    buffer_load_dwordx4 v[184:187], v1, s[12:15], s55 offen offset:1024 sc1
    buffer_load_dwordx4 v[188:191], v1, s[12:15], s50 offen offset:1024 sc1
    v_cvt_pk_bf16_f32 v120, v224, v225
    v_cvt_pk_bf16_f32 v121, v226, v227
    v_cvt_pk_bf16_f32 v122, v240, v241
    v_cvt_pk_bf16_f32 v123, v242, v243
    v_cvt_pk_bf16_f32 v124, v228, v229
    v_cvt_pk_bf16_f32 v125, v230, v231
    v_cvt_pk_bf16_f32 v126, v244, v245
    v_cvt_pk_bf16_f32 v127, v246, v247
    s_branch L_own
L_odd:
    v_cvt_pk_bf16_f32 v224, v224, v225
    v_cvt_pk_bf16_f32 v225, v226, v227
    v_cvt_pk_bf16_f32 v226, v240, v241
    v_cvt_pk_bf16_f32 v227, v242, v243
    buffer_store_dwordx4 v[224:227], v1, s[36:39], s69 offen offset:0 sc1
    v_cvt_pk_bf16_f32 v228, v228, v229
    v_cvt_pk_bf16_f32 v229, v230, v231
    v_cvt_pk_bf16_f32 v230, v244, v245
    v_cvt_pk_bf16_f32 v231, v246, v247
    buffer_store_dwordx4 v[228:231], v1, s[36:39], s69 offen offset:1024 sc1
    buffer_load_dwordx2 v[112:113], v57, s[4:7], 0 offen offset:0
    buffer_load_dwordx2 v[114:115], v57, s[4:7], 0 offen offset:32
    buffer_load_dwordx2 v[116:117], v57, s[4:7], s57 offen offset:0
    buffer_load_dwordx2 v[118:119], v57, s[4:7], s57 offen offset:32
    buffer_load_dwordx4 v[128:131], v1, s[12:15], s51 offen offset:0 sc1
    buffer_load_dwordx4 v[132:135], v1, s[12:15], s70 offen offset:0 sc1
    buffer_load_dwordx4 v[136:139], v1, s[12:15], s71 offen offset:0 sc1
    buffer_load_dwordx4 v[140:143], v1, s[12:15], s72 offen offset:0 sc1
    buffer_load_dwordx4 v[144:147], v1, s[12:15], s73 offen offset:0 sc1
    buffer_load_dwordx4 v[148:151], v1, s[12:15], s54 offen offset:0 sc1
    buffer_load_dwordx4 v[152:155], v1, s[12:15], s55 offen offset:0 sc1
    buffer_load_dwordx4 v[156:159], v1, s[12:15], s50 offen offset:0 sc1
    buffer_load_dwordx4 v[160:163], v1, s[12:15], s51 offen offset:1024 sc1
    buffer_load_dwordx4 v[164:167], v1, s[12:15], s70 offen offset:1024 sc1
    buffer_load_dwordx4 v[168:171], v1, s[12:15], s71 offen offset:1024 sc1
    buffer_load_dwordx4 v[172:175], v1, s[12:15], s72 offen offset:1024 sc1
    buffer_load_dwordx4 v[176:179], v1, s[12:15], s73 offen offset:1024 sc1
    buffer_load_dwordx4 v[180:183], v1, s[12:15], s54 offen offset:1024 sc1
    buffer_load_dwordx4 v[184:187], v1, s[12:15], s55 offen offset:1024 sc1
    buffer_load_dwordx4 v[188:191], v1, s[12:15], s50 offen offset:1024 sc1
    v_cvt_pk_bf16_f32 v120, v232, v233
    v_cvt_pk_bf16_f32 v121, v234, v235
    v_cvt_pk_bf16_f32 v122, v248, v249
    v_cvt_pk_bf16_f32 v123, v250, v251
    v_cvt_pk_bf16_f32 v124, v236, v237
    v_cvt_pk_bf16_f32 v125, v238, v239
    v_cvt_pk_bf16_f32 v126, v252, v253
    v_cvt_pk_bf16_f32 v127, v254, v255
L_own:
    s_mov_b32 s88, 0x3f80
    s_mov_b32 s89, 0x3f800000
    s_mov_b32 s95, 0
    s_mov_b32 s49, 0
    s_mov_b32 s8, s40
    s_mov_b32 s47, -1
    s_lshl_b32 s51, s42, 8
    s_lshl_b32 s52, s40, 2
    s_add_u32 s56, s51, s52
    v_lshlrev_b32 v7, 10, v0
    v_mov_b32 v8, s75
    s_waitcnt vmcnt(20)
    buffer_store_dword v8, v7, s[76:79], s56 offen sc1
    v_accvgpr_read_b32 v80, a16
    v_accvgpr_read_b32 v81, a17
    v_accvgpr_read_b32 v82, a18
    v_accvgpr_read_b32 v83, a19
    v_dot2_f32_bf16 v64, v80, s88, 0
    v_dot2_f32_bf16 v65, v80, s89, 0
    v_dot2_f32_bf16 v66, v81, s88, 0
    v_dot2_f32_bf16 v67, v81, s89, 0
    v_dot2_f32_bf16 v68, v82, s88, 0
    v_dot2_f32_bf16 v69, v82, s89, 0
    v_dot2_f32_bf16 v70, v83, s88, 0
    v_dot2_f32_bf16 v71, v83, s89, 0
    v_accvgpr_read_b32 v80, a24
    v_accvgpr_read_b32 v81, a25
    v_accvgpr_read_b32 v82, a26
    v_accvgpr_read_b32 v83, a27
    v_dot2_f32_bf16 v64, v80, s88, v64
    v_dot2_f32_bf16 v65, v80, s89, v65
    v_dot2_f32_bf16 v66, v81, s88, v66
    v_dot2_f32_bf16 v67, v81, s89, v67
    v_dot2_f32_bf16 v68, v82, s88, v68
    v_dot2_f32_bf16 v69, v82, s89, v69
    v_dot2_f32_bf16 v70, v83, s88, v70
    v_dot2_f32_bf16 v71, v83, s89, v71
    v_accvgpr_read_b32 v80, a32
    v_accvgpr_read_b32 v81, a33
    v_accvgpr_read_b32 v82, a34
    v_accvgpr_read_b32 v83, a35
    v_dot2_f32_bf16 v64, v80, s88, v64
    v_dot2_f32_bf16 v65, v80, s89, v65
    v_dot2_f32_bf16 v66, v81, s88, v66
    v_dot2_f32_bf16 v67, v81, s89, v67
    v_dot2_f32_bf16 v68, v82, s88, v68
    v_dot2_f32_bf16 v69, v82, s89, v69
    v_dot2_f32_bf16 v70, v83, s88, v70
    v_dot2_f32_bf16 v71, v83, s89, v71
    v_accvgpr_read_b32 v80, a40
    v_accvgpr_read_b32 v81, a41
    v_accvgpr_read_b32 v82, a42
    v_accvgpr_read_b32 v83, a43
    v_dot2_f32_bf16 v64, v80, s88, v64
    v_dot2_f32_bf16 v65, v80, s89, v65
    v_dot2_f32_bf16 v66, v81, s88, v66
    v_dot2_f32_bf16 v67, v81, s89, v67
    v_dot2_f32_bf16 v68, v82, s88, v68
    v_dot2_f32_bf16 v69, v82, s89, v69
    v_dot2_f32_bf16 v70, v83, s88, v70
    v_dot2_f32_bf16 v71, v83, s89, v71
    v_accvgpr_read_b32 v80, a48
    v_accvgpr_read_b32 v81, a49
    v_accvgpr_read_b32 v82, a50
    v_accvgpr_read_b32 v83, a51
    v_dot2_f32_bf16 v64, v80, s88, v64
    v_dot2_f32_bf16 v65, v80, s89, v65
    v_dot2_f32_bf16 v66, v81, s88, v66
    v_dot2_f32_bf16 v67, v81, s89, v67
    v_dot2_f32_bf16 v68, v82, s88, v68
    v_dot2_f32_bf16 v69, v82, s89, v69
    v_dot2_f32_bf16 v70, v83, s88, v70
    v_dot2_f32_bf16 v71, v83, s89, v71
    v_accvgpr_read_b32 v80, a56
    v_accvgpr_read_b32 v81, a57
    v_accvgpr_read_b32 v82, a58
    v_accvgpr_read_b32 v83, a59
    v_dot2_f32_bf16 v64, v80, s88, v64
    v_dot2_f32_bf16 v65, v80, s89, v65
    v_dot2_f32_bf16 v66, v81, s88, v66
    v_dot2_f32_bf16 v67, v81, s89, v67
    v_dot2_f32_bf16 v68, v82, s88, v68
    v_dot2_f32_bf16 v69, v82, s89, v69
    v_dot2_f32_bf16 v70, v83, s88, v70
    v_dot2_f32_bf16 v71, v83, s89, v71
    v_accvgpr_read_b32 v80, a64
    v_accvgpr_read_b32 v81, a65
    v_accvgpr_read_b32 v82, a66
    v_accvgpr_read_b32 v83, a67
    v_dot2_f32_bf16 v64, v80, s88, v64
    v_dot2_f32_bf16 v65, v80, s89, v65
    v_dot2_f32_bf16 v66, v81, s88, v66
    v_dot2_f32_bf16 v67, v81, s89, v67
    v_dot2_f32_bf16 v68, v82, s88, v68
    v_dot2_f32_bf16 v69, v82, s89, v69
    v_dot2_f32_bf16 v70, v83, s88, v70
    v_dot2_f32_bf16 v71, v83, s89, v71
    v_accvgpr_read_b32 v80, a72
    v_accvgpr_read_b32 v81, a73
    v_accvgpr_read_b32 v82, a74
    v_accvgpr_read_b32 v83, a75
    v_dot2_f32_bf16 v64, v80, s88, v64
    v_dot2_f32_bf16 v65, v80, s89, v65
    v_dot2_f32_bf16 v66, v81, s88, v66
    v_dot2_f32_bf16 v67, v81, s89, v67
    v_dot2_f32_bf16 v68, v82, s88, v68
    v_dot2_f32_bf16 v69, v82, s89, v69
    v_dot2_f32_bf16 v70, v83, s88, v70
    v_dot2_f32_bf16 v71, v83, s89, v71
    v_mul_f32 v104, 0xbfb8aa3b, v64
    v_mul_f32 v105, 0xbfb8aa3b, v65
    v_mul_f32 v106, 0xbfb8aa3b, v66
    v_mul_f32 v107, 0xbfb8aa3b, v67
    v_mul_f32 v108, 0xbfb8aa3b, v68
    v_mul_f32 v109, 0xbfb8aa3b, v69
    v_mul_f32 v110, 0xbfb8aa3b, v70
    v_mul_f32 v111, 0xbfb8aa3b, v71
    v_exp_f32 v104, v104
    v_exp_f32 v105, v105
    v_exp_f32 v106, v106
    v_exp_f32 v107, v107
    v_exp_f32 v108, v108
    v_exp_f32 v109, v109
    v_exp_f32 v110, v110
    v_exp_f32 v111, v111
    v_add_f32 v104, 1.0, v104
    v_add_f32 v105, 1.0, v105
    v_add_f32 v106, 1.0, v106
    v_add_f32 v107, 1.0, v107
    v_add_f32 v108, 1.0, v108
    v_add_f32 v109, 1.0, v109
    v_add_f32 v110, 1.0, v110
    v_add_f32 v111, 1.0, v111
    v_rcp_f32 v104, v104
    v_rcp_f32 v105, v105
    v_rcp_f32 v106, v106
    v_rcp_f32 v107, v107
    v_rcp_f32 v108, v108
    v_rcp_f32 v109, v109
    v_rcp_f32 v110, v110
    v_rcp_f32 v111, v111
    v_mul_f32 v64, v64, v104
    v_mul_f32 v65, v65, v105
    v_mul_f32 v66, v66, v106
    v_mul_f32 v67, v67, v107
    v_mul_f32 v68, v68, v108
    v_mul_f32 v69, v69, v109
    v_mul_f32 v70, v70, v110
    v_mul_f32 v71, v71, v111
    v_accvgpr_read_b32 v80, a20
    v_accvgpr_read_b32 v81, a21
    v_accvgpr_read_b32 v82, a22
    v_accvgpr_read_b32 v83, a23
    v_dot2_f32_bf16 v72, v80, s88, 0
    v_dot2_f32_bf16 v73, v80, s89, 0
    v_dot2_f32_bf16 v74, v81, s88, 0
    v_dot2_f32_bf16 v75, v81, s89, 0
    v_dot2_f32_bf16 v76, v82, s88, 0
    v_dot2_f32_bf16 v77, v82, s89, 0
    v_dot2_f32_bf16 v78, v83, s88, 0
    v_dot2_f32_bf16 v79, v83, s89, 0
    v_accvgpr_read_b32 v80, a28
    v_accvgpr_read_b32 v81, a29
    v_accvgpr_read_b32 v82, a30
    v_accvgpr_read_b32 v83, a31
    v_dot2_f32_bf16 v72, v80, s88, v72
    v_dot2_f32_bf16 v73, v80, s89, v73
    v_dot2_f32_bf16 v74, v81, s88, v74
    v_dot2_f32_bf16 v75, v81, s89, v75
    v_dot2_f32_bf16 v76, v82, s88, v76
    v_dot2_f32_bf16 v77, v82, s89, v77
    v_dot2_f32_bf16 v78, v83, s88, v78
    v_dot2_f32_bf16 v79, v83, s89, v79
    v_accvgpr_read_b32 v80, a36
    v_accvgpr_read_b32 v81, a37
    v_accvgpr_read_b32 v82, a38
    v_accvgpr_read_b32 v83, a39
    v_dot2_f32_bf16 v72, v80, s88, v72
    v_dot2_f32_bf16 v73, v80, s89, v73
    v_dot2_f32_bf16 v74, v81, s88, v74
    v_dot2_f32_bf16 v75, v81, s89, v75
    v_dot2_f32_bf16 v76, v82, s88, v76
    v_dot2_f32_bf16 v77, v82, s89, v77
    v_dot2_f32_bf16 v78, v83, s88, v78
    v_dot2_f32_bf16 v79, v83, s89, v79
    v_accvgpr_read_b32 v80, a44
    v_accvgpr_read_b32 v81, a45
    v_accvgpr_read_b32 v82, a46
    v_accvgpr_read_b32 v83, a47
    v_dot2_f32_bf16 v72, v80, s88, v72
    v_dot2_f32_bf16 v73, v80, s89, v73
    v_dot2_f32_bf16 v74, v81, s88, v74
    v_dot2_f32_bf16 v75, v81, s89, v75
    v_dot2_f32_bf16 v76, v82, s88, v76
    v_dot2_f32_bf16 v77, v82, s89, v77
    v_dot2_f32_bf16 v78, v83, s88, v78
    v_dot2_f32_bf16 v79, v83, s89, v79
    v_accvgpr_read_b32 v80, a52
    v_accvgpr_read_b32 v81, a53
    v_accvgpr_read_b32 v82, a54
    v_accvgpr_read_b32 v83, a55
    v_dot2_f32_bf16 v72, v80, s88, v72
    v_dot2_f32_bf16 v73, v80, s89, v73
    v_dot2_f32_bf16 v74, v81, s88, v74
    v_dot2_f32_bf16 v75, v81, s89, v75
    v_dot2_f32_bf16 v76, v82, s88, v76
    v_dot2_f32_bf16 v77, v82, s89, v77
    v_dot2_f32_bf16 v78, v83, s88, v78
    v_dot2_f32_bf16 v79, v83, s89, v79
    v_accvgpr_read_b32 v80, a60
    v_accvgpr_read_b32 v81, a61
    v_accvgpr_read_b32 v82, a62
    v_accvgpr_read_b32 v83, a63
    v_dot2_f32_bf16 v72, v80, s88, v72
    v_dot2_f32_bf16 v73, v80, s89, v73
    v_dot2_f32_bf16 v74, v81, s88, v74
    v_dot2_f32_bf16 v75, v81, s89, v75
    v_dot2_f32_bf16 v76, v82, s88, v76
    v_dot2_f32_bf16 v77, v82, s89, v77
    v_dot2_f32_bf16 v78, v83, s88, v78
    v_dot2_f32_bf16 v79, v83, s89, v79
    v_accvgpr_read_b32 v80, a68
    v_accvgpr_read_b32 v81, a69
    v_accvgpr_read_b32 v82, a70
    v_accvgpr_read_b32 v83, a71
    v_dot2_f32_bf16 v72, v80, s88, v72
    v_dot2_f32_bf16 v73, v80, s89, v73
    v_dot2_f32_bf16 v74, v81, s88, v74
    v_dot2_f32_bf16 v75, v81, s89, v75
    v_dot2_f32_bf16 v76, v82, s88, v76
    v_dot2_f32_bf16 v77, v82, s89, v77
    v_dot2_f32_bf16 v78, v83, s88, v78
    v_dot2_f32_bf16 v79, v83, s89, v79
    v_accvgpr_read_b32 v80, a76
    v_accvgpr_read_b32 v81, a77
    v_accvgpr_read_b32 v82, a78
    v_accvgpr_read_b32 v83, a79
    v_dot2_f32_bf16 v72, v80, s88, v72
    v_dot2_f32_bf16 v73, v80, s89, v73
    v_dot2_f32_bf16 v74, v81, s88, v74
    v_dot2_f32_bf16 v75, v81, s89, v75
    v_dot2_f32_bf16 v76, v82, s88, v76
    v_dot2_f32_bf16 v77, v82, s89, v77
    v_dot2_f32_bf16 v78, v83, s88, v78
    v_dot2_f32_bf16 v79, v83, s89, v79
    v_mul_f32 v104, 0xbfb8aa3b, v72
    v_mul_f32 v105, 0xbfb8aa3b, v73
    v_mul_f32 v106, 0xbfb8aa3b, v74
    v_mul_f32 v107, 0xbfb8aa3b, v75
    v_mul_f32 v108, 0xbfb8aa3b, v76
    v_mul_f32 v109, 0xbfb8aa3b, v77
    v_mul_f32 v110, 0xbfb8aa3b, v78
    v_mul_f32 v111, 0xbfb8aa3b, v79
    v_exp_f32 v104, v104
    v_exp_f32 v105, v105
    v_exp_f32 v106, v106
    v_exp_f32 v107, v107
    v_exp_f32 v108, v108
    v_exp_f32 v109, v109
    v_exp_f32 v110, v110
    v_exp_f32 v111, v111
    v_add_f32 v104, 1.0, v104
    v_add_f32 v105, 1.0, v105
    v_add_f32 v106, 1.0, v106
    v_add_f32 v107, 1.0, v107
    v_add_f32 v108, 1.0, v108
    v_add_f32 v109, 1.0, v109
    v_add_f32 v110, 1.0, v110
    v_add_f32 v111, 1.0, v111
    v_rcp_f32 v104, v104
    v_rcp_f32 v105, v105
    v_rcp_f32 v106, v106
    v_rcp_f32 v107, v107
    v_rcp_f32 v108, v108
    v_rcp_f32 v109, v109
    v_rcp_f32 v110, v110
    v_rcp_f32 v111, v111
    v_mul_f32 v72, v72, v104
    v_mul_f32 v73, v73, v105
    v_mul_f32 v74, v74, v106
    v_mul_f32 v75, v75, v107
    v_mul_f32 v76, v76, v108
    v_mul_f32 v77, v77, v109
    v_mul_f32 v78, v78, v110
    v_mul_f32 v79, v79, v111
    s_mov_b32 s53, 1
    s_cmp_eq_u32 s66, 0
    s_cbranch_scc1 L_full
    s_cmp_eq_u32 s10, 0xff
    s_cbranch_scc1 L_gated
    s_branch L_poll
L_full:
    s_mov_b32 s30, s63
    s_lshl_b32 s51, s40, 21
    s_add_u32 s51, s51, 16777216
    buffer_store_dwordx4 v[120:123], v1, s[28:31], s51 offen sc1
    buffer_store_dwordx4 v[124:127], v1, s[28:31], s51 offen offset:1024 sc1
    s_waitcnt vmcnt(0)
L_slice:
    s_lshl_b32 s51, s41, 2
    s_add_u32 s51, s51, s42
    s_lshl_b32 s51, s51, 3
    s_add_u32 s51, s51, s8
    s_lshl_b32 s51, s51, 11
    s_add_u32 s12, s86, s51
    s_addc_u32 s13, s87, 0
    s_sub_u32 s14, 33554432, s51
    s_mov_b32 s15, 0x20000
    s_and_b32 s51, s8, 1
    s_lshl_b32 s51, s51, 15
    s_lshr_b32 s52, s8, 1
    s_lshl_b32 s52, s52, 6
    s_add_u32 s51, s51, s52
    s_lshl_b32 s52, s42, 8
    s_add_u32 s51, s51, s52
    v_and_b32 v57, 15, v0
    v_lshrrev_b32 v9, 4, v0
    v_lshlrev_b32 v57, 10, v57
    v_lshl_add_u32 v57, v9, 3, v57
    v_add_u32 v57, s51, v57
    buffer_load_dwordx2 v[112:113], v57, s[4:7], 0 offen offset:0
    buffer_load_dwordx2 v[114:115], v57, s[4:7], 0 offen offset:32
    buffer_load_dwordx2 v[116:117], v57, s[4:7], s57 offen offset:0
    buffer_load_dwordx2 v[118:119], v57, s[4:7], s57 offen offset:32
    s_lshl_b32 s51, s8, 21
    s_add_u32 s51, s51, 16777216
    buffer_load_dwordx4 v[120:123], v1, s[12:15], s51 offen offset:0 sc1
    buffer_load_dwordx4 v[124:127], v1, s[12:15], s51 offen offset:1024 sc1
    s_mov_b32 s10, 0
L_look:
    v_cmp_eq_u32 vcc, s75, v21
    s_nop 0
    s_and_b32 s11, vcc_lo, 0xff
    s_lshr_b32 s94, vcc_lo, 8
    s_and_b32 s94, s94, 0xff
    s_or_b32 s9, s9, s11
    s_andn2_b32 s53, s9, s10
    s_mov_b32 s10, s9
    s_bitcmp1_b32 s53, 0
    s_cbranch_scc0 L_skip0
    s_mov_b32 s51, 0
    s_mov_b32 s52, 16777216
    s_cmp_eq_u32 s8, 0
    s_cselect_b32 s52, s65, s52
    buffer_load_dwordx4 v[128:131], v1, s[12:15], s52 offen offset:0 sc1
    buffer_load_dwordx4 v[160:163], v1, s[12:15], s52 offen offset:1024 sc1
    s_cmp_lg_u32 s66, 0
    s_cbranch_scc1 L_skip0
    buffer_load_dwordx4 v[192:195], v1, s[12:15], s51 offen offset:0 sc1
    buffer_load_dwordx4 v[224:227], v1, s[12:15], s51 offen offset:1024 sc1
L_skip0:
    s_bitcmp1_b32 s53, 1
    s_cbranch_scc0 L_skip1
    s_mov_b32 s51, 2097152
    s_mov_b32 s52, 18874368
    s_cmp_eq_u32 s8, 1
    s_cselect_b32 s52, s65, s52
    buffer_load_dwordx4 v[132:135], v1, s[12:15], s52 offen offset:0 sc1
    buffer_load_dwordx4 v[164:167], v1, s[12:15], s52 offen offset:1024 sc1
    s_cmp_lg_u32 s66, 0
    s_cbranch_scc1 L_skip1
    buffer_load_dwordx4 v[196:199], v1, s[12:15], s51 offen offset:0 sc1
    buffer_load_dwordx4 v[228:231], v1, s[12:15], s51 offen offset:1024 sc1
L_skip1:
    s_bitcmp1_b32 s53, 2
    s_cbranch_scc0 L_skip2
    s_mov_b32 s51, 4194304
    s_mov_b32 s52, 20971520
    s_cmp_eq_u32 s8, 2
    s_cselect_b32 s52, s65, s52
    buffer_load_dwordx4 v[136:139], v1, s[12:15], s52 offen offset:0 sc1
    buffer_load_dwordx4 v[168:171], v1, s[12:15], s52 offen offset:1024 sc1
    s_cmp_lg_u32 s66, 0
    s_cbranch_scc1 L_skip2
    buffer_load_dwordx4 v[200:203], v1, s[12:15], s51 offen offset:0 sc1
    buffer_load_dwordx4 v[232:235], v1, s[12:15], s51 offen offset:1024 sc1
L_skip2:
    s_bitcmp1_b32 s53, 3
    s_cbranch_scc0 L_skip3
    s_mov_b32 s51, 6291456
    s_mov_b32 s52, 23068672
    s_cmp_eq_u32 s8, 3
    s_cselect_b32 s52, s65, s52
    buffer_load_dwordx4 v[140:143], v1, s[12:15], s52 offen offset:0 sc1
    buffer_load_dwordx4 v[172:175], v1, s[12:15], s52 offen offset:1024 sc1
    s_cmp_lg_u32 s66, 0
    s_cbranch_scc1 L_skip3
    buffer_load_dwordx4 v[204:207], v1, s[12:15], s51 offen offset:0 sc1
    buffer_load_dwordx4 v[236:239], v1, s[12:15], s51 offen offset:1024 sc1
L_skip3:
    s_bitcmp1_b32 s53, 4
    s_cbranch_scc0 L_skip4
    s_mov_b32 s51, 8388608
    s_mov_b32 s52, 25165824
    s_cmp_eq_u32 s8, 4
    s_cselect_b32 s52, s65, s52
    buffer_load_dwordx4 v[144:147], v1, s[12:15], s52 offen offset:0 sc1
    buffer_load_dwordx4 v[176:179], v1, s[12:15], s52 offen offset:1024 sc1
    s_cmp_lg_u32 s66, 0
    s_cbranch_scc1 L_skip4
    buffer_load_dwordx4 v[208:211], v1, s[12:15], s51 offen offset:0 sc1
    buffer_load_dwordx4 v[240:243], v1, s[12:15], s51 offen offset:1024 sc1
L_skip4:
    s_bitcmp1_b32 s53, 5
    s_cbranch_scc0 L_skip5
    s_mov_b32 s51, 10485760
    s_mov_b32 s52, 27262976
    s_cmp_eq_u32 s8, 5
    s_cselect_b32 s52, s65, s52
    buffer_load_dwordx4 v[148:151], v1, s[12:15], s52 offen offset:0 sc1
    buffer_load_dwordx4 v[180:183], v1, s[12:15], s52 offen offset:1024 sc1
    s_cmp_lg_u32 s66, 0
    s_cbranch_scc1 L_skip5
    buffer_load_dwordx4 v[212:215], v1, s[12:15], s51 offen offset:0 sc1
    buffer_load_dwordx4 v[244:247], v1, s[12:15], s51 offen offset:1024 sc1
L_skip5:
    s_bitcmp1_b32 s53, 6
    s_cbranch_scc0 L_skip6
    s_mov_b32 s51, 12582912
    s_mov_b32 s52, 29360128
    s_cmp_eq_u32 s8, 6
    s_cselect_b32 s52, s65, s52
    buffer_load_dwordx4 v[152:155], v1, s[12:15], s52 offen offset:0 sc1
    buffer_load_dwordx4 v[184:187], v1, s[12:15], s52 offen offset:1024 sc1
    s_cmp_lg_u32 s66, 0
    s_cbranch_scc1 L_skip6
    buffer_load_dwordx4 v[216:219], v1, s[12:15], s51 offen offset:0 sc1
    buffer_load_dwordx4 v[248:251], v1, s[12:15], s51 offen offset:1024 sc1
L_skip6:
    s_bitcmp1_b32 s53, 7
    s_cbranch_scc0 L_skip7
    s_mov_b32 s51, 14680064
    s_mov_b32 s52, 31457280
    s_cmp_eq_u32 s8, 7
    s_cselect_b32 s52, s65, s52
    buffer_load_dwordx4 v[156:159], v1, s[12:15], s52 offen offset:0 sc1
    buffer_load_dwordx4 v[188:191], v1, s[12:15], s52 offen offset:1024 sc1
    s_cmp_lg_u32 s66, 0
    s_cbranch_scc1 L_skip7
    buffer_load_dwordx4 v[220:223], v1, s[12:15], s51 offen offset:0 sc1
    buffer_load_dwordx4 v[252:255], v1, s[12:15], s51 offen offset:1024 sc1
L_skip7:
    s_cmp_eq_u32 s10, 0xff
    s_cbranch_scc1 L_sum
    s_cmp_lg_u32 s53, 0
    s_cbranch_scc1 L_poll
    s_bitcmp1_b32 s11, s40
    s_cbranch_scc0 L_poll
    s_cmp_lg_u32 s49, 0
    s_cbranch_scc1 L_fin
    s_add_u32 s95, s95, 1
    s_cmp_lt_u32 s95, 4096
    s_cbranch_scc1 L_poll
    s_cmp_eq_u32 s66, 0
    s_cbranch_scc1 L_stored
    s_mov_b32 s30, s63
    s_lshl_b32 s51, s40, 21
    s_add_u32 s51, s51, 16777216
    buffer_store_dwordx4 v[120:123], v1, s[28:31], s51 offen sc1
    buffer_store_dwordx4 v[124:127], v1, s[28:31], s51 offen offset:1024 sc1
    s_waitcnt vmcnt(0)
L_stored:
    buffer_store_dword v8, v7, s[76:79], s56 offen offset:32 sc1
    s_mov_b32 s49, 1
    s_waitcnt vmcnt(0)
L_poll:
    buffer_load_dword v21, v59, s[76:79], 0 offen sc1
    s_waitcnt vmcnt(0)
    s_branch L_look
L_sum:
    s_waitcnt vmcnt(0)
    s_cmp_lg_u32 s66, 0
    s_cbranch_scc1 L_gated
    v_dot2_f32_bf16 v64, v192, s88, 0
    v_dot2_f32_bf16 v65, v192, s89, 0
    v_dot2_f32_bf16 v66, v193, s88, 0
    v_dot2_f32_bf16 v67, v193, s89, 0
    v_dot2_f32_bf16 v68, v194, s88, 0
    v_dot2_f32_bf16 v69, v194, s89, 0
    v_dot2_f32_bf16 v70, v195, s88, 0
    v_dot2_f32_bf16 v71, v195, s89, 0
    v_dot2_f32_bf16 v64, v196, s88, v64
    v_dot2_f32_bf16 v65, v196, s89, v65
    v_dot2_f32_bf16 v66, v197, s88, v66
    v_dot2_f32_bf16 v67, v197, s89, v67
    v_dot2_f32_bf16 v68, v198, s88, v68
    v_dot2_f32_bf16 v69, v198, s89, v69
    v_dot2_f32_bf16 v70, v199, s88, v70
    v_dot2_f32_bf16 v71, v199, s89, v71
    v_dot2_f32_bf16 v64, v200, s88, v64
    v_dot2_f32_bf16 v65, v200, s89, v65
    v_dot2_f32_bf16 v66, v201, s88, v66
    v_dot2_f32_bf16 v67, v201, s89, v67
    v_dot2_f32_bf16 v68, v202, s88, v68
    v_dot2_f32_bf16 v69, v202, s89, v69
    v_dot2_f32_bf16 v70, v203, s88, v70
    v_dot2_f32_bf16 v71, v203, s89, v71
    v_dot2_f32_bf16 v64, v204, s88, v64
    v_dot2_f32_bf16 v65, v204, s89, v65
    v_dot2_f32_bf16 v66, v205, s88, v66
    v_dot2_f32_bf16 v67, v205, s89, v67
    v_dot2_f32_bf16 v68, v206, s88, v68
    v_dot2_f32_bf16 v69, v206, s89, v69
    v_dot2_f32_bf16 v70, v207, s88, v70
    v_dot2_f32_bf16 v71, v207, s89, v71
    v_dot2_f32_bf16 v64, v208, s88, v64
    v_dot2_f32_bf16 v65, v208, s89, v65
    v_dot2_f32_bf16 v66, v209, s88, v66
    v_dot2_f32_bf16 v67, v209, s89, v67
    v_dot2_f32_bf16 v68, v210, s88, v68
    v_dot2_f32_bf16 v69, v210, s89, v69
    v_dot2_f32_bf16 v70, v211, s88, v70
    v_dot2_f32_bf16 v71, v211, s89, v71
    v_dot2_f32_bf16 v64, v212, s88, v64
    v_dot2_f32_bf16 v65, v212, s89, v65
    v_dot2_f32_bf16 v66, v213, s88, v66
    v_dot2_f32_bf16 v67, v213, s89, v67
    v_dot2_f32_bf16 v68, v214, s88, v68
    v_dot2_f32_bf16 v69, v214, s89, v69
    v_dot2_f32_bf16 v70, v215, s88, v70
    v_dot2_f32_bf16 v71, v215, s89, v71
    v_dot2_f32_bf16 v64, v216, s88, v64
    v_dot2_f32_bf16 v65, v216, s89, v65
    v_dot2_f32_bf16 v66, v217, s88, v66
    v_dot2_f32_bf16 v67, v217, s89, v67
    v_dot2_f32_bf16 v68, v218, s88, v68
    v_dot2_f32_bf16 v69, v218, s89, v69
    v_dot2_f32_bf16 v70, v219, s88, v70
    v_dot2_f32_bf16 v71, v219, s89, v71
    v_dot2_f32_bf16 v64, v220, s88, v64
    v_dot2_f32_bf16 v65, v220, s89, v65
    v_dot2_f32_bf16 v66, v221, s88, v66
    v_dot2_f32_bf16 v67, v221, s89, v67
    v_dot2_f32_bf16 v68, v222, s88, v68
    v_dot2_f32_bf16 v69, v222, s89, v69
    v_dot2_f32_bf16 v70, v223, s88, v70
    v_dot2_f32_bf16 v71, v223, s89, v71
    v_mul_f32 v96, 0xbfb8aa3b, v64
    v_mul_f32 v97, 0xbfb8aa3b, v65
    v_mul_f32 v98, 0xbfb8aa3b, v66
    v_mul_f32 v99, 0xbfb8aa3b, v67
    v_mul_f32 v100, 0xbfb8aa3b, v68
    v_mul_f32 v101, 0xbfb8aa3b, v69
    v_mul_f32 v102, 0xbfb8aa3b, v70
    v_mul_f32 v103, 0xbfb8aa3b, v71
    v_exp_f32 v96, v96
    v_exp_f32 v97, v97
    v_exp_f32 v98, v98
    v_exp_f32 v99, v99
    v_exp_f32 v100, v100
    v_exp_f32 v101, v101
    v_exp_f32 v102, v102
    v_exp_f32 v103, v103
    v_add_f32 v96, 1.0, v96
    v_add_f32 v97, 1.0, v97
    v_add_f32 v98, 1.0, v98
    v_add_f32 v99, 1.0, v99
    v_add_f32 v100, 1.0, v100
    v_add_f32 v101, 1.0, v101
    v_add_f32 v102, 1.0, v102
    v_add_f32 v103, 1.0, v103
    v_rcp_f32 v96, v96
    v_rcp_f32 v97, v97
    v_rcp_f32 v98, v98
    v_rcp_f32 v99, v99
    v_rcp_f32 v100, v100
    v_rcp_f32 v101, v101
    v_rcp_f32 v102, v102
    v_rcp_f32 v103, v103
    v_mul_f32 v64, v64, v96
    v_mul_f32 v65, v65, v97
    v_mul_f32 v66, v66, v98
    v_mul_f32 v67, v67, v99
    v_mul_f32 v68, v68, v100
    v_mul_f32 v69, v69, v101
    v_mul_f32 v70, v70, v102
    v_mul_f32 v71, v71, v103
    v_dot2_f32_bf16 v72, v224, s88, 0
    v_dot2_f32_bf16 v73, v224, s89, 0
    v_dot2_f32_bf16 v74, v225, s88, 0
    v_dot2_f32_bf16 v75, v225, s89, 0
    v_dot2_f32_bf16 v76, v226, s88, 0
    v_dot2_f32_bf16 v77, v226, s89, 0
    v_dot2_f32_bf16 v78, v227, s88, 0
    v_dot2_f32_bf16 v79, v227, s89, 0
    v_dot2_f32_bf16 v72, v228, s88, v72
    v_dot2_f32_bf16 v73, v228, s89, v73
    v_dot2_f32_bf16 v74, v229, s88, v74
    v_dot2_f32_bf16 v75, v229, s89, v75
    v_dot2_f32_bf16 v76, v230, s88, v76
    v_dot2_f32_bf16 v77, v230, s89, v77
    v_dot2_f32_bf16 v78, v231, s88, v78
    v_dot2_f32_bf16 v79, v231, s89, v79
    v_dot2_f32_bf16 v72, v232, s88, v72
    v_dot2_f32_bf16 v73, v232, s89, v73
    v_dot2_f32_bf16 v74, v233, s88, v74
    v_dot2_f32_bf16 v75, v233, s89, v75
    v_dot2_f32_bf16 v76, v234, s88, v76
    v_dot2_f32_bf16 v77, v234, s89, v77
    v_dot2_f32_bf16 v78, v235, s88, v78
    v_dot2_f32_bf16 v79, v235, s89, v79
    v_dot2_f32_bf16 v72, v236, s88, v72
    v_dot2_f32_bf16 v73, v236, s89, v73
    v_dot2_f32_bf16 v74, v237, s88, v74
    v_dot2_f32_bf16 v75, v237, s89, v75
    v_dot2_f32_bf16 v76, v238, s88, v76
    v_dot2_f32_bf16 v77, v238, s89, v77
    v_dot2_f32_bf16 v78, v239, s88, v78
    v_dot2_f32_bf16 v79, v239, s89, v79
    v_dot2_f32_bf16 v72, v240, s88, v72
    v_dot2_f32_bf16 v73, v240, s89, v73
    v_dot2_f32_bf16 v74, v241, s88, v74
    v_dot2_f32_bf16 v75, v241, s89, v75
    v_dot2_f32_bf16 v76, v242, s88, v76
    v_dot2_f32_bf16 v77, v242, s89, v77
    v_dot2_f32_bf16 v78, v243, s88, v78
    v_dot2_f32_bf16 v79, v243, s89, v79
    v_dot2_f32_bf16 v72, v244, s88, v72
    v_dot2_f32_bf16 v73, v244, s89, v73
    v_dot2_f32_bf16 v74, v245, s88, v74
    v_dot2_f32_bf16 v75, v245, s89, v75
    v_dot2_f32_bf16 v76, v246, s88, v76
    v_dot2_f32_bf16 v77, v246, s89, v77
    v_dot2_f32_bf16 v78, v247, s88, v78
    v_dot2_f32_bf16 v79, v247, s89, v79
    v_dot2_f32_bf16 v72, v248, s88, v72
    v_dot2_f32_bf16 v73, v248, s89, v73
    v_dot2_f32_bf16 v74, v249, s88, v74
    v_dot2_f32_bf16 v75, v249, s89, v75
    v_dot2_f32_bf16 v76, v250, s88, v76
    v_dot2_f32_bf16 v77, v250, s89, v77
    v_dot2_f32_bf16 v78, v251, s88, v78
    v_dot2_f32_bf16 v79, v251, s89, v79
    v_dot2_f32_bf16 v72, v252, s88, v72
    v_dot2_f32_bf16 v73, v252, s89, v73
    v_dot2_f32_bf16 v74, v253, s88, v74
    v_dot2_f32_bf16 v75, v253, s89, v75
    v_dot2_f32_bf16 v76, v254, s88, v76
    v_dot2_f32_bf16 v77, v254, s89, v77
    v_dot2_f32_bf16 v78, v255, s88, v78
    v_dot2_f32_bf16 v79, v255, s89, v79
    v_mul_f32 v96, 0xbfb8aa3b, v72
    v_mul_f32 v97, 0xbfb8aa3b, v73
    v_mul_f32 v98, 0xbfb8aa3b, v74
    v_mul_f32 v99, 0xbfb8aa3b, v75
    v_mul_f32 v100, 0xbfb8aa3b, v76
    v_mul_f32 v101, 0xbfb8aa3b, v77
    v_mul_f32 v102, 0xbfb8aa3b, v78
    v_mul_f32 v103, 0xbfb8aa3b, v79
    v_exp_f32 v96, v96
    v_exp_f32 v97, v97
    v_exp_f32 v98, v98
    v_exp_f32 v99, v99
    v_exp_f32 v100, v100
    v_exp_f32 v101, v101
    v_exp_f32 v102, v102
    v_exp_f32 v103, v103
    v_add_f32 v96, 1.0, v96
    v_add_f32 v97, 1.0, v97
    v_add_f32 v98, 1.0, v98
    v_add_f32 v99, 1.0, v99
    v_add_f32 v100, 1.0, v100
    v_add_f32 v101, 1.0, v101
    v_add_f32 v102, 1.0, v102
    v_add_f32 v103, 1.0, v103
    v_rcp_f32 v96, v96
    v_rcp_f32 v97, v97
    v_rcp_f32 v98, v98
    v_rcp_f32 v99, v99
    v_rcp_f32 v100, v100
    v_rcp_f32 v101, v101
    v_rcp_f32 v102, v102
    v_rcp_f32 v103, v103
    v_mul_f32 v72, v72, v96
    v_mul_f32 v73, v73, v97
    v_mul_f32 v74, v74, v98
    v_mul_f32 v75, v75, v99
    v_mul_f32 v76, v76, v100
    v_mul_f32 v77, v77, v101
    v_mul_f32 v78, v78, v102
    v_mul_f32 v79, v79, v103
L_gated:
L_gated2:
    v_dot2_f32_bf16 v80, v120, s88, 0
    v_dot2_f32_bf16 v81, v120, s89, 0
    v_dot2_f32_bf16 v82, v121, s88, 0
    v_dot2_f32_bf16 v83, v121, s89, 0
    v_dot2_f32_bf16 v84, v122, s88, 0
    v_dot2_f32_bf16 v85, v122, s89, 0
    v_dot2_f32_bf16 v86, v123, s88, 0
    v_dot2_f32_bf16 v87, v123, s89, 0
    s_waitcnt vmcnt(16)
    v_dot2_f32_bf16 v80, v128, s88, v80
    v_dot2_f32_bf16 v81, v128, s89, v81
    v_dot2_f32_bf16 v82, v129, s88, v82
    v_dot2_f32_bf16 v83, v129, s89, v83
    v_dot2_f32_bf16 v84, v130, s88, v84
    v_dot2_f32_bf16 v85, v130, s89, v85
    v_dot2_f32_bf16 v86, v131, s88, v86
    v_dot2_f32_bf16 v87, v131, s89, v87
    s_waitcnt vmcnt(15)
    v_dot2_f32_bf16 v80, v132, s88, v80
    v_dot2_f32_bf16 v81, v132, s89, v81
    v_dot2_f32_bf16 v82, v133, s88, v82
    v_dot2_f32_bf16 v83, v133, s89, v83
    v_dot2_f32_bf16 v84, v134, s88, v84
    v_dot2_f32_bf16 v85, v134, s89, v85
    v_dot2_f32_bf16 v86, v135, s88, v86
    v_dot2_f32_bf16 v87, v135, s89, v87
    s_waitcnt vmcnt(14)
    v_dot2_f32_bf16 v80, v136, s88, v80
    v_dot2_f32_bf16 v81, v136, s89, v81
    v_dot2_f32_bf16 v82, v137, s88, v82
    v_dot2_f32_bf16 v83, v137, s89, v83
    v_dot2_f32_bf16 v84, v138, s88, v84
    v_dot2_f32_bf16 v85, v138, s89, v85
    v_dot2_f32_bf16 v86, v139, s88, v86
    v_dot2_f32_bf16 v87, v139, s89, v87
    s_waitcnt vmcnt(13)
    v_dot2_f32_bf16 v80, v140, s88, v80
    v_dot2_f32_bf16 v81, v140, s89, v81
    v_dot2_f32_bf16 v82, v141, s88, v82
    v_dot2_f32_bf16 v83, v141, s89, v83
    v_dot2_f32_bf16 v84, v142, s88, v84
    v_dot2_f32_bf16 v85, v142, s89, v85
    v_dot2_f32_bf16 v86, v143, s88, v86
    v_dot2_f32_bf16 v87, v143, s89, v87
    s_waitcnt vmcnt(12)
    v_dot2_f32_bf16 v80, v144, s88, v80
    v_dot2_f32_bf16 v81, v144, s89, v81
    v_dot2_f32_bf16 v82, v145, s88, v82
    v_dot2_f32_bf16 v83, v145, s89, v83
    v_dot2_f32_bf16 v84, v146, s88, v84
    v_dot2_f32_bf16 v85, v146, s89, v85
    v_dot2_f32_bf16 v86, v147, s88, v86
    v_dot2_f32_bf16 v87, v147, s89, v87
    s_waitcnt vmcnt(11)
    v_dot2_f32_bf16 v80, v148, s88, v80
    v_dot2_f32_bf16 v81, v148, s89, v81
    v_dot2_f32_bf16 v82, v149, s88, v82
    v_dot2_f32_bf16 v83, v149, s89, v83
    v_dot2_f32_bf16 v84, v150, s88, v84
    v_dot2_f32_bf16 v85, v150, s89, v85
    v_dot2_f32_bf16 v86, v151, s88, v86
    v_dot2_f32_bf16 v87, v151, s89, v87
    s_waitcnt vmcnt(10)
    v_dot2_f32_bf16 v80, v152, s88, v80
    v_dot2_f32_bf16 v81, v152, s89, v81
    v_dot2_f32_bf16 v82, v153, s88, v82
    v_dot2_f32_bf16 v83, v153, s89, v83
    v_dot2_f32_bf16 v84, v154, s88, v84
    v_dot2_f32_bf16 v85, v154, s89, v85
    v_dot2_f32_bf16 v86, v155, s88, v86
    v_dot2_f32_bf16 v87, v155, s89, v87
    s_waitcnt vmcnt(9)
    v_dot2_f32_bf16 v80, v156, s88, v80
    v_dot2_f32_bf16 v81, v156, s89, v81
    v_dot2_f32_bf16 v82, v157, s88, v82
    v_dot2_f32_bf16 v83, v157, s89, v83
    v_dot2_f32_bf16 v84, v158, s88, v84
    v_dot2_f32_bf16 v85, v158, s89, v85
    v_dot2_f32_bf16 v86, v159, s88, v86
    v_dot2_f32_bf16 v87, v159, s89, v87
    v_lshlrev_b32 v96, 16, v112
    v_and_b32 v97, s61, v112
    v_pk_fma_f32 v[96:97], v[80:81], v[64:65], v[96:97]
    v_cvt_pk_bf16_f32 v112, v96, v97
    v_lshlrev_b32 v98, 16, v113
    v_and_b32 v99, s61, v113
    v_pk_fma_f32 v[98:99], v[82:83], v[66:67], v[98:99]
    v_cvt_pk_bf16_f32 v113, v98, v99
    v_lshlrev_b32 v100, 16, v114
    v_and_b32 v101, s61, v114
    v_pk_fma_f32 v[100:101], v[84:85], v[68:69], v[100:101]
    v_cvt_pk_bf16_f32 v114, v100, v101
    v_lshlrev_b32 v102, 16, v115
    v_and_b32 v103, s61, v115
    v_pk_fma_f32 v[102:103], v[86:87], v[70:71], v[102:103]
    v_cvt_pk_bf16_f32 v115, v102, v103
    buffer_store_dwordx2 v[112:113], v57, s[80:83], 0 offen offset:0
    buffer_store_dwordx2 v[114:115], v57, s[80:83], 0 offen offset:32
    v_dot2_f32_bf16 v88, v124, s88, 0
    v_dot2_f32_bf16 v89, v124, s89, 0
    v_dot2_f32_bf16 v90, v125, s88, 0
    v_dot2_f32_bf16 v91, v125, s89, 0
    v_dot2_f32_bf16 v92, v126, s88, 0
    v_dot2_f32_bf16 v93, v126, s89, 0
    v_dot2_f32_bf16 v94, v127, s88, 0
    v_dot2_f32_bf16 v95, v127, s89, 0
    s_waitcnt vmcnt(10)
    v_dot2_f32_bf16 v88, v160, s88, v88
    v_dot2_f32_bf16 v89, v160, s89, v89
    v_dot2_f32_bf16 v90, v161, s88, v90
    v_dot2_f32_bf16 v91, v161, s89, v91
    v_dot2_f32_bf16 v92, v162, s88, v92
    v_dot2_f32_bf16 v93, v162, s89, v93
    v_dot2_f32_bf16 v94, v163, s88, v94
    v_dot2_f32_bf16 v95, v163, s89, v95
    s_waitcnt vmcnt(9)
    v_dot2_f32_bf16 v88, v164, s88, v88
    v_dot2_f32_bf16 v89, v164, s89, v89
    v_dot2_f32_bf16 v90, v165, s88, v90
    v_dot2_f32_bf16 v91, v165, s89, v91
    v_dot2_f32_bf16 v92, v166, s88, v92
    v_dot2_f32_bf16 v93, v166, s89, v93
    v_dot2_f32_bf16 v94, v167, s88, v94
    v_dot2_f32_bf16 v95, v167, s89, v95
    s_waitcnt vmcnt(8)
    v_dot2_f32_bf16 v88, v168, s88, v88
    v_dot2_f32_bf16 v89, v168, s89, v89
    v_dot2_f32_bf16 v90, v169, s88, v90
    v_dot2_f32_bf16 v91, v169, s89, v91
    v_dot2_f32_bf16 v92, v170, s88, v92
    v_dot2_f32_bf16 v93, v170, s89, v93
    v_dot2_f32_bf16 v94, v171, s88, v94
    v_dot2_f32_bf16 v95, v171, s89, v95
    s_waitcnt vmcnt(7)
    v_dot2_f32_bf16 v88, v172, s88, v88
    v_dot2_f32_bf16 v89, v172, s89, v89
    v_dot2_f32_bf16 v90, v173, s88, v90
    v_dot2_f32_bf16 v91, v173, s89, v91
    v_dot2_f32_bf16 v92, v174, s88, v92
    v_dot2_f32_bf16 v93, v174, s89, v93
    v_dot2_f32_bf16 v94, v175, s88, v94
    v_dot2_f32_bf16 v95, v175, s89, v95
    s_waitcnt vmcnt(6)
    v_dot2_f32_bf16 v88, v176, s88, v88
    v_dot2_f32_bf16 v89, v176, s89, v89
    v_dot2_f32_bf16 v90, v177, s88, v90
    v_dot2_f32_bf16 v91, v177, s89, v91
    v_dot2_f32_bf16 v92, v178, s88, v92
    v_dot2_f32_bf16 v93, v178, s89, v93
    v_dot2_f32_bf16 v94, v179, s88, v94
    v_dot2_f32_bf16 v95, v179, s89, v95
    s_waitcnt vmcnt(5)
    v_dot2_f32_bf16 v88, v180, s88, v88
    v_dot2_f32_bf16 v89, v180, s89, v89
    v_dot2_f32_bf16 v90, v181, s88, v90
    v_dot2_f32_bf16 v91, v181, s89, v91
    v_dot2_f32_bf16 v92, v182, s88, v92
    v_dot2_f32_bf16 v93, v182, s89, v93
    v_dot2_f32_bf16 v94, v183, s88, v94
    v_dot2_f32_bf16 v95, v183, s89, v95
    s_waitcnt vmcnt(4)
    v_dot2_f32_bf16 v88, v184, s88, v88
    v_dot2_f32_bf16 v89, v184, s89, v89
    v_dot2_f32_bf16 v90, v185, s88, v90
    v_dot2_f32_bf16 v91, v185, s89, v91
    v_dot2_f32_bf16 v92, v186, s88, v92
    v_dot2_f32_bf16 v93, v186, s89, v93
    v_dot2_f32_bf16 v94, v187, s88, v94
    v_dot2_f32_bf16 v95, v187, s89, v95
    s_waitcnt vmcnt(3)
    v_dot2_f32_bf16 v88, v188, s88, v88
    v_dot2_f32_bf16 v89, v188, s89, v89
    v_dot2_f32_bf16 v90, v189, s88, v90
    v_dot2_f32_bf16 v91, v189, s89, v91
    v_dot2_f32_bf16 v92, v190, s88, v92
    v_dot2_f32_bf16 v93, v190, s89, v93
    v_dot2_f32_bf16 v94, v191, s88, v94
    v_dot2_f32_bf16 v95, v191, s89, v95
    v_lshlrev_b32 v96, 16, v116
    v_and_b32 v97, s61, v116
    v_pk_fma_f32 v[96:97], v[88:89], v[72:73], v[96:97]
    v_cvt_pk_bf16_f32 v116, v96, v97
    v_lshlrev_b32 v98, 16, v117
    v_and_b32 v99, s61, v117
    v_pk_fma_f32 v[98:99], v[90:91], v[74:75], v[98:99]
    v_cvt_pk_bf16_f32 v117, v98, v99
    v_lshlrev_b32 v100, 16, v118
    v_and_b32 v101, s61, v118
    v_pk_fma_f32 v[100:101], v[92:93], v[76:77], v[100:101]
    v_cvt_pk_bf16_f32 v118, v100, v101
    v_lshlrev_b32 v102, 16, v119
    v_and_b32 v103, s61, v119
    v_pk_fma_f32 v[102:103], v[94:95], v[78:79], v[102:103]
    v_cvt_pk_bf16_f32 v119, v102, v103
    buffer_store_dwordx2 v[116:117], v57, s[80:83], s57 offen offset:0
    buffer_store_dwordx2 v[118:119], v57, s[80:83], s57 offen offset:32
L_seen:
    s_cmp_eq_u32 s11, 0xff
    s_cbranch_scc1 L_all
    buffer_load_dword v21, v59, s[76:79], 0 offen sc1
    s_waitcnt vmcnt(0)
    v_cmp_eq_u32 vcc, s75, v21
    s_nop 0
    s_and_b32 s11, vcc_lo, 0xff
    s_lshr_b32 s94, vcc_lo, 8
    s_and_b32 s94, s94, 0xff
    s_branch L_seen
L_all:
    s_lshl_b32 s51, 1, s8
    s_andn2_b32 s47, s47, s51
    s_and_b32 s51, s47, s94
    s_cbranch_scc0 L_fin
    s_ff1_i32_b32 s8, s51
    s_mov_b32 s66, 0
    s_waitcnt vmcnt(0)
    s_branch L_slice
L_fin:
L_end:
    s_endpgm
L_hook:
    s_cmp_eq_u32 s42, 0
    s_cbranch_scc0 L_dback
    s_lshl_b32 s51, s41, 3
    v_mov_b32 v4, s51
    s_cmp_eq_u32 s59, 0
    s_cbranch_scc0 L_dback
    v_mov_b32 v3, 1
    s_mov_b64 exec, 1
    global_atomic_add v4, v3, s[84:85] sc1
    s_mov_b64 exec, -1
    s_branch L_dback
L_slow:
    s_waitcnt vmcnt(0)
    s_mov_b32 s59, 1
    s_mov_b32 s58, 0
    s_lshl_b32 s54, s42, 12
    s_mov_b32 m0, s56
    v_mov_b32 v60, 0xff800000
    v_mov_b32 v61, 0xff800000
    v_mov_b32 v62, 0xff800000
    v_mov_b32 v63, 0xff800000
L_slow_loop:
    s_barrier
    buffer_load_dwordx4 v46, s[8:11], s54 offen offset:0 lds
    buffer_load_dwordx4 v47, s[8:11], s54 offen offset:1024 lds
    buffer_load_dwordx4 v48, s[8:11], s54 offen offset:2048 lds
    buffer_load_dwordx4 v49, s[8:11], s54 offen offset:3072 lds
    s_add_u32 s54, s54, 16384
    s_waitcnt vmcnt(0)
    s_barrier
    ds_read_b128 a[0:3], v34 offset:0
    ds_read_b128 a[4:7], v35 offset:0
    ds_read_b128 a[8:11], v36 offset:0
    ds_read_b128 a[12:15], v37 offset:0
    s_waitcnt lgkmcnt(0)
    v_mfma_f32_16x16x32_bf16 v[128:131], a[0:3], v[64:67], 0
    v_mfma_f32_16x16x32_bf16 v[132:135], a[0:3], v[80:83], 0
    v_mfma_f32_16x16x32_bf16 v[136:139], a[0:3], v[96:99], 0
    v_mfma_f32_16x16x32_bf16 v[140:143], a[0:3], v[112:115], 0
    v_mfma_f32_16x16x32_bf16 v[128:131], a[4:7], v[68:71], v[128:131]
    v_mfma_f32_16x16x32_bf16 v[132:135], a[4:7], v[84:87], v[132:135]
    v_mfma_f32_16x16x32_bf16 v[136:139], a[4:7], v[100:103], v[136:139]
    v_mfma_f32_16x16x32_bf16 v[140:143], a[4:7], v[116:119], v[140:143]
    v_mfma_f32_16x16x32_bf16 v[128:131], a[8:11], v[72:75], v[128:131]
    v_mfma_f32_16x16x32_bf16 v[132:135], a[8:11], v[88:91], v[132:135]
    v_mfma_f32_16x16x32_bf16 v[136:139], a[8:11], v[104:107], v[136:139]
    v_mfma_f32_16x16x32_bf16 v[140:143], a[8:11], v[120:123], v[140:143]
    v_mfma_f32_16x16x32_bf16 v[128:131], a[12:15], v[76:79], v[128:131]
    v_mfma_f32_16x16x32_bf16 v[132:135], a[12:15], v[92:95], v[132:135]
    v_mfma_f32_16x16x32_bf16 v[136:139], a[12:15], v[108:111], v[136:139]
    v_mfma_f32_16x16x32_bf16 v[140:143], a[12:15], v[124:127], v[140:143]
    s_nop 4
    v_max3_f32 v60, v128, v129, v60
    v_max3_f32 v60, v130, v131, v60
    v_max3_f32 v61, v132, v133, v61
    v_max3_f32 v61, v134, v135, v61
    v_max3_f32 v62, v136, v137, v62
    v_max3_f32 v62, v138, v139, v62
    v_max3_f32 v63, v140, v141, v63
    v_max3_f32 v63, v142, v143, v63
    ds_read_b128 a[0:3], v34 offset:4096
    ds_read_b128 a[4:7], v35 offset:4096
    ds_read_b128 a[8:11], v36 offset:4096
    ds_read_b128 a[12:15], v37 offset:4096
    s_waitcnt lgkmcnt(0)
    v_mfma_f32_16x16x32_bf16 v[128:131], a[0:3], v[64:67], 0
    v_mfma_f32_16x16x32_bf16 v[132:135], a[0:3], v[80:83], 0
    v_mfma_f32_16x16x32_bf16 v[136:139], a[0:3], v[96:99], 0
    v_mfma_f32_16x16x32_bf16 v[140:143], a[0:3], v[112:115], 0
    v_mfma_f32_16x16x32_bf16 v[128:131], a[4:7], v[68:71], v[128:131]
    v_mfma_f32_16x16x32_bf16 v[132:135], a[4:7], v[84:87], v[132:135]
    v_mfma_f32_16x16x32_bf16 v[136:139], a[4:7], v[100:103], v[136:139]
    v_mfma_f32_16x16x32_bf16 v[140:143], a[4:7], v[116:119], v[140:143]
    v_mfma_f32_16x16x32_bf16 v[128:131], a[8:11], v[72:75], v[128:131]
    v_mfma_f32_16x16x32_bf16 v[132:135], a[8:11], v[88:91], v[132:135]
    v_mfma_f32_16x16x32_bf16 v[136:139], a[8:11], v[104:107], v[136:139]
    v_mfma_f32_16x16x32_bf16 v[140:143], a[8:11], v[120:123], v[140:143]
    v_mfma_f32_16x16x32_bf16 v[128:131], a[12:15], v[76:79], v[128:131]
    v_mfma_f32_16x16x32_bf16 v[132:135], a[12:15], v[92:95], v[132:135]
    v_mfma_f32_16x16x32_bf16 v[136:139], a[12:15], v[108:111], v[136:139]
    v_mfma_f32_16x16x32_bf16 v[140:143], a[12:15], v[124:127], v[140:143]
    s_nop 4
    v_max3_f32 v60, v128, v129, v60
    v_max3_f32 v60, v130, v131, v60
    v_max3_f32 v61, v132, v133, v61
    v_max3_f32 v61, v134, v135, v61
    v_max3_f32 v62, v136, v137, v62
    v_max3_f32 v62, v138, v139, v62
    v_max3_f32 v63, v140, v141, v63
    v_max3_f32 v63, v142, v143, v63
    ds_read_b128 a[0:3], v34 offset:8192
    ds_read_b128 a[4:7], v35 offset:8192
    ds_read_b128 a[8:11], v36 offset:8192
    ds_read_b128 a[12:15], v37 offset:8192
    s_waitcnt lgkmcnt(0)
    v_mfma_f32_16x16x32_bf16 v[128:131], a[0:3], v[64:67], 0
    v_mfma_f32_16x16x32_bf16 v[132:135], a[0:3], v[80:83], 0
    v_mfma_f32_16x16x32_bf16 v[136:139], a[0:3], v[96:99], 0
    v_mfma_f32_16x16x32_bf16 v[140:143], a[0:3], v[112:115], 0
    v_mfma_f32_16x16x32_bf16 v[128:131], a[4:7], v[68:71], v[128:131]
    v_mfma_f32_16x16x32_bf16 v[132:135], a[4:7], v[84:87], v[132:135]
    v_mfma_f32_16x16x32_bf16 v[136:139], a[4:7], v[100:103], v[136:139]
    v_mfma_f32_16x16x32_bf16 v[140:143], a[4:7], v[116:119], v[140:143]
    v_mfma_f32_16x16x32_bf16 v[128:131], a[8:11], v[72:75], v[128:131]
    v_mfma_f32_16x16x32_bf16 v[132:135], a[8:11], v[88:91], v[132:135]
    v_mfma_f32_16x16x32_bf16 v[136:139], a[8:11], v[104:107], v[136:139]
    v_mfma_f32_16x16x32_bf16 v[140:143], a[8:11], v[120:123], v[140:143]
    v_mfma_f32_16x16x32_bf16 v[128:131], a[12:15], v[76:79], v[128:131]
    v_mfma_f32_16x16x32_bf16 v[132:135], a[12:15], v[92:95], v[132:135]
    v_mfma_f32_16x16x32_bf16 v[136:139], a[12:15], v[108:111], v[136:139]
    v_mfma_f32_16x16x32_bf16 v[140:143], a[12:15], v[124:127], v[140:143]
    s_nop 4
    v_max3_f32 v60, v128, v129, v60
    v_max3_f32 v60, v130, v131, v60
    v_max3_f32 v61, v132, v133, v61
    v_max3_f32 v61, v134, v135, v61
    v_max3_f32 v62, v136, v137, v62
    v_max3_f32 v62, v138, v139, v62
    v_max3_f32 v63, v140, v141, v63
    v_max3_f32 v63, v142, v143, v63
    ds_read_b128 a[0:3], v34 offset:12288
    ds_read_b128 a[4:7], v35 offset:12288
    ds_read_b128 a[8:11], v36 offset:12288
    ds_read_b128 a[12:15], v37 offset:12288
    s_waitcnt lgkmcnt(0)
    v_mfma_f32_16x16x32_bf16 v[128:131], a[0:3], v[64:67], 0
    v_mfma_f32_16x16x32_bf16 v[132:135], a[0:3], v[80:83], 0
    v_mfma_f32_16x16x32_bf16 v[136:139], a[0:3], v[96:99], 0
    v_mfma_f32_16x16x32_bf16 v[140:143], a[0:3], v[112:115], 0
    v_mfma_f32_16x16x32_bf16 v[128:131], a[4:7], v[68:71], v[128:131]
    v_mfma_f32_16x16x32_bf16 v[132:135], a[4:7], v[84:87], v[132:135]
    v_mfma_f32_16x16x32_bf16 v[136:139], a[4:7], v[100:103], v[136:139]
    v_mfma_f32_16x16x32_bf16 v[140:143], a[4:7], v[116:119], v[140:143]
    v_mfma_f32_16x16x32_bf16 v[128:131], a[8:11], v[72:75], v[128:131]
    v_mfma_f32_16x16x32_bf16 v[132:135], a[8:11], v[88:91], v[132:135]
    v_mfma_f32_16x16x32_bf16 v[136:139], a[8:11], v[104:107], v[136:139]
    v_mfma_f32_16x16x32_bf16 v[140:143], a[8:11], v[120:123], v[140:143]
    v_mfma_f32_16x16x32_bf16 v[128:131], a[12:15], v[76:79], v[128:131]
    v_mfma_f32_16x16x32_bf16 v[132:135], a[12:15], v[92:95], v[132:135]
    v_mfma_f32_16x16x32_bf16 v[136:139], a[12:15], v[108:111], v[136:139]
    v_mfma_f32_16x16x32_bf16 v[140:143], a[12:15], v[124:127], v[140:143]
    s_nop 4
    v_max3_f32 v60, v128, v129, v60
    v_max3_f32 v60, v130, v131, v60
    v_max3_f32 v61, v132, v133, v61
    v_max3_f32 v61, v134, v135, v61
    v_max3_f32 v62, v136, v137, v62
    v_max3_f32 v62, v138, v139, v62
    v_max3_f32 v63, v140, v141, v63
    v_max3_f32 v63, v142, v143, v63
    s_add_u32 s58, s58, 1
    s_cmp_lt_u32 s58, 32
    s_cbranch_scc1 L_slow_loop
    s_barrier
    v_accvgpr_write_b32 a108, 0
    v_accvgpr_write_b32 a109, 0
    v_accvgpr_write_b32 a110, 0
    v_accvgpr_write_b32 a111, 0
    v_subrev_u32 v34, 32768, v34
    v_subrev_u32 v35, 32768, v35
    v_subrev_u32 v36, 32768, v36
    v_subrev_u32 v37, 32768, v37
    v_subrev_u32 v42, 57344, v42
    v_subrev_u32 v43, 57344, v43
    v_subrev_u32 v44, 57344, v44
    v_subrev_u32 v45, 57344, v45
    s_cmp_lt_u32 s42, 2
    s_cselect_b64 vcc, -1, 0
    v_cndmask_b32 v30, v50, v46, vcc
    v_cndmask_b32 v31, v51, v47, vcc
    v_cndmask_b32 v32, v50, v48, vcc
    v_cndmask_b32 v33, v51, v49, vcc
    s_and_b32 s52, s41, 0
    s_lshl_b32 s52, s52, 14
    s_and_b32 s53, s42, 1
    s_lshl_b32 s53, s53, 12
    s_add_u32 s94, s52, s53
    s_lshr_b32 s51, s42, 1
    s_add_u32 s51, s51, 1
    s_lshl_b32 s51, s51, 13
    s_add_u32 s54, s94, s51
    s_and_b32 s54, s54, 0x7ffff
    s_sub_u32 s55, s54, 16384
    s_and_b32 s55, s55, 0x7ffff
    s_mul_i32 s51, s42, 2048
    v_add_u32 v18, s51, v1
    s_mov_b32 m0, s95
    s_nop 0
    buffer_load_dwordx4 v30, s[88:91], s94 offen offset:0 lds
    buffer_load_dwordx4 v31, s[88:91], s94 offen offset:1024 lds
    buffer_load_dwordx4 v32, s[88:91], s94 offen offset:2048 lds
    buffer_load_dwordx4 v33, s[88:91], s94 offen offset:3072 lds
    s_sub_u32 m0, s56, 24576
    s_nop 0
    buffer_load_dwordx4 v46, s[8:11], s54 offen offset:0 lds
    buffer_load_dwordx4 v47, s[8:11], s54 offen offset:1024 lds
    buffer_load_dwordx4 v48, s[8:11], s54 offen offset:2048 lds
    buffer_load_dwordx4 v49, s[8:11], s54 offen offset:3072 lds
    s_add_u32 s54, s54, 16384
    s_and_b32 s54, s54, 524287
    s_add_u32 m0, s56, 16384
    s_nop 0
    buffer_load_dwordx4 v46, s[8:11], s54 offen offset:0 lds
    buffer_load_dwordx4 v47, s[8:11], s54 offen offset:1024 lds
    buffer_load_dwordx4 v48, s[8:11], s54 offen offset:2048 lds
    buffer_load_dwordx4 v49, s[8:11], s54 offen offset:3072 lds
    s_add_u32 s54, s54, 16384
    s_and_b32 s54, s54, 524287
    s_add_u32 m0, s57, 0
    s_nop 0
    buffer_load_dwordx4 v50, s[12:15], s55 offen offset:0 lds
    buffer_load_dwordx4 v51, s[12:15], s55 offen offset:1024 lds
    buffer_load_dwordx4 v50, s[12:15], s55 offen offset:2048 lds
    buffer_load_dwordx4 v51, s[12:15], s55 offen offset:3072 lds
    s_add_u32 s55, s55, 16384
    s_and_b32 s55, s55, 524287
    s_add_u32 m0, s57, 16384
    s_nop 0
    buffer_load_dwordx4 v50, s[12:15], s55 offen offset:0 lds
    buffer_load_dwordx4 v51, s[12:15], s55 offen offset:1024 lds
    buffer_load_dwordx4 v50, s[12:15], s55 offen offset:2048 lds
    buffer_load_dwordx4 v51, s[12:15], s55 offen offset:3072 lds
    s_add_u32 s55, s55, 16384
    s_and_b32 s55, s55, 524287
    s_waitcnt vmcnt(0)
    s_barrier
    ds_read_b128 a[0:3], v34 offset:0
    ds_read_b128 a[4:7], v35 offset:0
    ds_read_b128 a[8:11], v36 offset:0
    ds_read_b128 a[12:15], v37 offset:0
    ds_read_b128 a[80:83], v34 offset:4096
    ds_read_b128 a[84:87], v35 offset:4096
    ds_read_b128 a[88:91], v36 offset:4096
    ds_read_b128 a[92:95], v37 offset:4096
    s_waitcnt lgkmcnt(0)
    v_mfma_f32_16x16x32_bf16 v[128:131], a[0:3], v[64:67], 0
    v_mfma_f32_16x16x32_bf16 v[132:135], a[0:3], v[80:83], 0
    v_mfma_f32_16x16x32_bf16 v[136:139], a[0:3], v[96:99], 0
    v_mfma_f32_16x16x32_bf16 v[140:143], a[0:3], v[112:115], 0
    v_mfma_f32_16x16x32_bf16 v[128:131], a[4:7], v[68:71], v[128:131]
    v_mfma_f32_16x16x32_bf16 v[132:135], a[4:7], v[84:87], v[132:135]
    v_mfma_f32_16x16x32_bf16 v[136:139], a[4:7], v[100:103], v[136:139]
    v_mfma_f32_16x16x32_bf16 v[140:143], a[4:7], v[116:119], v[140:143]
    v_mfma_f32_16x16x32_bf16 v[128:131], a[8:11], v[72:75], v[128:131]
    v_mfma_f32_16x16x32_bf16 v[132:135], a[8:11], v[88:91], v[132:135]
    v_mfma_f32_16x16x32_bf16 v[136:139], a[8:11], v[104:107], v[136:139]
    v_mfma_f32_16x16x32_bf16 v[140:143], a[8:11], v[120:123], v[140:143]
    v_mfma_f32_16x16x32_bf16 v[128:131], a[12:15], v[76:79], v[128:131]
    v_mfma_f32_16x16x32_bf16 v[132:135], a[12:15], v[92:95], v[132:135]
    v_mfma_f32_16x16x32_bf16 v[136:139], a[12:15], v[108:111], v[136:139]
    v_mfma_f32_16x16x32_bf16 v[140:143], a[12:15], v[124:127], v[140:143]
    v_mfma_f32_16x16x32_bf16 v[144:147], a[80:83], v[64:67], 0
    v_mfma_f32_16x16x32_bf16 v[148:151], a[80:83], v[80:83], 0
    v_mfma_f32_16x16x32_bf16 v[152:155], a[80:83], v[96:99], 0
    v_mfma_f32_16x16x32_bf16 v[156:159], a[80:83], v[112:115], 0
    v_mfma_f32_16x16x32_bf16 v[144:147], a[84:87], v[68:71], v[144:147]
    v_mfma_f32_16x16x32_bf16 v[148:151], a[84:87], v[84:87], v[148:151]
    v_mfma_f32_16x16x32_bf16 v[152:155], a[84:87], v[100:103], v[152:155]
    v_mfma_f32_16x16x32_bf16 v[156:159], a[84:87], v[116:119], v[156:159]
    v_mfma_f32_16x16x32_bf16 v[144:147], a[88:91], v[72:75], v[144:147]
    v_mfma_f32_16x16x32_bf16 v[148:151], a[88:91], v[88:91], v[148:151]
    v_mfma_f32_16x16x32_bf16 v[152:155], a[88:91], v[104:107], v[152:155]
    v_mfma_f32_16x16x32_bf16 v[156:159], a[88:91], v[120:123], v[156:159]
    v_mfma_f32_16x16x32_bf16 v[144:147], a[92:95], v[76:79], v[144:147]
    v_mfma_f32_16x16x32_bf16 v[148:151], a[92:95], v[92:95], v[148:151]
    v_mfma_f32_16x16x32_bf16 v[152:155], a[92:95], v[108:111], v[152:155]
    v_mfma_f32_16x16x32_bf16 v[156:159], a[92:95], v[124:127], v[156:159]
    s_nop 7
    s_branch L_max
L_code_end:
.section .rodata,"a"
.p2align 6
.amdhsa_kernel recurrent_scan__gqa_block_cached__glu_gated_glu__prompt_kernel
  .amdhsa_next_free_vgpr 512
  .amdhsa_next_free_sgpr 102
  .amdhsa_accum_offset 256
  .amdhsa_group_segment_fixed_size 0
  .amdhsa_kernarg_size 96
  .amdhsa_user_sgpr_count 2
  .amdhsa_user_sgpr_kernarg_segment_ptr 1
  .amdhsa_system_sgpr_workgroup_id_x 1
  .amdhsa_float_denorm_mode_32 3
.end_amdhsa_kernel
```
